```python
import torch

def _softmax(x, axis=-1):
    return torch.softmax(x, dim=axis)
def _gelu(x):
    return torch.nn.functional.gelu(x, approximate="tanh")
def _silu(x):
    return torch.nn.functional.silu(x)
def _sigmoid(x):
    return torch.sigmoid(x)
def _layernorm(x, axis=-1, eps=1e-5):
    m = x.mean(dim=axis, keepdim=True)
    v = x.var(dim=axis, keepdim=True, unbiased=False)
    return (x - m) / torch.sqrt(v + eps)
def _scatter_add(tgt, idx, src, axis=0):
    return tgt.clone().index_add_(axis, idx, src)
def _segment_sum(src, seg, n):
    out = torch.zeros((n,) + src.shape[1:], dtype=src.dtype)
    return out.index_add_(0, seg, src)
def _pad(x, pw):
    flat = tuple(v for pair in reversed(pw) for v in pair)
    return torch.nn.functional.pad(x, flat)

kernel_name = 'recurrent_scan__linear_kernel_hedgehog__mixer_s_mlp__prompt'

def setup_inputs():

    _w = (lambda a: (lambda t: t.to(torch.bfloat16) if t.is_floating_point() else t)(torch.as_tensor(a)))
    def _A_setup():
        B, S, D, H = 1, 2048, 512, 32
        Dh = D // H
        return {
            "x": _w((lambda *s: torch.randn(*s, dtype=torch.bfloat16) * 0.05)(B, S, D)),
            "wqkv": _w((lambda *s: torch.randn(*s, dtype=torch.bfloat16) * 0.2)(D, 3 * D)),
            "w_phi": _w((lambda *s: torch.randn(*s, dtype=torch.bfloat16) * 0.2)(H, Dh, Dh) * (Dh ** -0.5)),
            "wo": _w((lambda *s: torch.randn(*s, dtype=torch.bfloat16) * 0.05)(D, D)),
        }
    _A_in = _A_setup()

    def _B_setup():
        B, S, D, F = 1, 2048, 512, 1792
        return {
            "x":  _w((lambda *s: torch.randn(*s, dtype=torch.bfloat16) * 0.05)(B, S, D)),
            "w1": _w((lambda *s: torch.randn(*s, dtype=torch.bfloat16) * 0.8)(D, D) * (D ** -0.5)),
            "w2": _w((lambda *s: torch.randn(*s, dtype=torch.bfloat16) * 0.8)(D, D) * (D ** -0.5)),
            "w3": _w((lambda *s: torch.randn(*s, dtype=torch.bfloat16) * 0.8)(D, F) * (D ** -0.5)),
            "w4": _w((lambda *s: torch.randn(*s, dtype=torch.bfloat16) * 0.8)(F, D) * (F ** -0.5)),
        }
    _B_in = _B_setup()

    return {
        "A_x": _A_in["x"],
        "A_wqkv": _A_in["wqkv"],
        "A_w_phi": _A_in["w_phi"],
        "A_wo": _A_in["wo"],
        "B_x": _B_in["x"],
        "B_w1": _B_in["w1"],
        "B_w2": _B_in["w2"],
        "B_w3": _B_in["w3"],
        "B_w4": _B_in["w4"],
    }

def reference(A_x, A_wqkv, A_w_phi, A_wo, B_x, B_w1, B_w2, B_w3, B_w4):
    def _A_ref(x, wqkv, w_phi, wo):
        B, S, D = x.shape
        H = 32; Dh = D // H
        qkv = (lambda x, *d: x.permute(*d))((x @ wqkv).reshape(B, S, 3, H, Dh), 2, 0, 3, 1, 4)
        q, k, v = qkv[0], qkv[1], qkv[2]
        pq = torch.einsum("bhsd,hdf->bhsf", q, w_phi)
        pk = torch.einsum("bhsd,hdf->bhsf", k, w_phi)
        phi_q = torch.concatenate([_softmax(pq, axis=-1), _softmax(-pq, axis=-1)], axis=-1)
        phi_k = torch.concatenate([_softmax(pk, axis=-1), _softmax(-pk, axis=-1)], axis=-1)
        kv = torch.einsum("bhsf,bhsd->bhfd", phi_k, v)
        z  = torch.einsum("bhsf->bhf", phi_k)
        num = torch.einsum("bhqf,bhfd->bhqd", phi_q, kv)
        den = torch.einsum("bhqf,bhf->bhq", phi_q, z)[..., None] + 1e-6
        o = num / den
        return (lambda x, *d: x.permute(*d))(o, 0, 2, 1, 3).reshape(B, S, D) @ wo

    def _B_ref(x, w1, w2, w3, w4):
        B, S, D = x.shape
        h = _gelu(_layernorm(x, axis=-1) @ w1)
        c = D // 4
        g0 = _pad(h[:, :, 0*c:1*c], ((0, 0), (1, 0), (0, 0)))[:, :S, :]
        g1 = _pad(h[:, :, 1*c:2*c], ((0, 0), (0, 1), (0, 0)))[:, 1:, :]
        g2 = _pad(h[:, :, 2*c:3*c], ((0, 0), (2, 0), (0, 0)))[:, :S, :]
        g3 = _pad(h[:, :, 3*c:   ], ((0, 0), (0, 2), (0, 0)))[:, 2:, :]
        hs = torch.concatenate([g0, g1, g2, g3], axis=-1) @ w2
        x1 = x + hs
        h2 = _gelu(_layernorm(x1, axis=-1) @ w3) @ w4
        return x1 + h2

    x = A_x
    xn = _layernorm(x, axis=-1)
    s = _A_ref(xn, A_wqkv, A_w_phi, A_wo)
    g = _silu(_B_ref(xn, B_w1, B_w2, B_w3, B_w4))
    return x + s * g
```

```asm
; @launch grid=(256,1,1) block=(256,1,1) lds=163840
.amdgcn_target "amdgcn-amd-amdhsa--gfx950"
.text
.globl recurrent_scan__linear_kernel_hedgehog__mixer_s_mlp__prompt_kernel
.p2align 8
.type recurrent_scan__linear_kernel_hedgehog__mixer_s_mlp__prompt_kernel,@function
recurrent_scan__linear_kernel_hedgehog__mixer_s_mlp__prompt_kernel:
s_cmp_ge_u32 s2, 256
s_cbranch_scc1 L_end
s_load_dwordx2 s[4:5], s[0:1], 0
s_load_dwordx2 s[20:21], s[0:1], 40
s_load_dwordx2 s[8:9], s[0:1], 8
s_load_dwordx2 s[40:41], s[0:1], 88
s_load_dwordx2 s[12:13], s[0:1], 16
s_load_dwordx2 s[24:25], s[0:1], 48
s_load_dwordx2 s[28:29], s[0:1], 56
s_load_dwordx2 s[16:17], s[0:1], 24
s_load_dwordx2 s[32:33], s[0:1], 64
s_load_dwordx2 s[36:37], s[0:1], 72
v_lshrrev_b32 v1, 6, v0
v_and_b32 v0, 63, v0
v_readfirstlane_b32 s48, v1
s_mov_b32 s6, 0x200000
s_mov_b32 s7, 0x20000
s_mov_b32 s22, 0x80000
s_mov_b32 s23, 0x20000
s_mov_b32 s10, 0x180000
s_mov_b32 s11, 0x20000
s_mov_b32 s42, 0x10000000
s_mov_b32 s43, 0x20000
s_mov_b32 s14, 0x4000
s_mov_b32 s15, 0x20000
s_mov_b32 s26, 0x80000
s_mov_b32 s27, 0x20000
s_mov_b32 s30, 0x1c0000
s_mov_b32 s31, 0x20000
s_mov_b32 s18, 0x80000
s_mov_b32 s19, 0x20000
s_mov_b32 s34, 0x1c0000
s_mov_b32 s35, 0x20000
s_mov_b32 s38, 0x200000
s_mov_b32 s39, 0x20000
s_and_b32 s60, s2, 7
s_lshr_b32 s61, s2, 3
s_lshr_b32 s49, s60, 1
s_lshl_b32 s49, s49, 2
s_lshr_b32 s62, s61, 3
s_add_u32 s49, s49, s62
s_and_b32 s51, s61, 7
s_and_b32 s50, s60, 1
s_lshl_b32 s50, s50, 3
s_add_u32 s50, s50, s51
s_add_u32 s53, s49, s50
s_and_b32 s53, s53, 3
s_lshl_b32 s59, s48, 12
s_lshl_b32 s62, s49, 17
s_add_u32 s69, s53, 0
s_and_b32 s69, s69, 3
s_lshl_b32 s65, s69, 8
s_add_u32 s65, s65, s62
s_lshl_b32 s69, s69, 7
s_add_u32 s70, s53, 1
s_and_b32 s70, s70, 3
s_lshl_b32 s66, s70, 8
s_add_u32 s66, s66, s62
s_lshl_b32 s70, s70, 7
s_add_u32 s71, s53, 2
s_and_b32 s71, s71, 3
s_lshl_b32 s67, s71, 8
s_add_u32 s67, s67, s62
s_lshl_b32 s71, s71, 7
s_add_u32 s72, s53, 3
s_and_b32 s72, s72, 3
s_lshl_b32 s68, s72, 8
s_add_u32 s68, s68, s62
s_lshl_b32 s72, s72, 7
v_lshlrev_b32 v1, 4, v0
v_lshlrev_b32 v29, 2, v0
s_lshl_b32 s63, s48, 5
v_lshrrev_b32 v96, 3, v0
v_lshrrev_b32 v97, 4, v0
v_xor_b32 v97, v0, v97
v_and_b32 v97, 7, v97
v_lshlrev_b32 v97, 4, v97
v_add_u32 v96, s63, v96
v_lshl_add_u32 v6, v96, 10, v97
v_xor_b32 v98, 64, v6
v_add_u32 v7, 0x1c00, v98
v_add_u32 v8, 0x3800, v6
v_add_u32 v9, 0x5400, v98
s_lshl_b32 s76, s51, 7
s_cmp_lt_u32 s50, 8
s_cbranch_scc1 Lkv_1
v_lshrrev_b32 v96, 3, v0
v_lshrrev_b32 v97, 2, v0
v_and_b32 v97, 4, v97
v_xor_b32 v97, v0, v97
v_and_b32 v97, 7, v97
v_lshlrev_b32 v97, 4, v97
v_add_u32 v96, s63, v96
v_mul_u32_u24 v96, 0x400, v96
v_add_u32 v2, v96, v97
v_add_u32 v3, 0x1c00, v2
v_add_u32 v4, 0x3800, v2
v_add_u32 v5, 0x5400, v2
v_mov_b32 v25, 0
s_mov_b32 s60, 0x1200000
s_waitcnt lgkmcnt(0)
s_add_u32 m0, s59, 0x8000
s_mul_i32 s64, s69, 1024
s_add_u32 s64, s64, s76
buffer_load_dwordx4 v2, s[20:23], s64 offen offset:0 lds
buffer_load_dwordx4 v3, s[20:23], s64 offen offset:1024 lds
buffer_load_dwordx4 v4, s[20:23], s64 offen offset:2048 lds
buffer_load_dwordx4 v5, s[20:23], s64 offen offset:3072 lds
s_add_u32 m0, s59, 0x0
s_nop 0
buffer_load_dwordx4 v6, s[4:7], s65 offen offset:0 lds
buffer_load_dwordx4 v7, s[4:7], s65 offen offset:1024 lds
buffer_load_dwordx4 v8, s[4:7], s65 offen offset:2048 lds
buffer_load_dwordx4 v9, s[4:7], s65 offen offset:3072 lds
buffer_load_dword v30, v25, s[40:43], s60 offen sc1
s_lshl_b32 s61, s49, 4
s_add_u32 s61, s61, s50
s_lshl_b32 s61, s61, 2
s_add_u32 s61, s61, s48
s_lshl_b32 s60, s61, 11
s_lshl_b32 s73, s61, 5
buffer_load_dwordx4 v[240:243], v1, s[4:7], s60 offen offset:0
buffer_load_dwordx4 v[244:247], v1, s[4:7], s60 offen offset:1024
s_lshr_b32 s60, s2, 3
s_lshl_b32 s60, s60, 2
s_add_u32 s60, s60, s48
s_lshl_b32 s60, s60, 9
v_and_b32 v25, 3, v0
v_lshlrev_b32 v25, 7, v25
v_add_u32 v25, s60, v25
v_min_u32 v25, CODE_BYTES-4, v25
s_getpc_b64 s[62:63]
Lpc_3:
s_sub_u32 s62, s62, Lpc_3-recurrent_scan__linear_kernel_hedgehog__mixer_s_mlp__prompt_kernel
s_subb_u32 s63, s63, 0
global_load_dword v22, v25, s[62:63]
v_and_b32 v96, 31, v0
v_bfe_u32 v97, v0, 1, 3
v_lshrrev_b32 v11, 5, v0
v_xor_b32 v97, v97, v11
v_lshlrev_b32 v97, 4, v97
v_lshl_add_u32 v96, v96, 7, v97
v_add_u32 v10, s59, v96
v_xor_b32 v11, 32, v10
v_xor_b32 v12, 64, v10
v_xor_b32 v13, 96, v10
v_bfe_u32 v96, v0, 2, 2
v_lshrrev_b32 v97, 5, v0
v_mad_u32_u24 v97, v97, 8, v96
v_lshlrev_b32 v14, 7, v97
v_lshrrev_b32 v96, 1, v96
v_lshl_add_u32 v14, v96, 6, v14
v_bfe_u32 v96, v0, 4, 1
v_lshl_add_u32 v14, v96, 5, v14
v_and_b32 v96, 3, v0
v_lshl_add_u32 v14, v96, 3, v14
v_xor_b32 v15, 64, v14
v_bfe_u32 v96, v0, 2, 2
v_lshrrev_b32 v97, 5, v0
v_mad_u32_u24 v97, v97, 4, v96
v_lshlrev_b32 v18, 7, v97
v_lshrrev_b32 v96, 1, v96
v_lshl_add_u32 v18, v96, 6, v18
v_bfe_u32 v96, v0, 4, 1
v_lshl_add_u32 v18, v96, 5, v18
v_and_b32 v96, 3, v0
v_lshl_add_u32 v18, v96, 3, v18
v_xor_b32 v19, 64, v18
v_add_u32 v16, s59, v18
v_add_u32 v17, s59, v19
s_mov_b32 s95, 0x3f803f80
v_accvgpr_write_b32 a252, s95
v_accvgpr_write_b32 a253, s95
v_accvgpr_write_b32 a254, s95
v_accvgpr_write_b32 a255, s95
s_mov_b32 s78, 0x3fb8aa3b
s_mov_b32 s79, 0x3fb8aa3b
s_mov_b32 s80, 0xffff0000
s_mov_b32 s81, 0xffff0000
s_lshr_b32 s57, s48, 1
s_and_b32 s58, s48, 1
s_lshl_b32 s60, s48, 4
s_mov_b64 s[84:85], 0xffff
s_lshl_b64 s[84:85], s[84:85], s60
s_and_b32 s47, s50, 1
s_lshl_b32 s60, s47, 1
s_lshl_b32 s74, s49, 2
s_add_u32 s55, s74, s60
s_add_u32 s55, s55, s58
s_add_u32 s74, s74, s48
s_lshr_b32 s56, s50, 1
s_lshl_b32 s56, s56, 7
s_lshr_b32 s60, s50, 3
s_sub_u32 s75, s50, s60
s_add_u32 s61, s60, 14
s_cmp_lt_u32 s51, 7
s_cselect_b32 s75, s75, s61
s_mul_i32 s60, s60, 7
s_min_u32 s61, s51, 6
s_add_u32 s60, s60, s61
s_lshl_b32 s77, s60, 8
s_lshr_b32 s54, s55, 1
s_mul_i32 s60, s54, 37
s_lshr_b32 s60, s60, 8
s_mul_i32 s60, s60, 7
s_sub_u32 s54, s54, s60
s_lshl_b32 s60, s57, 13
v_bfe_u32 v96, v0, 2, 2
v_lshrrev_b32 v97, 5, v0
v_mad_u32_u24 v97, v97, 4, v96
v_lshlrev_b32 v20, 7, v97
v_lshrrev_b32 v96, 1, v96
v_xor_b32 v96, s57, v96
v_lshl_add_u32 v20, v96, 6, v20
v_bfe_u32 v96, v0, 4, 1
v_lshl_add_u32 v20, v96, 5, v20
v_and_b32 v96, 3, v0
v_lshl_add_u32 v20, v96, 3, v20
v_add_u32 v20, s60, v20
v_xor_b32 v21, 64, v20
v_bfe_u32 v96, v0, 1, 2
s_lshl_b32 s60, s57, 2
v_add_u32 v96, s60, v96
v_and_b32 v97, 2, v96
v_add_u32 v97, -1, v97
v_and_b32 v98, 1, v0
v_mul_i32_i24 v97, v97, v98
v_add_u32 v97, s55, v97
v_and_b32 v97, 63, v97
v_lshl_add_u32 v96, v96, 6, v97
v_lshlrev_b32 v23, 6, v96
s_mov_b32 s96, 0x1100000
s_lshl_b32 s60, s55, 15
s_lshl_b32 s61, s56, 5
s_add_u32 s60, s60, s61
s_lshl_b32 s61, s57, 11
s_add_u32 s60, s60, s61
s_add_u32 s93, s60, 0x200000
s_lshr_b32 s61, s56, 6
s_add_u32 s61, s61, s57
s_lshl_b32 s62, s55, 4
s_add_u32 s62, s62, s61
s_lshl_b32 s60, s62, 8
s_add_u32 s94, s60, 0xd00000
s_lshl_b32 s62, s62, 6
s_add_u32 s99, s62, 0x1110000
s_lshl_b32 s60, s48, 5
v_lshrrev_b32 v96, 3, v0
v_lshrrev_b32 v97, 2, v0
v_and_b32 v97, 4, v97
v_xor_b32 v97, v0, v97
v_and_b32 v97, 7, v97
v_lshlrev_b32 v97, 4, v97
v_add_u32 v96, s60, v96
v_mul_u32_u24 v96, 0xc00, v96
v_add_u32 v98, v96, v97
v_accvgpr_write_b32 a89, v98
v_lshrrev_b32 v96, 3, v0
v_lshrrev_b32 v97, 2, v0
v_and_b32 v97, 4, v97
v_xor_b32 v97, v0, v97
v_and_b32 v97, 7, v97
v_lshlrev_b32 v97, 4, v97
v_add_u32 v96, s60, v96
v_mul_u32_u24 v96, 0xe00, v96
v_add_u32 v98, v96, v97
v_accvgpr_write_b32 a91, v98
s_lshl_b32 s60, s57, 8
s_lshl_b32 s61, s58, 5
s_add_u32 s60, s60, s61
v_lshrrev_b32 v96, 3, v0
v_lshrrev_b32 v97, 2, v0
v_and_b32 v97, 4, v97
v_xor_b32 v97, v0, v97
v_and_b32 v97, 7, v97
v_lshlrev_b32 v97, 4, v97
v_add_u32 v96, s60, v96
v_mul_u32_u24 v96, 0x400, v96
v_add_u32 v98, v96, v97
v_accvgpr_write_b32 a90, v98
s_lshl_b32 s60, s57, 7
v_lshrrev_b32 v96, 3, v0
v_lshrrev_b32 v97, 2, v0
v_and_b32 v97, 4, v97
v_xor_b32 v97, v0, v97
v_and_b32 v97, 7, v97
v_lshlrev_b32 v97, 4, v97
v_add_u32 v96, s60, v96
v_mul_u32_u24 v96, 0x400, v96
v_add_u32 v98, v96, v97
v_accvgpr_write_b32 a242, v98
s_lshl_b32 s60, s55, 15
s_add_u32 s60, s60, s56
s_lshl_b32 s61, s57, 6
s_add_u32 s60, s60, s61
v_and_b32 v96, 31, v0
v_lshrrev_b32 v97, 5, v0
v_lshlrev_b32 v98, 10, v96
v_add_u32 v98, s60, v98
v_lshl_add_u32 v99, v97, 4, v98
v_accvgpr_write_b32 a241, v99
s_lshl_b32 s60, s48, 14
v_subrev_u32 v99, s60, v6
v_accvgpr_write_b32 a94, v99
v_bfe_u32 v99, v0, 1, 3
s_lshl_b32 s60, s57, 2
v_xor_b32 v99, s60, v99
v_lshlrev_b32 v99, 4, v99
v_lshl_add_u32 v99, v97, 3, v99
v_lshl_add_u32 v99, v96, 7, v99
s_lshl_b32 s60, s58, 12
s_add_u32 s60, s60, 0x26000
v_add_u32 v99, s60, v99
v_accvgpr_write_b32 a87, v99
v_lshlrev_b32 v99, 4, v96
v_accvgpr_write_b32 a88, v99
v_bfe_u32 v96, v0, 2, 2
v_lshl_add_u32 v96, v97, 2, v96
v_lshlrev_b32 v96, 5, v96
v_bfe_u32 v98, v0, 4, 1
v_lshl_add_u32 v96, v98, 9, v96
v_and_b32 v98, 3, v0
v_lshl_add_u32 v96, v98, 3, v96
v_add_u32 v96, 0x24000, v96
v_accvgpr_write_b32 a92, v96
v_and_b32 v96, 7, v0
v_min_u32 v96, 6, v96
v_lshlrev_b32 v96, 7, v96
s_lshl_b32 s60, s55, 12
s_lshl_b32 s61, s57, 6
s_add_u32 s60, s60, s61
v_add_u32 v96, s60, v96
v_accvgpr_write_b32 a240, v96
s_mul_i32 s60, s55, 0x1c000
s_lshl_b32 s61, s57, 13
s_add_u32 s60, s60, s61
s_add_u32 s60, s60, 0x600000
v_add_u32 v96, s60, v1
v_accvgpr_write_b32 a93, v96
v_lshrrev_b32 v96, 5, v0
v_and_b32 v97, 0x7c, v29
v_lshl_add_u32 v96, v96, 10, v97
s_bfe_u32 s62, s49, 0x10001
s_lshl_b32 s62, s62, 11
s_and_b32 s60, s49, 1
s_lshl_b32 s60, s60, 9
s_add_u32 s62, s62, s60
s_lshl_b32 s60, s48, 7
s_add_u32 s62, s62, s60
s_lshr_b32 s61, s49, 2
s_lshl_b32 s61, s61, 12
s_add_u32 s62, s62, s61
s_lshl_b32 s61, s51, 18
s_add_u32 s62, s62, s61
s_add_u32 s62, s62, 0x2400000
v_add_u32 v96, s62, v96
v_accvgpr_write_b32 a243, v96
s_lshr_b32 s60, s51, 1
s_lshr_b32 s61, s60, 1
s_add_u32 s61, s61, 1
s_sub_u32 s62, 0, s61
s_bitcmp1_b32 s60, 0
s_cselect_b32 s61, s62, s61
s_lshl_b32 s62, s74, 5
s_add_u32 s61, s61, s62
v_and_b32 v96, 31, v0
v_add_u32 v96, s61, v96
v_cmp_gt_u32 vcc, 0x800, v96
v_and_b32 v96, 0x7ff, v96
v_lshrrev_b32 v97, 5, v96
v_and_b32 v96, 31, v96
v_and_b32 v98, 32, v0
v_add_u32 v96, v96, v98
v_lshlrev_b32 v96, 4, v96
v_lshl_add_u32 v96, v97, 15, v96
v_mov_b32 v97, 0x7ff00000
v_cndmask_b32 v118, v97, v96, vcc
v_cndmask_b32 v119, v96, v97, vcc
s_lshl_b32 s63, s51, 12
v_accvgpr_write_b32 a96, 0
v_accvgpr_write_b32 a97, 0
v_accvgpr_write_b32 a98, 0
v_accvgpr_write_b32 a99, 0
s_lshl_b32 s60, s51, 6
s_add_u32 s60, s60, s74
s_lshl_b32 s60, s60, 6
s_add_u32 s92, s60, 0x1100000
s_add_u32 m0, s59, 0x4000
s_add_u32 s64, s65, 0x80
buffer_load_dwordx4 v6, s[4:7], s64 offen offset:0 lds
buffer_load_dwordx4 v7, s[4:7], s64 offen offset:1024 lds
buffer_load_dwordx4 v8, s[4:7], s64 offen offset:2048 lds
buffer_load_dwordx4 v9, s[4:7], s64 offen offset:3072 lds
s_add_u32 m0, s59, 0x14000
s_mul_i32 s64, s70, 1024
s_add_u32 s64, s64, s76
buffer_load_dwordx4 v2, s[20:23], s64 offen offset:0 lds
buffer_load_dwordx4 v3, s[20:23], s64 offen offset:1024 lds
buffer_load_dwordx4 v4, s[20:23], s64 offen offset:2048 lds
buffer_load_dwordx4 v5, s[20:23], s64 offen offset:3072 lds
s_waitcnt vmcnt(16)
s_barrier
ds_read_b64_tr_b16 v[32:33], v16 offset:32768
ds_read_b64_tr_b16 v[34:35], v16 offset:33792
ds_read_b64_tr_b16 v[36:37], v17 offset:32768
ds_read_b64_tr_b16 v[38:39], v17 offset:33792
ds_read_b64_tr_b16 v[40:41], v16 offset:34816
ds_read_b64_tr_b16 v[42:43], v16 offset:35840
ds_read_b64_tr_b16 v[44:45], v17 offset:34816
ds_read_b64_tr_b16 v[46:47], v17 offset:35840
s_waitcnt vmcnt(12)
ds_read_b128 v[128:131], v10 offset:0
ds_read_b128 v[132:135], v11 offset:0
ds_read_b128 v[136:139], v12 offset:0
ds_read_b128 v[140:143], v13 offset:0
s_waitcnt lgkmcnt(10)
v_mfma_f32_32x32x16_bf16 a[0:15], a[252:255], v[32:35], 0
ds_read_b64_tr_b16 v[48:49], v14 offset:32768
ds_read_b64_tr_b16 v[50:51], v14 offset:33280
s_add_u32 m0, s59, 0xc000
s_nop 0
buffer_load_dwordx4 v6, s[4:7], s66 offen offset:0 lds
s_waitcnt lgkmcnt(10)
v_mfma_f32_32x32x16_bf16 a[16:31], a[252:255], v[36:39], 0
ds_read_b64_tr_b16 v[52:53], v15 offset:32768
ds_read_b64_tr_b16 v[54:55], v15 offset:33280
buffer_load_dwordx4 v7, s[4:7], s66 offen offset:1024 lds
s_waitcnt lgkmcnt(10)
v_mfma_f32_32x32x16_bf16 a[0:15], a[252:255], v[40:43], a[0:15]
ds_read_b64_tr_b16 v[56:57], v14 offset:34816
ds_read_b64_tr_b16 v[58:59], v14 offset:35328
buffer_load_dwordx4 v8, s[4:7], s66 offen offset:2048 lds
s_waitcnt lgkmcnt(10)
v_mfma_f32_32x32x16_bf16 a[16:31], a[252:255], v[44:47], a[16:31]
ds_read_b64_tr_b16 v[60:61], v15 offset:34816
ds_read_b64_tr_b16 v[62:63], v15 offset:35328
s_waitcnt lgkmcnt(8)
s_mov_b32 s60, 1664525
s_waitcnt vmcnt(14)
v_mul_lo_u32 v30, v30, s60
v_add_u32 v30, 1013904223, v30
s_nop 0
v_readfirstlane_b32 s52, v30
v_mov_b32 v100, 0
v_mov_b32 v101, 0
v_mov_b32 v102, 0
v_mov_b32 v103, 0
s_waitcnt vmcnt(13)
v_dot2c_f32_bf16 v100, s95, v240
v_dot2c_f32_bf16 v101, v240, v240
s_waitcnt vmcnt(12)
v_dot2c_f32_bf16 v102, s95, v244
v_dot2c_f32_bf16 v103, v244, v244
v_dot2c_f32_bf16 v100, s95, v241
v_dot2c_f32_bf16 v101, v241, v241
v_dot2c_f32_bf16 v102, s95, v245
v_dot2c_f32_bf16 v103, v245, v245
v_dot2c_f32_bf16 v100, s95, v242
v_dot2c_f32_bf16 v101, v242, v242
v_dot2c_f32_bf16 v102, s95, v246
v_dot2c_f32_bf16 v103, v246, v246
v_dot2c_f32_bf16 v100, s95, v243
v_dot2c_f32_bf16 v101, v243, v243
v_dot2c_f32_bf16 v102, s95, v247
v_dot2c_f32_bf16 v103, v247, v247
s_nop 1
v_permlane32_swap_b32 v100, v102
v_permlane32_swap_b32 v101, v103
v_add_f32 v100, v100, v102
v_add_f32 v101, v101, v103
s_nop 0
v_add_f32_dpp v100, v100, v100 row_ror:8 row_mask:0xf bank_mask:0xf
v_add_f32_dpp v101, v101, v101 row_ror:8 row_mask:0xf bank_mask:0xf
s_nop 0
v_add_f32_dpp v100, v100, v100 row_ror:4 row_mask:0xf bank_mask:0xf
v_add_f32_dpp v101, v101, v101 row_ror:4 row_mask:0xf bank_mask:0xf
s_nop 0
v_add_f32_dpp v100, v100, v100 row_ror:2 row_mask:0xf bank_mask:0xf
v_add_f32_dpp v101, v101, v101 row_ror:2 row_mask:0xf bank_mask:0xf
s_nop 0
v_add_f32_dpp v100, v100, v100 row_ror:1 row_mask:0xf bank_mask:0xf
v_add_f32_dpp v101, v101, v101 row_ror:1 row_mask:0xf bank_mask:0xf
s_nop 1
v_permlane16_swap_b32 v100, v101
v_add_f32 v100, v100, v101
v_mov_b32 v101, v100
s_nop 1
v_permlane16_swap_b32 v100, v101
v_mul_f32 v104, 0xbb000000, v100
v_mul_f32 v101, 0x3b000000, v101
v_fma_f32 v101, -v104, v104, v101
v_max_f32 v101, 0, v101
v_add_f32 v105, 0x3727c5ac, v101
v_rsq_f32 v105, v105
v_mov_b32 v102, 0x3727c5ac
v_mov_b32 v107, v30
v_mul_f32 v100, v105, v105
v_fma_f32 v100, v100, v101, v102
v_rsq_f32 v100, v100
v_lshrrev_b32 v102, 1, v0
s_add_u32 s73, s73, 0xd80000
v_mul_f32 v106, v100, v105
s_mov_b32 exec_lo, 1
s_mov_b32 exec_hi, 1
buffer_store_dwordx4 v[104:107], v102, s[40:43], s73 offen sc1
s_mov_b64 exec, -1
v_and_b32 v25, 0x7c, v29
s_lshl_b32 s60, s48, 9
s_add_u32 s60, s60, 0x24c00
v_add_u32 v25, s60, v25
ds_write_b32 v25, a0 offset:0
ds_write_b32 v25, a16 offset:128
s_waitcnt lgkmcnt(8)
v_mfma_f32_32x32x16_bf16 v[64:79], v[48:51], v[128:131], 0
ds_read_b64_tr_b16 v[32:33], v14 offset:36864
ds_read_b64_tr_b16 v[34:35], v14 offset:37376
buffer_load_dwordx4 v9, s[4:7], s66 offen offset:3072 lds
s_waitcnt lgkmcnt(8)
v_mfma_f32_32x32x16_bf16 v[80:95], v[52:55], v[128:131], 0
ds_read_b64_tr_b16 v[36:37], v15 offset:36864
ds_read_b64_tr_b16 v[38:39], v15 offset:37376
s_add_u32 m0, s59, 0x10000
s_add_u32 s64, s66, 0x80
buffer_load_dwordx4 v6, s[4:7], s64 offen offset:0 lds
s_waitcnt lgkmcnt(8)
v_mfma_f32_32x32x16_bf16 v[64:79], v[56:59], v[132:135], v[64:79]
ds_read_b64_tr_b16 v[40:41], v14 offset:38912
ds_read_b64_tr_b16 v[42:43], v14 offset:39424
buffer_load_dwordx4 v7, s[4:7], s64 offen offset:1024 lds
s_waitcnt vmcnt(11)
ds_read_b128 v[144:147], v10 offset:16384
ds_read_b128 v[148:151], v11 offset:16384
ds_read_b128 v[152:155], v12 offset:16384
ds_read_b128 v[156:159], v13 offset:16384
s_waitcnt lgkmcnt(12)
v_mfma_f32_32x32x16_bf16 v[80:95], v[60:63], v[132:135], v[80:95]
ds_read_b64_tr_b16 v[44:45], v15 offset:38912
ds_read_b64_tr_b16 v[46:47], v15 offset:39424
buffer_load_dwordx4 v8, s[4:7], s64 offen offset:2048 lds
s_waitcnt lgkmcnt(10)
v_mfma_f32_32x32x16_bf16 v[64:79], v[32:35], v[136:139], v[64:79]
ds_read_b64_tr_b16 v[48:49], v14 offset:40960
ds_read_b64_tr_b16 v[50:51], v14 offset:41472
s_waitcnt lgkmcnt(10)
v_mfma_f32_32x32x16_bf16 v[80:95], v[36:39], v[136:139], v[80:95]
ds_read_b64_tr_b16 v[52:53], v15 offset:40960
ds_read_b64_tr_b16 v[54:55], v15 offset:41472
buffer_load_dwordx4 v9, s[4:7], s64 offen offset:3072 lds
s_waitcnt lgkmcnt(10)
v_mfma_f32_32x32x16_bf16 v[64:79], v[40:43], v[140:143], v[64:79]
ds_read_b64_tr_b16 v[56:57], v14 offset:43008
ds_read_b64_tr_b16 v[58:59], v14 offset:43520
s_add_u32 m0, s59, 0x20000
s_mul_i32 s64, s71, 1024
s_add_u32 s64, s64, s76
buffer_load_dwordx4 v2, s[20:23], s64 offen offset:0 lds
s_waitcnt lgkmcnt(6)
v_mfma_f32_32x32x16_bf16 v[80:95], v[44:47], v[140:143], v[80:95]
ds_read_b64_tr_b16 v[60:61], v15 offset:43008
ds_read_b64_tr_b16 v[62:63], v15 offset:43520
buffer_load_dwordx4 v3, s[20:23], s64 offen offset:1024 lds
s_waitcnt lgkmcnt(6)
v_mfma_f32_32x32x16_bf16 v[64:79], v[48:51], v[144:147], v[64:79]
ds_read_b64_tr_b16 v[32:33], v14 offset:45056
ds_read_b64_tr_b16 v[34:35], v14 offset:45568
buffer_load_dwordx4 v4, s[20:23], s64 offen offset:2048 lds
s_waitcnt lgkmcnt(6)
v_mfma_f32_32x32x16_bf16 v[80:95], v[52:55], v[144:147], v[80:95]
ds_read_b64_tr_b16 v[36:37], v15 offset:45056
ds_read_b64_tr_b16 v[38:39], v15 offset:45568
s_waitcnt lgkmcnt(6)
v_mfma_f32_32x32x16_bf16 v[64:79], v[56:59], v[148:151], v[64:79]
ds_read_b64_tr_b16 v[40:41], v14 offset:47104
ds_read_b64_tr_b16 v[42:43], v14 offset:47616
buffer_load_dwordx4 v5, s[20:23], s64 offen offset:3072 lds
s_waitcnt vmcnt(13)
s_barrier
s_waitcnt vmcnt(8)
ds_read_b128 v[160:163], v10 offset:49152
ds_read_b128 v[164:167], v11 offset:49152
ds_read_b128 v[168:171], v12 offset:49152
ds_read_b128 v[172:175], v13 offset:49152
s_waitcnt lgkmcnt(10)
v_mfma_f32_32x32x16_bf16 v[80:95], v[60:63], v[148:151], v[80:95]
ds_read_b64_tr_b16 v[44:45], v15 offset:47104
ds_read_b64_tr_b16 v[46:47], v15 offset:47616
s_add_u32 m0, s59, 0x18000
s_nop 0
buffer_load_dwordx4 v6, s[4:7], s67 offen offset:0 lds
s_waitcnt lgkmcnt(10)
v_mfma_f32_32x32x16_bf16 v[64:79], v[32:35], v[152:155], v[64:79]
v_add_u32 v14, 0x14000, v14
ds_read_b64_tr_b16 v[48:49], v14 offset:0
ds_read_b64_tr_b16 v[50:51], v14 offset:512
buffer_load_dwordx4 v7, s[4:7], s67 offen offset:1024 lds
v_add_u32 v25, 0x24c00, v29
ds_read2st64_b32 v[108:109], v25 offset0:0 offset1:2
s_waitcnt lgkmcnt(11)
v_mfma_f32_32x32x16_bf16 v[80:95], v[36:39], v[152:155], v[80:95]
v_add_u32 v15, 0x14000, v15
ds_read_b64_tr_b16 v[52:53], v15 offset:0
ds_read_b64_tr_b16 v[54:55], v15 offset:512
buffer_load_dwordx4 v8, s[4:7], s67 offen offset:2048 lds
ds_read2st64_b32 v[110:111], v25 offset0:4 offset1:6
s_waitcnt lgkmcnt(12)
v_mfma_f32_32x32x16_bf16 v[64:79], v[40:43], v[156:159], v[64:79]
ds_read_b64_tr_b16 v[56:57], v14 offset:2048
ds_read_b64_tr_b16 v[58:59], v14 offset:2560
s_waitcnt lgkmcnt(8)
v_mfma_f32_32x32x16_bf16 v[80:95], v[44:47], v[156:159], v[80:95]
ds_read_b64_tr_b16 v[60:61], v15 offset:2048
ds_read_b64_tr_b16 v[62:63], v15 offset:2560
buffer_load_dwordx4 v9, s[4:7], s67 offen offset:3072 lds
s_waitcnt lgkmcnt(8)
v_mfma_f32_32x32x16_bf16 v[64:79], v[48:51], v[160:163], v[64:79]
ds_read_b64_tr_b16 v[32:33], v14 offset:4096
ds_read_b64_tr_b16 v[34:35], v14 offset:4608
s_add_u32 m0, s59, 0x1c000
s_add_u32 s64, s67, 0x80
buffer_load_dwordx4 v6, s[4:7], s64 offen offset:0 lds
s_waitcnt lgkmcnt(7)
v_mfma_f32_32x32x16_bf16 v[80:95], v[52:55], v[160:163], v[80:95]
ds_read_b64_tr_b16 v[36:37], v15 offset:4096
ds_read_b64_tr_b16 v[38:39], v15 offset:4608
buffer_load_dwordx4 v7, s[4:7], s64 offen offset:1024 lds
v_lshlrev_b32 v25, 3, v0
v_add_f32 v108, v108, v109
s_waitcnt lgkmcnt(6)
v_mfma_f32_32x32x16_bf16 v[64:79], v[56:59], v[164:167], v[64:79]
ds_read_b64_tr_b16 v[40:41], v14 offset:6144
ds_read_b64_tr_b16 v[42:43], v14 offset:6656
buffer_load_dwordx4 v8, s[4:7], s64 offen offset:2048 lds
v_add_f32 v110, v110, v111
v_mov_b32 v109, v30
s_waitcnt vmcnt(11)
v_add_u32 v10, 0x10000, v10
ds_read_b128 v[176:179], v10 offset:0
v_add_u32 v11, 0x10000, v11
ds_read_b128 v[180:183], v11 offset:0
v_add_u32 v12, 0x10000, v12
ds_read_b128 v[184:187], v12 offset:0
v_add_u32 v13, 0x10000, v13
ds_read_b128 v[188:191], v13 offset:0
s_waitcnt lgkmcnt(10)
v_mfma_f32_32x32x16_bf16 v[80:95], v[60:63], v[164:167], v[80:95]
ds_read_b64_tr_b16 v[44:45], v15 offset:6144
ds_read_b64_tr_b16 v[46:47], v15 offset:6656
v_add_f32 v108, v108, v110
s_lshl_b32 s60, s49, 4
s_add_u32 s60, s60, s50
s_lshl_b32 s60, s60, 10
s_add_u32 s60, s60, 0xda0000
s_mov_b64 exec, s[84:85]
buffer_store_dwordx2 v[108:109], v25, s[40:43], s60 offen offset:0 sc1
s_mov_b64 exec, -1
s_waitcnt lgkmcnt(10)
v_mfma_f32_32x32x16_bf16 v[64:79], v[32:35], v[168:171], v[64:79]
ds_read_b64_tr_b16 v[48:49], v14 offset:8192
ds_read_b64_tr_b16 v[50:51], v14 offset:8704
buffer_load_dwordx4 v9, s[4:7], s64 offen offset:3072 lds
s_waitcnt lgkmcnt(10)
v_mfma_f32_32x32x16_bf16 v[80:95], v[36:39], v[168:171], v[80:95]
ds_read_b64_tr_b16 v[52:53], v15 offset:8192
ds_read_b64_tr_b16 v[54:55], v15 offset:8704
s_add_u32 m0, s59, 0x0
s_mul_i32 s64, s72, 1024
s_add_u32 s64, s64, s76
buffer_load_dwordx4 v2, s[20:23], s64 offen offset:0 lds
s_waitcnt lgkmcnt(10)
v_mfma_f32_32x32x16_bf16 v[64:79], v[40:43], v[172:175], v[64:79]
ds_read_b64_tr_b16 v[56:57], v14 offset:10240
ds_read_b64_tr_b16 v[58:59], v14 offset:10752
buffer_load_dwordx4 v3, s[20:23], s64 offen offset:1024 lds
s_waitcnt lgkmcnt(6)
v_mfma_f32_32x32x16_bf16 v[80:95], v[44:47], v[172:175], v[80:95]
ds_read_b64_tr_b16 v[60:61], v15 offset:10240
ds_read_b64_tr_b16 v[62:63], v15 offset:10752
buffer_load_dwordx4 v4, s[20:23], s64 offen offset:2048 lds
s_waitcnt lgkmcnt(6)
v_mfma_f32_32x32x16_bf16 v[64:79], v[48:51], v[176:179], v[64:79]
ds_read_b64_tr_b16 v[32:33], v14 offset:12288
ds_read_b64_tr_b16 v[34:35], v14 offset:12800
s_waitcnt lgkmcnt(6)
v_mfma_f32_32x32x16_bf16 v[80:95], v[52:55], v[176:179], v[80:95]
ds_read_b64_tr_b16 v[36:37], v15 offset:12288
ds_read_b64_tr_b16 v[38:39], v15 offset:12800
buffer_load_dwordx4 v5, s[20:23], s64 offen offset:3072 lds
s_waitcnt lgkmcnt(6)
v_mfma_f32_32x32x16_bf16 v[64:79], v[56:59], v[180:183], v[64:79]
ds_read_b64_tr_b16 v[40:41], v14 offset:14336
ds_read_b64_tr_b16 v[42:43], v14 offset:14848
s_add_u32 m0, s59, 0x4000
s_nop 0
buffer_load_dwordx4 v6, s[4:7], s68 offen offset:0 lds
s_waitcnt vmcnt(14)
s_barrier
s_waitcnt vmcnt(10)
ds_read_b128 v[192:195], v10 offset:32768
ds_read_b128 v[196:199], v11 offset:32768
ds_read_b128 v[200:203], v12 offset:32768
ds_read_b128 v[204:207], v13 offset:32768
s_waitcnt lgkmcnt(10)
v_mfma_f32_32x32x16_bf16 v[80:95], v[60:63], v[180:183], v[80:95]
ds_read_b64_tr_b16 v[44:45], v15 offset:14336
ds_read_b64_tr_b16 v[46:47], v15 offset:14848
buffer_load_dwordx4 v7, s[4:7], s68 offen offset:1024 lds
s_waitcnt lgkmcnt(10)
v_mfma_f32_32x32x16_bf16 v[64:79], v[32:35], v[184:187], v[64:79]
ds_read_b64_tr_b16 v[48:49], v14 offset:49152
ds_read_b64_tr_b16 v[50:51], v14 offset:49664
buffer_load_dwordx4 v8, s[4:7], s68 offen offset:2048 lds
s_waitcnt lgkmcnt(10)
v_mfma_f32_32x32x16_bf16 v[80:95], v[36:39], v[184:187], v[80:95]
ds_read_b64_tr_b16 v[52:53], v15 offset:49152
ds_read_b64_tr_b16 v[54:55], v15 offset:49664
s_waitcnt lgkmcnt(10)
v_mfma_f32_32x32x16_bf16 v[64:79], v[40:43], v[188:191], v[64:79]
ds_read_b64_tr_b16 v[56:57], v14 offset:51200
ds_read_b64_tr_b16 v[58:59], v14 offset:51712
buffer_load_dwordx4 v9, s[4:7], s68 offen offset:3072 lds
s_waitcnt lgkmcnt(6)
v_mfma_f32_32x32x16_bf16 v[80:95], v[44:47], v[188:191], v[80:95]
ds_read_b64_tr_b16 v[60:61], v15 offset:51200
ds_read_b64_tr_b16 v[62:63], v15 offset:51712
s_add_u32 m0, s59, 0xc000
s_add_u32 s64, s68, 0x80
buffer_load_dwordx4 v6, s[4:7], s64 offen offset:0 lds
s_waitcnt lgkmcnt(6)
v_mfma_f32_32x32x16_bf16 v[64:79], v[48:51], v[192:195], v[64:79]
ds_read_b64_tr_b16 v[32:33], v14 offset:53248
ds_read_b64_tr_b16 v[34:35], v14 offset:53760
buffer_load_dwordx4 v7, s[4:7], s64 offen offset:1024 lds
s_waitcnt lgkmcnt(6)
v_mfma_f32_32x32x16_bf16 v[80:95], v[52:55], v[192:195], v[80:95]
ds_read_b64_tr_b16 v[36:37], v15 offset:53248
ds_read_b64_tr_b16 v[38:39], v15 offset:53760
buffer_load_dwordx4 v8, s[4:7], s64 offen offset:2048 lds
s_waitcnt lgkmcnt(6)
v_mfma_f32_32x32x16_bf16 v[64:79], v[56:59], v[196:199], v[64:79]
ds_read_b64_tr_b16 v[40:41], v14 offset:55296
ds_read_b64_tr_b16 v[42:43], v14 offset:55808
s_waitcnt vmcnt(11)
ds_read_b128 v[208:211], v10 offset:49152
ds_read_b128 v[212:215], v11 offset:49152
ds_read_b128 v[216:219], v12 offset:49152
ds_read_b128 v[220:223], v13 offset:49152
s_waitcnt lgkmcnt(10)
v_mfma_f32_32x32x16_bf16 v[80:95], v[60:63], v[196:199], v[80:95]
ds_read_b64_tr_b16 v[44:45], v15 offset:55296
ds_read_b64_tr_b16 v[46:47], v15 offset:55808
buffer_load_dwordx4 v9, s[4:7], s64 offen offset:3072 lds
s_waitcnt lgkmcnt(10)
v_mfma_f32_32x32x16_bf16 v[64:79], v[32:35], v[200:203], v[64:79]
ds_read_b64_tr_b16 v[48:49], v14 offset:57344
ds_read_b64_tr_b16 v[50:51], v14 offset:57856
s_lshl_b32 s88, s58, 10
s_add_u32 m0, s88, 0x24000
s_lshl_b32 s64, s51, 11
s_add_u32 s64, s64, s88
buffer_load_dwordx4 v1, s[12:15], s64 offen lds
s_waitcnt lgkmcnt(10)
v_mfma_f32_32x32x16_bf16 v[80:95], v[36:39], v[200:203], v[80:95]
ds_read_b64_tr_b16 v[52:53], v15 offset:57344
ds_read_b64_tr_b16 v[54:55], v15 offset:57856
v_accvgpr_read_b32 v2, a89
v_add_u32 v3, 0x5c00, v2
v_add_u32 v4, 0xb800, v2
v_add_u32 v5, 0x11400, v2
s_waitcnt lgkmcnt(10)
v_mfma_f32_32x32x16_bf16 v[64:79], v[40:43], v[204:207], v[64:79]
ds_read_b64_tr_b16 v[56:57], v14 offset:59392
ds_read_b64_tr_b16 v[58:59], v14 offset:59904
v_accvgpr_read_b32 v126, a94
s_lshl_b32 s88, s48, 11
s_add_u32 m0, s88, 0x26000
s_lshr_b32 s64, s55, 1
s_lshl_b32 s64, s64, 16
s_add_u32 s64, s64, s56
buffer_load_dwordx4 v126, s[4:7], s64 offen offset:0 lds
v_accvgpr_read_b32 v28, a88
s_lshl_b32 s62, s74, 9
s_add_u32 s62, s62, 0xd80000
buffer_load_dwordx4 v[112:115], v28, s[40:43], s62 offen sc1
s_waitcnt lgkmcnt(6)
v_mfma_f32_32x32x16_bf16 v[80:95], v[44:47], v[204:207], v[80:95]
ds_read_b64_tr_b16 v[60:61], v15 offset:59392
ds_read_b64_tr_b16 v[62:63], v15 offset:59904
s_waitcnt lgkmcnt(6)
v_mfma_f32_32x32x16_bf16 v[64:79], v[48:51], v[208:211], v[64:79]
ds_read_b64_tr_b16 v[32:33], v14 offset:61440
ds_read_b64_tr_b16 v[34:35], v14 offset:61952
v_xor_b32 v126, 64, v126
v_add_u32 v126, 0x1c00, v126
buffer_load_dwordx4 v126, s[4:7], s64 offen offset:1024 lds
v_lshlrev_b32 v22, 3, v0
s_and_b32 s97, s49, 12
s_lshl_b32 s97, s97, 4
s_add_u32 s97, s97, s50
s_lshl_b32 s97, s97, 10
s_add_u32 s97, s97, 0xda0000
s_add_u32 s98, s97, 0x4000
s_add_u32 s100, s97, 0x8000
s_add_u32 s101, s97, 0xc000
buffer_load_dwordx2 v[96:97], v22, s[40:43], s97 offen offset:0 sc1
buffer_load_dwordx2 v[98:99], v22, s[40:43], s98 offen offset:0 sc1
buffer_load_dwordx2 v[100:101], v22, s[40:43], s100 offen offset:0 sc1
buffer_load_dwordx2 v[102:103], v22, s[40:43], s101 offen offset:0 sc1
s_waitcnt lgkmcnt(6)
v_mfma_f32_32x32x16_bf16 v[80:95], v[52:55], v[208:211], v[80:95]
ds_read_b64_tr_b16 v[36:37], v15 offset:61440
ds_read_b64_tr_b16 v[38:39], v15 offset:61952
s_add_u32 s88, s74, 1
s_and_b32 s88, s88, 62
s_cmp_lg_u32 s88, 0
s_cbranch_scc1 Lhit_4
buffer_store_dwordx4 a[96:99], v119, s[40:43], s63 offen offset:0 sc1
buffer_store_dwordx4 a[96:99], v119, s[40:43], s63 offen offset:1024 sc1
buffer_store_dwordx4 a[96:99], v119, s[40:43], s63 offen offset:2048 sc1
buffer_store_dwordx4 a[96:99], v119, s[40:43], s63 offen offset:3072 sc1
Lhit_4:
s_waitcnt lgkmcnt(6)
v_mfma_f32_32x32x16_bf16 v[64:79], v[56:59], v[212:215], v[64:79]
ds_read_b64_tr_b16 v[40:41], v14 offset:63488
ds_read_b64_tr_b16 v[42:43], v14 offset:64000
s_add_u32 m0, s59, 0x10000
s_mul_i32 s64, s69, 3072
s_add_u32 s64, s64, s76
buffer_load_dwordx4 v2, s[8:11], s64 offen offset:0 lds
s_waitcnt vmcnt(8)
s_barrier
v_add_u32 v10, 0xffff4000, v10
ds_read_b128 v[224:227], v10 offset:0
v_add_u32 v11, 0xffff4000, v11
ds_read_b128 v[228:231], v11 offset:0
v_add_u32 v12, 0xffff4000, v12
ds_read_b128 v[232:235], v12 offset:0
v_add_u32 v13, 0xffff4000, v13
ds_read_b128 v[236:239], v13 offset:0
s_waitcnt lgkmcnt(10)
v_mfma_f32_32x32x16_bf16 v[80:95], v[60:63], v[212:215], v[80:95]
ds_read_b64_tr_b16 v[44:45], v15 offset:63488
ds_read_b64_tr_b16 v[46:47], v15 offset:64000
buffer_load_dwordx4 v3, s[8:11], s64 offen offset:1024 lds
s_waitcnt lgkmcnt(10)
v_mfma_f32_32x32x16_bf16 v[64:79], v[32:35], v[216:219], v[64:79]
v_add_u32 v14, 0xfffec000, v14
ds_read_b64_tr_b16 v[48:49], v14 offset:0
ds_read_b64_tr_b16 v[50:51], v14 offset:512
s_waitcnt lgkmcnt(10)
v_mfma_f32_32x32x16_bf16 v[80:95], v[36:39], v[216:219], v[80:95]
v_add_u32 v15, 0xfffec000, v15
ds_read_b64_tr_b16 v[52:53], v15 offset:0
ds_read_b64_tr_b16 v[54:55], v15 offset:512
buffer_load_dwordx4 v4, s[8:11], s64 offen offset:2048 lds
s_waitcnt lgkmcnt(10)
v_mfma_f32_32x32x16_bf16 v[64:79], v[40:43], v[220:223], v[64:79]
ds_read_b64_tr_b16 v[56:57], v14 offset:2048
ds_read_b64_tr_b16 v[58:59], v14 offset:2560
buffer_load_dwordx4 v5, s[8:11], s64 offen offset:3072 lds
s_waitcnt lgkmcnt(6)
v_mfma_f32_32x32x16_bf16 v[80:95], v[44:47], v[220:223], v[80:95]
ds_read_b64_tr_b16 v[60:61], v15 offset:2048
ds_read_b64_tr_b16 v[62:63], v15 offset:2560
s_add_u32 m0, s59, 0x8000
s_mul_i32 s64, s70, 3072
s_add_u32 s64, s64, s76
buffer_load_dwordx4 v2, s[8:11], s64 offen offset:0 lds
s_waitcnt lgkmcnt(6)
v_mfma_f32_32x32x16_bf16 v[64:79], v[48:51], v[224:227], v[64:79]
ds_read_b64_tr_b16 v[32:33], v14 offset:4096
ds_read_b64_tr_b16 v[34:35], v14 offset:4608
buffer_load_dwordx4 v3, s[8:11], s64 offen offset:1024 lds
s_waitcnt lgkmcnt(6)
v_mfma_f32_32x32x16_bf16 v[80:95], v[52:55], v[224:227], v[80:95]
ds_read_b64_tr_b16 v[36:37], v15 offset:4096
ds_read_b64_tr_b16 v[38:39], v15 offset:4608
s_waitcnt lgkmcnt(6)
v_mfma_f32_32x32x16_bf16 v[64:79], v[56:59], v[228:231], v[64:79]
ds_read_b64_tr_b16 v[40:41], v14 offset:6144
ds_read_b64_tr_b16 v[42:43], v14 offset:6656
buffer_load_dwordx4 v4, s[8:11], s64 offen offset:2048 lds
ds_read_b128 v[240:243], v10 offset:32768
ds_read_b128 v[244:247], v11 offset:32768
ds_read_b128 v[248:251], v12 offset:32768
ds_read_b128 v[252:255], v13 offset:32768
s_waitcnt lgkmcnt(10)
v_mfma_f32_32x32x16_bf16 v[80:95], v[60:63], v[228:231], v[80:95]
ds_read_b64_tr_b16 v[44:45], v15 offset:6144
ds_read_b64_tr_b16 v[46:47], v15 offset:6656
buffer_load_dwordx4 v5, s[8:11], s64 offen offset:3072 lds
s_waitcnt lgkmcnt(10)
v_mfma_f32_32x32x16_bf16 v[64:79], v[32:35], v[232:235], v[64:79]
ds_read_b64_tr_b16 v[48:49], v14 offset:8192
ds_read_b64_tr_b16 v[50:51], v14 offset:8704
s_add_u32 m0, s59, 0x18000
s_mul_i32 s64, s71, 3072
s_add_u32 s64, s64, s76
buffer_load_dwordx4 v2, s[8:11], s64 offen offset:0 lds
s_waitcnt lgkmcnt(10)
v_mfma_f32_32x32x16_bf16 v[80:95], v[36:39], v[232:235], v[80:95]
ds_read_b64_tr_b16 v[52:53], v15 offset:8192
ds_read_b64_tr_b16 v[54:55], v15 offset:8704
buffer_load_dwordx4 v3, s[8:11], s64 offen offset:1024 lds
s_waitcnt lgkmcnt(10)
v_mfma_f32_32x32x16_bf16 v[64:79], v[40:43], v[236:239], v[64:79]
ds_read_b64_tr_b16 v[56:57], v14 offset:10240
ds_read_b64_tr_b16 v[58:59], v14 offset:10752
s_waitcnt lgkmcnt(6)
v_mfma_f32_32x32x16_bf16 v[80:95], v[44:47], v[236:239], v[80:95]
ds_read_b64_tr_b16 v[60:61], v15 offset:10240
ds_read_b64_tr_b16 v[62:63], v15 offset:10752
buffer_load_dwordx4 v4, s[8:11], s64 offen offset:2048 lds
s_waitcnt lgkmcnt(6)
v_mfma_f32_32x32x16_bf16 v[64:79], v[48:51], v[240:243], v[64:79]
ds_read_b64_tr_b16 v[32:33], v14 offset:12288
ds_read_b64_tr_b16 v[34:35], v14 offset:12800
buffer_load_dwordx4 v5, s[8:11], s64 offen offset:3072 lds
s_waitcnt vmcnt(15)
v_xor_b32 v104, s52, v97
s_waitcnt vmcnt(14)
v_xor_b32 v105, s52, v99
v_or_b32 v104, v104, v105
s_waitcnt vmcnt(13)
v_xor_b32 v105, s52, v101
v_or_b32 v104, v104, v105
s_waitcnt vmcnt(12)
v_xor_b32 v105, s52, v103
v_or_b32 v104, v104, v105
v_cmp_ne_u32 vcc, 0, v104
s_nop 4
s_cbranch_vccz Lok_5
s_mov_b32 s73, 0x8000
Lpoll_6:
buffer_load_dwordx2 v[96:97], v22, s[40:43], s97 offen offset:0 sc1
buffer_load_dwordx2 v[98:99], v22, s[40:43], s98 offen offset:0 sc1
buffer_load_dwordx2 v[100:101], v22, s[40:43], s100 offen offset:0 sc1
buffer_load_dwordx2 v[102:103], v22, s[40:43], s101 offen offset:0 sc1
s_waitcnt vmcnt(0)
s_sub_u32 s73, s73, 1
s_cbranch_scc1 Lok_5
v_xor_b32 v104, s52, v97
v_xor_b32 v105, s52, v99
v_or_b32 v104, v104, v105
v_xor_b32 v105, s52, v101
v_or_b32 v104, v104, v105
v_xor_b32 v105, s52, v103
v_or_b32 v104, v104, v105
v_cmp_ne_u32 vcc, 0, v104
s_nop 4
s_cbranch_vccnz Lpoll_6
Lok_5:
s_lshl_b32 s60, s48, 9
s_add_u32 s60, s60, 0x25400
v_add_u32 v22, s60, v29
v_add_f32 v96, v96, v98
v_add_f32 v100, v100, v102
v_lshrrev_b32 v25, 5, v0
v_add_f32 v96, v96, v100
ds_write_b32 v22, v96 offset:0
v_lshl_add_u32 v25, v25, 4, s60
s_waitcnt lgkmcnt(7)
v_mfma_f32_32x32x16_bf16 v[80:95], v[52:55], v[240:243], v[80:95]
ds_read_b64_tr_b16 v[36:37], v15 offset:12288
ds_read_b64_tr_b16 v[38:39], v15 offset:12800
s_add_u32 m0, s59, 0x1c000
s_mul_i32 s64, s72, 3072
s_add_u32 s64, s64, s76
buffer_load_dwordx4 v2, s[8:11], s64 offen offset:0 lds
ds_read_b128 v[96:99], v25 offset:0
ds_read_b128 v[100:103], v25 offset:32
s_waitcnt lgkmcnt(9)
v_mfma_f32_32x32x16_bf16 v[64:79], v[56:59], v[244:247], v[64:79]
ds_read_b64_tr_b16 v[40:41], v14 offset:14336
ds_read_b64_tr_b16 v[42:43], v14 offset:14848
ds_read_b128 v[104:107], v25 offset:64
ds_read_b128 v[108:111], v25 offset:96
s_waitcnt lgkmcnt(11)
v_mfma_f32_32x32x16_bf16 v[80:95], v[60:63], v[244:247], v[80:95]
ds_read_b64_tr_b16 v[44:45], v15 offset:14336
ds_read_b64_tr_b16 v[46:47], v15 offset:14848
v_cmp_ne_u32 vcc, s52, v115
s_nop 4
s_cbranch_vccz Lok_7
s_mov_b32 s73, 0x8000
Lpoll_8:
buffer_load_dwordx4 v[112:115], v28, s[40:43], s62 offen sc1
s_sub_u32 s73, s73, 1
s_waitcnt vmcnt(0)
s_cbranch_scc1 Lok_7
v_cmp_ne_u32 vcc, s52, v115
s_nop 4
s_cbranch_vccnz Lpoll_8
Lok_7:
v_mov_b32 v26, v112
s_waitcnt lgkmcnt(11)
v_mfma_f32_32x32x16_bf16 v[64:79], v[32:35], v[248:251], v[64:79]
v_mov_b32 v27, v113
v_mul_f32 v124, 0xc0135761, v114
s_waitcnt lgkmcnt(8)
v_mfma_f32_32x32x16_bf16 v[80:95], v[36:39], v[248:251], v[80:95]
v_mul_f32 v125, v114, v114
s_waitcnt lgkmcnt(4)
v_mfma_f32_32x32x16_bf16 v[64:79], v[40:43], v[252:255], v[64:79]
v_mul_f32 v125, v125, v114
v_mul_f32 v125, 0xbdd2d3e8, v125
s_waitcnt lgkmcnt(0)
v_mfma_f32_32x32x16_bf16 v[80:95], v[44:47], v[252:255], v[80:95]
v_rcp_f32 v122, v114
s_nop 6
v_pk_fma_f32 v[64:65], v[96:97], v[26:27], v[64:65] op_sel_hi:[1,0,1]
v_pk_fma_f32 v[66:67], v[98:99], v[26:27], v[66:67] op_sel_hi:[1,0,1]
v_pk_fma_f32 v[68:69], v[100:101], v[26:27], v[68:69] op_sel_hi:[1,0,1]
v_pk_fma_f32 v[70:71], v[102:103], v[26:27], v[70:71] op_sel_hi:[1,0,1]
v_pk_fma_f32 v[72:73], v[104:105], v[26:27], v[72:73] op_sel_hi:[1,0,1]
v_pk_fma_f32 v[74:75], v[106:107], v[26:27], v[74:75] op_sel_hi:[1,0,1]
v_pk_fma_f32 v[76:77], v[108:109], v[26:27], v[76:77] op_sel_hi:[1,0,1]
v_pk_fma_f32 v[78:79], v[110:111], v[26:27], v[78:79] op_sel_hi:[1,0,1]
ds_read_b128 v[96:99], v25 offset:128
ds_read_b128 v[100:103], v25 offset:160
ds_read_b128 v[104:107], v25 offset:192
ds_read_b128 v[108:111], v25 offset:224
v_pk_mul_f32 v[48:49], v[64:65], v[64:65]
v_pk_mul_f32 v[50:51], v[66:67], v[66:67]
v_pk_mul_f32 v[52:53], v[68:69], v[68:69]
v_pk_mul_f32 v[54:55], v[70:71], v[70:71]
v_pk_mul_f32 v[56:57], v[72:73], v[72:73]
buffer_load_dwordx4 v3, s[8:11], s64 offen offset:1024 lds
v_pk_mul_f32 v[58:59], v[74:75], v[74:75]
v_pk_mul_f32 v[60:61], v[76:77], v[76:77]
v_pk_mul_f32 v[62:63], v[78:79], v[78:79]
v_pk_fma_f32 v[48:49], v[48:49], v[124:125], v[124:125] op_sel:[0,1,0] op_sel_hi:[1,1,0]
v_pk_fma_f32 v[50:51], v[50:51], v[124:125], v[124:125] op_sel:[0,1,0] op_sel_hi:[1,1,0]
buffer_load_dwordx4 v4, s[8:11], s64 offen offset:2048 lds
v_pk_fma_f32 v[52:53], v[52:53], v[124:125], v[124:125] op_sel:[0,1,0] op_sel_hi:[1,1,0]
v_pk_fma_f32 v[54:55], v[54:55], v[124:125], v[124:125] op_sel:[0,1,0] op_sel_hi:[1,1,0]
v_pk_fma_f32 v[56:57], v[56:57], v[124:125], v[124:125] op_sel:[0,1,0] op_sel_hi:[1,1,0]
v_pk_fma_f32 v[58:59], v[58:59], v[124:125], v[124:125] op_sel:[0,1,0] op_sel_hi:[1,1,0]
v_pk_fma_f32 v[60:61], v[60:61], v[124:125], v[124:125] op_sel:[0,1,0] op_sel_hi:[1,1,0]
buffer_load_dwordx4 v5, s[8:11], s64 offen offset:3072 lds
v_pk_fma_f32 v[62:63], v[62:63], v[124:125], v[124:125] op_sel:[0,1,0] op_sel_hi:[1,1,0]
v_pk_mul_f32 v[48:49], v[48:49], v[64:65]
v_pk_mul_f32 v[50:51], v[50:51], v[66:67]
v_pk_mul_f32 v[52:53], v[52:53], v[68:69]
v_pk_mul_f32 v[54:55], v[54:55], v[70:71]
v_pk_mul_f32 v[56:57], v[56:57], v[72:73]
v_pk_mul_f32 v[58:59], v[58:59], v[74:75]
v_pk_mul_f32 v[60:61], v[60:61], v[76:77]
v_pk_mul_f32 v[62:63], v[62:63], v[78:79]
v_exp_f32 v48, v48
v_exp_f32 v49, v49
v_exp_f32 v50, v50
v_exp_f32 v51, v51
v_exp_f32 v52, v52
v_exp_f32 v53, v53
v_exp_f32 v54, v54
v_exp_f32 v55, v55
v_exp_f32 v56, v56
v_exp_f32 v57, v57
v_exp_f32 v58, v58
v_exp_f32 v59, v59
v_exp_f32 v60, v60
v_exp_f32 v61, v61
v_exp_f32 v62, v62
v_exp_f32 v63, v63
v_pk_fma_f32 v[48:49], v[48:49], v[122:123], v[122:123] op_sel_hi:[1,0,0]
v_pk_fma_f32 v[50:51], v[50:51], v[122:123], v[122:123] op_sel_hi:[1,0,0]
v_pk_fma_f32 v[52:53], v[52:53], v[122:123], v[122:123] op_sel_hi:[1,0,0]
v_pk_fma_f32 v[54:55], v[54:55], v[122:123], v[122:123] op_sel_hi:[1,0,0]
v_pk_fma_f32 v[56:57], v[56:57], v[122:123], v[122:123] op_sel_hi:[1,0,0]
v_pk_fma_f32 v[58:59], v[58:59], v[122:123], v[122:123] op_sel_hi:[1,0,0]
v_pk_fma_f32 v[60:61], v[60:61], v[122:123], v[122:123] op_sel_hi:[1,0,0]
v_pk_fma_f32 v[62:63], v[62:63], v[122:123], v[122:123] op_sel_hi:[1,0,0]
v_rcp_f32 v48, v48
v_rcp_f32 v49, v49
v_rcp_f32 v50, v50
v_rcp_f32 v51, v51
v_rcp_f32 v52, v52
v_rcp_f32 v53, v53
v_rcp_f32 v54, v54
v_rcp_f32 v55, v55
v_rcp_f32 v56, v56
v_rcp_f32 v57, v57
v_rcp_f32 v58, v58
v_rcp_f32 v59, v59
v_rcp_f32 v60, v60
v_rcp_f32 v61, v61
v_rcp_f32 v62, v62
v_rcp_f32 v63, v63
v_pk_mul_f32 v[48:49], v[48:49], v[64:65]
v_pk_mul_f32 v[50:51], v[50:51], v[66:67]
v_pk_mul_f32 v[52:53], v[52:53], v[68:69]
v_pk_mul_f32 v[54:55], v[54:55], v[70:71]
v_pk_mul_f32 v[56:57], v[56:57], v[72:73]
v_pk_mul_f32 v[58:59], v[58:59], v[74:75]
v_pk_mul_f32 v[60:61], v[60:61], v[76:77]
v_pk_mul_f32 v[62:63], v[62:63], v[78:79]
v_cvt_pk_bf16_f32 v32, v48, v49
v_cvt_pk_bf16_f32 v33, v50, v51
v_cvt_pk_bf16_f32 v34, v52, v53
v_cvt_pk_bf16_f32 v35, v54, v55
v_cvt_pk_bf16_f32 v36, v56, v57
v_cvt_pk_bf16_f32 v37, v58, v59
v_cvt_pk_bf16_f32 v38, v60, v61
v_cvt_pk_bf16_f32 v39, v62, v63
buffer_store_dwordx4 v[32:35], v118, s[40:43], s63 offen offset:0 sc1
buffer_store_dwordx4 v[36:39], v118, s[40:43], s63 offen offset:1024 sc1
s_waitcnt lgkmcnt(3)
v_pk_fma_f32 v[80:81], v[96:97], v[26:27], v[80:81] op_sel_hi:[1,0,1]
v_pk_fma_f32 v[82:83], v[98:99], v[26:27], v[82:83] op_sel_hi:[1,0,1]
s_waitcnt lgkmcnt(2)
v_pk_fma_f32 v[84:85], v[100:101], v[26:27], v[84:85] op_sel_hi:[1,0,1]
v_pk_fma_f32 v[86:87], v[102:103], v[26:27], v[86:87] op_sel_hi:[1,0,1]
s_waitcnt lgkmcnt(1)
v_pk_fma_f32 v[88:89], v[104:105], v[26:27], v[88:89] op_sel_hi:[1,0,1]
v_pk_fma_f32 v[90:91], v[106:107], v[26:27], v[90:91] op_sel_hi:[1,0,1]
s_waitcnt lgkmcnt(0)
v_pk_fma_f32 v[92:93], v[108:109], v[26:27], v[92:93] op_sel_hi:[1,0,1]
v_pk_fma_f32 v[94:95], v[110:111], v[26:27], v[94:95] op_sel_hi:[1,0,1]
v_pk_mul_f32 v[48:49], v[80:81], v[80:81]
v_pk_mul_f32 v[50:51], v[82:83], v[82:83]
v_pk_mul_f32 v[52:53], v[84:85], v[84:85]
v_pk_mul_f32 v[54:55], v[86:87], v[86:87]
v_pk_mul_f32 v[56:57], v[88:89], v[88:89]
v_pk_mul_f32 v[58:59], v[90:91], v[90:91]
v_pk_mul_f32 v[60:61], v[92:93], v[92:93]
v_pk_mul_f32 v[62:63], v[94:95], v[94:95]
v_pk_fma_f32 v[48:49], v[48:49], v[124:125], v[124:125] op_sel:[0,1,0] op_sel_hi:[1,1,0]
v_pk_fma_f32 v[50:51], v[50:51], v[124:125], v[124:125] op_sel:[0,1,0] op_sel_hi:[1,1,0]
v_pk_fma_f32 v[52:53], v[52:53], v[124:125], v[124:125] op_sel:[0,1,0] op_sel_hi:[1,1,0]
v_pk_fma_f32 v[54:55], v[54:55], v[124:125], v[124:125] op_sel:[0,1,0] op_sel_hi:[1,1,0]
v_pk_fma_f32 v[56:57], v[56:57], v[124:125], v[124:125] op_sel:[0,1,0] op_sel_hi:[1,1,0]
v_pk_fma_f32 v[58:59], v[58:59], v[124:125], v[124:125] op_sel:[0,1,0] op_sel_hi:[1,1,0]
v_pk_fma_f32 v[60:61], v[60:61], v[124:125], v[124:125] op_sel:[0,1,0] op_sel_hi:[1,1,0]
v_pk_fma_f32 v[62:63], v[62:63], v[124:125], v[124:125] op_sel:[0,1,0] op_sel_hi:[1,1,0]
v_pk_mul_f32 v[48:49], v[48:49], v[80:81]
v_pk_mul_f32 v[50:51], v[50:51], v[82:83]
v_pk_mul_f32 v[52:53], v[52:53], v[84:85]
v_pk_mul_f32 v[54:55], v[54:55], v[86:87]
v_pk_mul_f32 v[56:57], v[56:57], v[88:89]
v_pk_mul_f32 v[58:59], v[58:59], v[90:91]
v_pk_mul_f32 v[60:61], v[60:61], v[92:93]
v_pk_mul_f32 v[62:63], v[62:63], v[94:95]
v_exp_f32 v48, v48
v_exp_f32 v49, v49
v_exp_f32 v50, v50
v_exp_f32 v51, v51
v_exp_f32 v52, v52
v_exp_f32 v53, v53
v_exp_f32 v54, v54
v_exp_f32 v55, v55
v_exp_f32 v56, v56
v_exp_f32 v57, v57
v_exp_f32 v58, v58
v_exp_f32 v59, v59
v_exp_f32 v60, v60
v_exp_f32 v61, v61
v_exp_f32 v62, v62
v_exp_f32 v63, v63
v_pk_fma_f32 v[48:49], v[48:49], v[122:123], v[122:123] op_sel_hi:[1,0,0]
v_pk_fma_f32 v[50:51], v[50:51], v[122:123], v[122:123] op_sel_hi:[1,0,0]
v_pk_fma_f32 v[52:53], v[52:53], v[122:123], v[122:123] op_sel_hi:[1,0,0]
v_pk_fma_f32 v[54:55], v[54:55], v[122:123], v[122:123] op_sel_hi:[1,0,0]
v_pk_fma_f32 v[56:57], v[56:57], v[122:123], v[122:123] op_sel_hi:[1,0,0]
v_pk_fma_f32 v[58:59], v[58:59], v[122:123], v[122:123] op_sel_hi:[1,0,0]
v_pk_fma_f32 v[60:61], v[60:61], v[122:123], v[122:123] op_sel_hi:[1,0,0]
v_pk_fma_f32 v[62:63], v[62:63], v[122:123], v[122:123] op_sel_hi:[1,0,0]
v_rcp_f32 v48, v48
v_rcp_f32 v49, v49
v_rcp_f32 v50, v50
v_rcp_f32 v51, v51
v_rcp_f32 v52, v52
v_rcp_f32 v53, v53
v_rcp_f32 v54, v54
v_rcp_f32 v55, v55
v_rcp_f32 v56, v56
v_rcp_f32 v57, v57
v_rcp_f32 v58, v58
v_rcp_f32 v59, v59
v_rcp_f32 v60, v60
v_rcp_f32 v61, v61
v_rcp_f32 v62, v62
v_rcp_f32 v63, v63
v_pk_mul_f32 v[48:49], v[48:49], v[80:81]
v_pk_mul_f32 v[50:51], v[50:51], v[82:83]
v_pk_mul_f32 v[52:53], v[52:53], v[84:85]
v_pk_mul_f32 v[54:55], v[54:55], v[86:87]
v_pk_mul_f32 v[56:57], v[56:57], v[88:89]
v_pk_mul_f32 v[58:59], v[58:59], v[90:91]
v_pk_mul_f32 v[60:61], v[60:61], v[92:93]
v_pk_mul_f32 v[62:63], v[62:63], v[94:95]
v_cvt_pk_bf16_f32 v40, v48, v49
v_cvt_pk_bf16_f32 v41, v50, v51
v_cvt_pk_bf16_f32 v42, v52, v53
v_cvt_pk_bf16_f32 v43, v54, v55
v_cvt_pk_bf16_f32 v44, v56, v57
v_cvt_pk_bf16_f32 v45, v58, v59
v_cvt_pk_bf16_f32 v46, v60, v61
v_cvt_pk_bf16_f32 v47, v62, v63
buffer_store_dwordx4 v[40:43], v118, s[40:43], s63 offen offset:2048 sc1
buffer_store_dwordx4 v[44:47], v118, s[40:43], s63 offen offset:3072 sc1
s_waitcnt vmcnt(4)
s_barrier
v_add_u32 v16, 0x10000, v16
ds_read_b64_tr_b16 v[48:49], v16 offset:0
ds_read_b64_tr_b16 v[50:51], v16 offset:1024
v_add_u32 v17, 0x10000, v17
ds_read_b64_tr_b16 v[52:53], v17 offset:0
ds_read_b64_tr_b16 v[54:55], v17 offset:1024
ds_read_b64_tr_b16 v[56:57], v16 offset:2048
ds_read_b64_tr_b16 v[58:59], v16 offset:3072
ds_read_b64_tr_b16 v[60:61], v17 offset:2048
ds_read_b64_tr_b16 v[62:63], v17 offset:3072
s_waitcnt lgkmcnt(6)
v_mfma_f32_32x32x16_bf16 a[0:15], a[252:255], v[48:51], 0
v_add_u32 v14, 0x10000, v14
ds_read_b64_tr_b16 v[32:33], v14 offset:0
ds_read_b64_tr_b16 v[34:35], v14 offset:512
s_waitcnt lgkmcnt(6)
v_mfma_f32_32x32x16_bf16 a[16:31], a[252:255], v[52:55], 0
v_add_u32 v15, 0x10000, v15
ds_read_b64_tr_b16 v[36:37], v15 offset:0
ds_read_b64_tr_b16 v[38:39], v15 offset:512
s_add_u32 s88, s49, 0
s_add_u32 s65, s88, 0
s_and_b32 s65, s65, 3
s_lshl_b32 s65, s65, 7
s_add_u32 s66, s88, 1
s_and_b32 s66, s66, 3
s_lshl_b32 s66, s66, 7
s_add_u32 s67, s88, 2
s_and_b32 s67, s67, 3
s_lshl_b32 s67, s67, 7
s_add_u32 s68, s88, 3
s_and_b32 s68, s68, 3
s_lshl_b32 s68, s68, 7
v_accvgpr_read_b32 v6, a90
v_add_u32 v7, 0x1c00, v6
v_add_u32 v8, 0x3800, v6
v_add_u32 v9, 0x5400, v6
s_waitcnt lgkmcnt(6)
v_mfma_f32_32x32x16_bf16 a[0:15], a[252:255], v[56:59], a[0:15]
ds_read_b64_tr_b16 v[40:41], v14 offset:2048
ds_read_b64_tr_b16 v[42:43], v14 offset:2560
s_waitcnt lgkmcnt(6)
v_mfma_f32_32x32x16_bf16 a[16:31], a[252:255], v[60:63], a[16:31]
ds_read_b64_tr_b16 v[44:45], v15 offset:2048
ds_read_b64_tr_b16 v[46:47], v15 offset:2560
s_add_u32 m0, s59, 0x14000
s_mul_i32 s64, s65, 512
s_add_u32 s64, s64, s56
buffer_load_dwordx4 v6, s[24:27], s64 offen offset:0 lds
s_waitcnt lgkmcnt(6)
v_mfma_f32_32x32x16_bf16 v[64:79], v[32:35], v[128:131], 0
ds_read_b64_tr_b16 v[48:49], v14 offset:4096
ds_read_b64_tr_b16 v[50:51], v14 offset:4608
s_waitcnt lgkmcnt(6)
v_mfma_f32_32x32x16_bf16 v[80:95], v[36:39], v[128:131], 0
ds_read_b64_tr_b16 v[52:53], v15 offset:4096
ds_read_b64_tr_b16 v[54:55], v15 offset:4608
buffer_load_dwordx4 v7, s[24:27], s64 offen offset:1024 lds
s_waitcnt lgkmcnt(6)
v_mfma_f32_32x32x16_bf16 v[64:79], v[40:43], v[132:135], v[64:79]
ds_read_b64_tr_b16 v[56:57], v14 offset:6144
ds_read_b64_tr_b16 v[58:59], v14 offset:6656
s_waitcnt lgkmcnt(6)
v_mfma_f32_32x32x16_bf16 v[80:95], v[44:47], v[132:135], v[80:95]
ds_read_b64_tr_b16 v[60:61], v15 offset:6144
ds_read_b64_tr_b16 v[62:63], v15 offset:6656
buffer_load_dwordx4 v8, s[24:27], s64 offen offset:2048 lds
v_and_b32 v25, 0x7c, v29
s_lshl_b32 s60, s48, 9
s_add_u32 s60, s60, 0x24c00
v_add_u32 v25, s60, v25
ds_write_b32 v25, a0 offset:0
ds_write_b32 v25, a16 offset:128
s_waitcnt lgkmcnt(8)
v_mfma_f32_32x32x16_bf16 v[64:79], v[48:51], v[136:139], v[64:79]
ds_read_b64_tr_b16 v[32:33], v14 offset:8192
ds_read_b64_tr_b16 v[34:35], v14 offset:8704
s_waitcnt lgkmcnt(8)
v_mfma_f32_32x32x16_bf16 v[80:95], v[52:55], v[136:139], v[80:95]
ds_read_b64_tr_b16 v[36:37], v15 offset:8192
ds_read_b64_tr_b16 v[38:39], v15 offset:8704
buffer_load_dwordx4 v9, s[24:27], s64 offen offset:3072 lds
s_waitcnt lgkmcnt(8)
v_mfma_f32_32x32x16_bf16 v[64:79], v[56:59], v[140:143], v[64:79]
ds_read_b64_tr_b16 v[40:41], v14 offset:10240
ds_read_b64_tr_b16 v[42:43], v14 offset:10752
s_waitcnt lgkmcnt(6)
s_barrier
v_mfma_f32_32x32x16_bf16 v[80:95], v[60:63], v[140:143], v[80:95]
ds_read_b64_tr_b16 v[44:45], v15 offset:10240
ds_read_b64_tr_b16 v[46:47], v15 offset:10752
s_add_u32 m0, s59, 0x4000
s_mul_i32 s64, s67, 512
s_add_u32 s64, s64, s56
buffer_load_dwordx4 v6, s[24:27], s64 offen offset:0 lds
s_waitcnt lgkmcnt(6)
v_mfma_f32_32x32x16_bf16 v[64:79], v[32:35], v[144:147], v[64:79]
ds_read_b64_tr_b16 v[48:49], v14 offset:12288
ds_read_b64_tr_b16 v[50:51], v14 offset:12800
v_add_u32 v25, 0x24c00, v29
s_waitcnt lgkmcnt(6)
v_mfma_f32_32x32x16_bf16 v[80:95], v[36:39], v[144:147], v[80:95]
ds_read_b64_tr_b16 v[52:53], v15 offset:12288
ds_read_b64_tr_b16 v[54:55], v15 offset:12800
buffer_load_dwordx4 v7, s[24:27], s64 offen offset:1024 lds
ds_read2st64_b32 v[112:113], v25 offset0:0 offset1:2
s_waitcnt lgkmcnt(7)
v_mfma_f32_32x32x16_bf16 v[64:79], v[40:43], v[148:151], v[64:79]
ds_read_b64_tr_b16 v[56:57], v14 offset:14336
ds_read_b64_tr_b16 v[58:59], v14 offset:14848
ds_read2st64_b32 v[114:115], v25 offset0:4 offset1:6
s_waitcnt lgkmcnt(8)
v_mfma_f32_32x32x16_bf16 v[80:95], v[44:47], v[148:151], v[80:95]
ds_read_b64_tr_b16 v[60:61], v15 offset:14336
ds_read_b64_tr_b16 v[62:63], v15 offset:14848
buffer_load_dwordx4 v8, s[24:27], s64 offen offset:2048 lds
s_waitcnt lgkmcnt(8)
v_mfma_f32_32x32x16_bf16 v[64:79], v[48:51], v[152:155], v[64:79]
v_add_u32 v14, 0xffff8000, v14
ds_read_b64_tr_b16 v[32:33], v14 offset:0
ds_read_b64_tr_b16 v[34:35], v14 offset:512
s_waitcnt lgkmcnt(8)
v_mfma_f32_32x32x16_bf16 v[80:95], v[52:55], v[152:155], v[80:95]
v_add_u32 v15, 0xffff8000, v15
ds_read_b64_tr_b16 v[36:37], v15 offset:0
ds_read_b64_tr_b16 v[38:39], v15 offset:512
buffer_load_dwordx4 v9, s[24:27], s64 offen offset:3072 lds
v_lshlrev_b32 v25, 3, v0
s_waitcnt lgkmcnt(7)
v_mfma_f32_32x32x16_bf16 v[64:79], v[56:59], v[156:159], v[64:79]
ds_read_b64_tr_b16 v[40:41], v14 offset:2048
ds_read_b64_tr_b16 v[42:43], v14 offset:2560
v_add_f32 v112, v112, v113
s_waitcnt lgkmcnt(6)
v_mfma_f32_32x32x16_bf16 v[80:95], v[60:63], v[156:159], v[80:95]
ds_read_b64_tr_b16 v[44:45], v15 offset:2048
ds_read_b64_tr_b16 v[46:47], v15 offset:2560
s_add_u32 m0, s59, 0xc000
s_mul_i32 s64, s68, 512
s_add_u32 s64, s64, s56
buffer_load_dwordx4 v6, s[24:27], s64 offen offset:0 lds
v_add_f32 v114, v114, v115
s_waitcnt lgkmcnt(6)
v_mfma_f32_32x32x16_bf16 v[64:79], v[32:35], v[160:163], v[64:79]
ds_read_b64_tr_b16 v[48:49], v14 offset:4096
ds_read_b64_tr_b16 v[50:51], v14 offset:4608
v_mov_b32 v113, v30
s_waitcnt lgkmcnt(6)
v_mfma_f32_32x32x16_bf16 v[80:95], v[36:39], v[160:163], v[80:95]
ds_read_b64_tr_b16 v[52:53], v15 offset:4096
ds_read_b64_tr_b16 v[54:55], v15 offset:4608
buffer_load_dwordx4 v7, s[24:27], s64 offen offset:1024 lds
v_add_f32 v112, v112, v114
s_waitcnt lgkmcnt(6)
v_mfma_f32_32x32x16_bf16 v[64:79], v[40:43], v[164:167], v[64:79]
ds_read_b64_tr_b16 v[56:57], v14 offset:6144
ds_read_b64_tr_b16 v[58:59], v14 offset:6656
s_waitcnt vmcnt(10)
s_mov_b64 exec, 0xffff
buffer_store_dword v30, v29, s[40:43], s92 offen sc1
s_mov_b64 exec, -1
s_lshl_b32 s60, s49, 4
s_add_u32 s60, s60, s50
s_lshl_b32 s60, s60, 10
s_add_u32 s60, s60, 0xde0000
s_mov_b64 exec, s[84:85]
buffer_store_dwordx2 v[112:113], v25, s[40:43], s60 offen offset:0 sc1
s_mov_b64 exec, -1
s_waitcnt lgkmcnt(6)
v_mfma_f32_32x32x16_bf16 v[80:95], v[44:47], v[164:167], v[80:95]
ds_read_b64_tr_b16 v[60:61], v15 offset:6144
ds_read_b64_tr_b16 v[62:63], v15 offset:6656
buffer_load_dwordx4 v8, s[24:27], s64 offen offset:2048 lds
s_waitcnt lgkmcnt(6)
v_mfma_f32_32x32x16_bf16 v[64:79], v[48:51], v[168:171], v[64:79]
ds_read_b64_tr_b16 v[32:33], v14 offset:8192
ds_read_b64_tr_b16 v[34:35], v14 offset:8704
s_waitcnt lgkmcnt(6)
v_mfma_f32_32x32x16_bf16 v[80:95], v[52:55], v[168:171], v[80:95]
ds_read_b64_tr_b16 v[36:37], v15 offset:8192
ds_read_b64_tr_b16 v[38:39], v15 offset:8704
buffer_load_dwordx4 v9, s[24:27], s64 offen offset:3072 lds
v_accvgpr_read_b32 v2, a91
s_waitcnt lgkmcnt(6)
v_mfma_f32_32x32x16_bf16 v[64:79], v[56:59], v[172:175], v[64:79]
ds_read_b64_tr_b16 v[40:41], v14 offset:10240
ds_read_b64_tr_b16 v[42:43], v14 offset:10752
v_add_u32 v3, 0x6c00, v2
s_waitcnt lgkmcnt(6)
v_mfma_f32_32x32x16_bf16 v[80:95], v[60:63], v[172:175], v[80:95]
ds_read_b64_tr_b16 v[44:45], v15 offset:10240
ds_read_b64_tr_b16 v[46:47], v15 offset:10752
s_add_u32 m0, s59, 0x20000
s_mul_i32 s64, s66, 512
s_add_u32 s64, s64, s56
buffer_load_dwordx4 v6, s[24:27], s64 offen offset:0 lds
v_add_u32 v4, 0xd800, v2
s_waitcnt lgkmcnt(6)
v_mfma_f32_32x32x16_bf16 v[64:79], v[32:35], v[176:179], v[64:79]
ds_read_b64_tr_b16 v[48:49], v14 offset:12288
ds_read_b64_tr_b16 v[50:51], v14 offset:12800
v_add_u32 v5, 0x14400, v2
s_waitcnt lgkmcnt(6)
v_mfma_f32_32x32x16_bf16 v[80:95], v[36:39], v[176:179], v[80:95]
ds_read_b64_tr_b16 v[52:53], v15 offset:12288
ds_read_b64_tr_b16 v[54:55], v15 offset:12800
buffer_load_dwordx4 v7, s[24:27], s64 offen offset:1024 lds
s_waitcnt lgkmcnt(6)
v_mfma_f32_32x32x16_bf16 v[64:79], v[40:43], v[180:183], v[64:79]
ds_read_b64_tr_b16 v[56:57], v14 offset:14336
ds_read_b64_tr_b16 v[58:59], v14 offset:14848
s_waitcnt lgkmcnt(6)
v_mfma_f32_32x32x16_bf16 v[80:95], v[44:47], v[180:183], v[80:95]
ds_read_b64_tr_b16 v[60:61], v15 offset:14336
ds_read_b64_tr_b16 v[62:63], v15 offset:14848
buffer_load_dwordx4 v8, s[24:27], s64 offen offset:2048 lds
s_waitcnt lgkmcnt(6)
v_mfma_f32_32x32x16_bf16 v[64:79], v[48:51], v[184:187], v[64:79]
v_add_u32 v14, 0x10000, v14
ds_read_b64_tr_b16 v[32:33], v14 offset:0
ds_read_b64_tr_b16 v[34:35], v14 offset:512
s_waitcnt lgkmcnt(6)
v_mfma_f32_32x32x16_bf16 v[80:95], v[52:55], v[184:187], v[80:95]
v_add_u32 v15, 0x10000, v15
ds_read_b64_tr_b16 v[36:37], v15 offset:0
ds_read_b64_tr_b16 v[38:39], v15 offset:512
buffer_load_dwordx4 v9, s[24:27], s64 offen offset:3072 lds
s_waitcnt lgkmcnt(6)
v_mfma_f32_32x32x16_bf16 v[64:79], v[56:59], v[188:191], v[64:79]
ds_read_b64_tr_b16 v[40:41], v14 offset:2048
ds_read_b64_tr_b16 v[42:43], v14 offset:2560
s_waitcnt lgkmcnt(6)
v_mfma_f32_32x32x16_bf16 v[80:95], v[60:63], v[188:191], v[80:95]
ds_read_b64_tr_b16 v[44:45], v15 offset:2048
ds_read_b64_tr_b16 v[46:47], v15 offset:2560
s_add_u32 m0, s59, 0x0
s_mul_i32 s64, s65, 3584
s_add_u32 s64, s64, s77
s_add_u32 s64, s64, 0x80
buffer_load_dwordx4 v2, s[28:31], s64 offen offset:0 lds
s_waitcnt lgkmcnt(6)
v_mfma_f32_32x32x16_bf16 v[64:79], v[32:35], v[192:195], v[64:79]
ds_read_b64_tr_b16 v[48:49], v14 offset:4096
ds_read_b64_tr_b16 v[50:51], v14 offset:4608
s_waitcnt lgkmcnt(6)
v_mfma_f32_32x32x16_bf16 v[80:95], v[36:39], v[192:195], v[80:95]
ds_read_b64_tr_b16 v[52:53], v15 offset:4096
ds_read_b64_tr_b16 v[54:55], v15 offset:4608
buffer_load_dwordx4 v3, s[28:31], s64 offen offset:1024 lds
s_waitcnt lgkmcnt(6)
v_mfma_f32_32x32x16_bf16 v[64:79], v[40:43], v[196:199], v[64:79]
ds_read_b64_tr_b16 v[56:57], v14 offset:6144
ds_read_b64_tr_b16 v[58:59], v14 offset:6656
s_waitcnt lgkmcnt(6)
v_mfma_f32_32x32x16_bf16 v[80:95], v[44:47], v[196:199], v[80:95]
ds_read_b64_tr_b16 v[60:61], v15 offset:6144
ds_read_b64_tr_b16 v[62:63], v15 offset:6656
buffer_load_dwordx4 v4, s[28:31], s64 offen offset:2048 lds
s_waitcnt lgkmcnt(6)
v_mfma_f32_32x32x16_bf16 v[64:79], v[48:51], v[200:203], v[64:79]
ds_read_b64_tr_b16 v[32:33], v14 offset:8192
ds_read_b64_tr_b16 v[34:35], v14 offset:8704
s_waitcnt lgkmcnt(6)
v_mfma_f32_32x32x16_bf16 v[80:95], v[52:55], v[200:203], v[80:95]
ds_read_b64_tr_b16 v[36:37], v15 offset:8192
ds_read_b64_tr_b16 v[38:39], v15 offset:8704
s_waitcnt lgkmcnt(6)
v_mfma_f32_32x32x16_bf16 v[64:79], v[56:59], v[204:207], v[64:79]
ds_read_b64_tr_b16 v[40:41], v14 offset:10240
ds_read_b64_tr_b16 v[42:43], v14 offset:10752
v_accvgpr_read_b32 v113, a87
v_accvgpr_read_b32 v112, a88
ds_read_b64 v[120:121], v113
v_xor_b32 v114, 16, v113
ds_read_b64 v[122:123], v114
v_xor_b32 v114, 32, v113
ds_read_b64 v[124:125], v114
v_xor_b32 v114, 48, v113
ds_read_b64 v[126:127], v114
s_lshl_b32 s62, s55, 9
s_add_u32 s62, s62, 0xd80000
buffer_load_dwordx4 v[144:147], v112, s[40:43], s62 offen sc1
s_waitcnt lgkmcnt(10)
v_mfma_f32_32x32x16_bf16 v[80:95], v[60:63], v[204:207], v[80:95]
ds_read_b64_tr_b16 v[44:45], v15 offset:10240
ds_read_b64_tr_b16 v[46:47], v15 offset:10752
s_waitcnt lgkmcnt(10)
v_mfma_f32_32x32x16_bf16 v[64:79], v[32:35], v[208:211], v[64:79]
ds_read_b64_tr_b16 v[48:49], v14 offset:12288
ds_read_b64_tr_b16 v[50:51], v14 offset:12800
s_waitcnt lgkmcnt(10)
v_mfma_f32_32x32x16_bf16 v[80:95], v[36:39], v[208:211], v[80:95]
ds_read_b64_tr_b16 v[52:53], v15 offset:12288
ds_read_b64_tr_b16 v[54:55], v15 offset:12800
s_waitcnt lgkmcnt(10)
v_mfma_f32_32x32x16_bf16 v[64:79], v[40:43], v[212:215], v[64:79]
ds_read_b64_tr_b16 v[56:57], v14 offset:14336
ds_read_b64_tr_b16 v[58:59], v14 offset:14848
v_lshlrev_b32 v22, 3, v0
s_and_b32 s97, s49, 12
s_lshl_b32 s97, s97, 4
s_add_u32 s97, s97, s50
s_lshl_b32 s97, s97, 10
s_add_u32 s97, s97, 0xde0000
s_add_u32 s98, s97, 0x4000
s_add_u32 s100, s97, 0x8000
s_add_u32 s101, s97, 0xc000
buffer_load_dwordx2 v[128:129], v22, s[40:43], s97 offen offset:0 sc1
buffer_load_dwordx2 v[130:131], v22, s[40:43], s98 offen offset:0 sc1
buffer_load_dwordx2 v[132:133], v22, s[40:43], s100 offen offset:0 sc1
buffer_load_dwordx2 v[134:135], v22, s[40:43], s101 offen offset:0 sc1
s_waitcnt lgkmcnt(6)
v_mfma_f32_32x32x16_bf16 v[80:95], v[44:47], v[212:215], v[80:95]
ds_read_b64_tr_b16 v[60:61], v15 offset:14336
ds_read_b64_tr_b16 v[62:63], v15 offset:14848
s_waitcnt lgkmcnt(6)
v_mfma_f32_32x32x16_bf16 v[64:79], v[48:51], v[216:219], v[64:79]
ds_read_b64_tr_b16 v[32:33], v14 offset:16384
ds_read_b64_tr_b16 v[34:35], v14 offset:16896
s_waitcnt lgkmcnt(6)
v_mfma_f32_32x32x16_bf16 v[80:95], v[52:55], v[216:219], v[80:95]
ds_read_b64_tr_b16 v[36:37], v15 offset:16384
ds_read_b64_tr_b16 v[38:39], v15 offset:16896
s_waitcnt lgkmcnt(6)
v_mfma_f32_32x32x16_bf16 v[64:79], v[56:59], v[220:223], v[64:79]
ds_read_b64_tr_b16 v[40:41], v14 offset:18432
ds_read_b64_tr_b16 v[42:43], v14 offset:18944
v_mov_b32 v24, v30
s_mov_b64 exec, 0xff
buffer_load_dword v24, v23, s[40:43], s96 offen sc1
s_mov_b64 exec, -1
s_waitcnt lgkmcnt(6)
v_mfma_f32_32x32x16_bf16 v[80:95], v[60:63], v[220:223], v[80:95]
ds_read_b64_tr_b16 v[44:45], v15 offset:18432
ds_read_b64_tr_b16 v[46:47], v15 offset:18944
s_waitcnt lgkmcnt(6)
v_mfma_f32_32x32x16_bf16 v[64:79], v[32:35], v[224:227], v[64:79]
ds_read_b64_tr_b16 v[48:49], v14 offset:20480
ds_read_b64_tr_b16 v[50:51], v14 offset:20992
s_waitcnt lgkmcnt(6)
v_mfma_f32_32x32x16_bf16 v[80:95], v[36:39], v[224:227], v[80:95]
ds_read_b64_tr_b16 v[52:53], v15 offset:20480
ds_read_b64_tr_b16 v[54:55], v15 offset:20992
s_waitcnt lgkmcnt(6)
v_mfma_f32_32x32x16_bf16 v[64:79], v[40:43], v[228:231], v[64:79]
ds_read_b64_tr_b16 v[56:57], v14 offset:22528
ds_read_b64_tr_b16 v[58:59], v14 offset:23040
s_waitcnt lgkmcnt(6)
v_mfma_f32_32x32x16_bf16 v[80:95], v[44:47], v[228:231], v[80:95]
ds_read_b64_tr_b16 v[60:61], v15 offset:22528
ds_read_b64_tr_b16 v[62:63], v15 offset:23040
s_waitcnt lgkmcnt(6)
v_mfma_f32_32x32x16_bf16 v[64:79], v[48:51], v[232:235], v[64:79]
ds_read_b64_tr_b16 v[32:33], v14 offset:24576
ds_read_b64_tr_b16 v[34:35], v14 offset:25088
s_waitcnt lgkmcnt(6)
v_mfma_f32_32x32x16_bf16 v[80:95], v[52:55], v[232:235], v[80:95]
ds_read_b64_tr_b16 v[36:37], v15 offset:24576
ds_read_b64_tr_b16 v[38:39], v15 offset:25088
s_waitcnt lgkmcnt(6)
v_mfma_f32_32x32x16_bf16 v[64:79], v[56:59], v[236:239], v[64:79]
ds_read_b64_tr_b16 v[40:41], v14 offset:26624
ds_read_b64_tr_b16 v[42:43], v14 offset:27136
s_waitcnt lgkmcnt(6)
v_mfma_f32_32x32x16_bf16 v[80:95], v[60:63], v[236:239], v[80:95]
ds_read_b64_tr_b16 v[44:45], v15 offset:26624
ds_read_b64_tr_b16 v[46:47], v15 offset:27136
s_waitcnt lgkmcnt(6)
v_mfma_f32_32x32x16_bf16 v[64:79], v[32:35], v[240:243], v[64:79]
ds_read_b64_tr_b16 v[48:49], v14 offset:28672
ds_read_b64_tr_b16 v[50:51], v14 offset:29184
s_waitcnt lgkmcnt(6)
v_mfma_f32_32x32x16_bf16 v[80:95], v[36:39], v[240:243], v[80:95]
ds_read_b64_tr_b16 v[52:53], v15 offset:28672
ds_read_b64_tr_b16 v[54:55], v15 offset:29184
s_waitcnt lgkmcnt(6)
v_mfma_f32_32x32x16_bf16 v[64:79], v[40:43], v[244:247], v[64:79]
ds_read_b64_tr_b16 v[56:57], v14 offset:30720
ds_read_b64_tr_b16 v[58:59], v14 offset:31232
s_waitcnt lgkmcnt(6)
v_mfma_f32_32x32x16_bf16 v[80:95], v[44:47], v[244:247], v[80:95]
ds_read_b64_tr_b16 v[60:61], v15 offset:30720
ds_read_b64_tr_b16 v[62:63], v15 offset:31232
s_waitcnt lgkmcnt(6)
v_mfma_f32_32x32x16_bf16 v[64:79], v[48:51], v[248:251], v[64:79]
s_waitcnt lgkmcnt(4)
v_mfma_f32_32x32x16_bf16 v[80:95], v[52:55], v[248:251], v[80:95]
s_waitcnt lgkmcnt(2)
v_mfma_f32_32x32x16_bf16 v[64:79], v[56:59], v[252:255], v[64:79]
s_waitcnt lgkmcnt(0)
v_mfma_f32_32x32x16_bf16 v[80:95], v[60:63], v[252:255], v[80:95]
s_waitcnt vmcnt(0)
v_cmp_ne_u32 vcc, s52, v24
s_nop 4
s_cbranch_vccz Lok_9
s_mov_b32 s73, 0x8000
Lpoll_10:
s_mov_b64 exec, 0xff
buffer_load_dword v24, v23, s[40:43], s96 offen sc1
s_mov_b64 exec, -1
s_sub_u32 s73, s73, 1
s_waitcnt vmcnt(0)
s_cbranch_scc1 Lok_9
v_cmp_ne_u32 vcc, s52, v24
s_nop 4
s_cbranch_vccnz Lpoll_10
Lok_9:
buffer_load_dwordx4 v5, s[28:31], s64 offen offset:3072 lds
s_lshl_b32 s88, s55, 15
s_lshl_b32 s89, s57, 14
s_add_u32 s88, s88, s89
s_lshl_b32 s89, s65, 5
s_add_u32 s89, s89, s88
buffer_load_dwordx4 a[0:3], v1, s[40:43], s89 offen offset:0 sc1
buffer_load_dwordx4 a[4:7], v1, s[40:43], s89 offen offset:1024 sc1
buffer_load_dwordx4 a[8:11], v1, s[40:43], s89 offen offset:2048 sc1
buffer_load_dwordx4 a[12:15], v1, s[40:43], s89 offen offset:3072 sc1
s_lshl_b32 s89, s66, 5
s_add_u32 s89, s89, s88
buffer_load_dwordx4 a[16:19], v1, s[40:43], s89 offen offset:0 sc1
buffer_load_dwordx4 a[20:23], v1, s[40:43], s89 offen offset:1024 sc1
buffer_load_dwordx4 a[24:27], v1, s[40:43], s89 offen offset:2048 sc1
buffer_load_dwordx4 a[28:31], v1, s[40:43], s89 offen offset:3072 sc1
s_lshl_b32 s89, s67, 5
s_add_u32 s89, s89, s88
buffer_load_dwordx4 a[32:35], v1, s[40:43], s89 offen offset:0 sc1
buffer_load_dwordx4 a[36:39], v1, s[40:43], s89 offen offset:1024 sc1
buffer_load_dwordx4 a[40:43], v1, s[40:43], s89 offen offset:2048 sc1
buffer_load_dwordx4 a[44:47], v1, s[40:43], s89 offen offset:3072 sc1
s_lshl_b32 s89, s68, 5
s_add_u32 s89, s89, s88
buffer_load_dwordx4 a[48:51], v1, s[40:43], s89 offen offset:0 sc1
buffer_load_dwordx4 a[52:55], v1, s[40:43], s89 offen offset:1024 sc1
buffer_load_dwordx4 a[56:59], v1, s[40:43], s89 offen offset:2048 sc1
buffer_load_dwordx4 a[60:63], v1, s[40:43], s89 offen offset:3072 sc1
s_branch Ljoin_2
Lkv_1:
v_lshrrev_b32 v96, 3, v0
v_lshrrev_b32 v97, 2, v0
v_and_b32 v97, 4, v97
v_xor_b32 v97, v0, v97
v_and_b32 v97, 7, v97
v_lshlrev_b32 v97, 4, v97
v_add_u32 v96, s63, v96
v_mul_u32_u24 v96, 0xc00, v96
v_add_u32 v2, v96, v97
v_add_u32 v3, 0x5c00, v2
v_add_u32 v4, 0xb800, v2
v_add_u32 v5, 0x11400, v2
v_mov_b32 v25, 0
s_mov_b32 s60, 0x1200000
s_waitcnt lgkmcnt(0)
s_add_u32 m0, s59, 0x8000
s_mul_i32 s64, s69, 3072
s_add_u32 s64, s64, s76
s_add_u32 s64, s64, 0x400
buffer_load_dwordx4 v2, s[8:11], s64 offen offset:0 lds
buffer_load_dwordx4 v3, s[8:11], s64 offen offset:1024 lds
buffer_load_dwordx4 v4, s[8:11], s64 offen offset:2048 lds
buffer_load_dwordx4 v5, s[8:11], s64 offen offset:3072 lds
s_add_u32 m0, s59, 0x0
s_nop 0
buffer_load_dwordx4 v6, s[4:7], s65 offen offset:0 lds
buffer_load_dwordx4 v7, s[4:7], s65 offen offset:1024 lds
buffer_load_dwordx4 v8, s[4:7], s65 offen offset:2048 lds
buffer_load_dwordx4 v9, s[4:7], s65 offen offset:3072 lds
buffer_load_dword v30, v25, s[40:43], s60 offen sc1
s_lshl_b32 s61, s49, 4
s_add_u32 s61, s61, s50
s_lshl_b32 s61, s61, 2
s_add_u32 s61, s61, s48
s_lshl_b32 s60, s61, 11
s_lshl_b32 s73, s61, 5
buffer_load_dwordx4 v[240:243], v1, s[4:7], s60 offen offset:0
buffer_load_dwordx4 v[244:247], v1, s[4:7], s60 offen offset:1024
s_lshr_b32 s60, s2, 3
s_lshl_b32 s60, s60, 2
s_add_u32 s60, s60, s48
s_lshl_b32 s60, s60, 9
v_and_b32 v25, 3, v0
v_lshlrev_b32 v25, 7, v25
v_add_u32 v25, s60, v25
v_min_u32 v25, CODE_BYTES-4, v25
s_getpc_b64 s[62:63]
Lpc_11:
s_sub_u32 s62, s62, Lpc_11-recurrent_scan__linear_kernel_hedgehog__mixer_s_mlp__prompt_kernel
s_subb_u32 s63, s63, 0
global_load_dword v22, v25, s[62:63]
v_and_b32 v96, 31, v0
v_bfe_u32 v97, v0, 1, 3
v_lshrrev_b32 v11, 5, v0
v_xor_b32 v97, v97, v11
v_lshlrev_b32 v97, 4, v97
v_lshl_add_u32 v96, v96, 7, v97
v_add_u32 v10, s59, v96
v_xor_b32 v11, 32, v10
v_xor_b32 v12, 64, v10
v_xor_b32 v13, 96, v10
v_bfe_u32 v96, v0, 2, 2
v_lshrrev_b32 v97, 5, v0
v_mad_u32_u24 v97, v97, 8, v96
v_lshlrev_b32 v14, 7, v97
v_lshrrev_b32 v96, 1, v96
v_lshl_add_u32 v14, v96, 6, v14
v_bfe_u32 v96, v0, 4, 1
v_lshl_add_u32 v14, v96, 5, v14
v_and_b32 v96, 3, v0
v_lshl_add_u32 v14, v96, 3, v14
v_xor_b32 v15, 64, v14
v_bfe_u32 v96, v0, 2, 2
v_lshrrev_b32 v97, 5, v0
v_mad_u32_u24 v97, v97, 4, v96
v_lshlrev_b32 v18, 7, v97
v_lshrrev_b32 v96, 1, v96
v_lshl_add_u32 v18, v96, 6, v18
v_bfe_u32 v96, v0, 4, 1
v_lshl_add_u32 v18, v96, 5, v18
v_and_b32 v96, 3, v0
v_lshl_add_u32 v18, v96, 3, v18
v_xor_b32 v19, 64, v18
v_add_u32 v16, s59, v18
v_add_u32 v17, s59, v19
s_mov_b32 s95, 0x3f803f80
v_accvgpr_write_b32 a252, s95
v_accvgpr_write_b32 a253, s95
v_accvgpr_write_b32 a254, s95
v_accvgpr_write_b32 a255, s95
s_mov_b32 s78, 0x3fb8aa3b
s_mov_b32 s79, 0x3fb8aa3b
s_mov_b32 s80, 0xffff0000
s_mov_b32 s81, 0xffff0000
s_lshr_b32 s57, s48, 1
s_and_b32 s58, s48, 1
s_lshl_b32 s60, s48, 4
s_mov_b64 s[84:85], 0xffff
s_lshl_b64 s[84:85], s[84:85], s60
s_and_b32 s47, s50, 1
s_lshl_b32 s60, s47, 1
s_lshl_b32 s74, s49, 2
s_add_u32 s55, s74, s60
s_add_u32 s55, s55, s58
s_add_u32 s74, s74, s48
s_lshr_b32 s56, s50, 1
s_lshl_b32 s56, s56, 7
s_lshr_b32 s60, s50, 3
s_sub_u32 s75, s50, s60
s_add_u32 s61, s60, 14
s_cmp_lt_u32 s51, 7
s_cselect_b32 s75, s75, s61
s_mul_i32 s60, s60, 7
s_min_u32 s61, s51, 6
s_add_u32 s60, s60, s61
s_lshl_b32 s77, s60, 8
s_lshr_b32 s54, s55, 1
s_mul_i32 s60, s54, 37
s_lshr_b32 s60, s60, 8
s_mul_i32 s60, s60, 7
s_sub_u32 s54, s54, s60
s_lshl_b32 s60, s57, 13
v_bfe_u32 v96, v0, 2, 2
v_lshrrev_b32 v97, 5, v0
v_mad_u32_u24 v97, v97, 4, v96
v_lshlrev_b32 v20, 7, v97
v_lshrrev_b32 v96, 1, v96
v_xor_b32 v96, s57, v96
v_lshl_add_u32 v20, v96, 6, v20
v_bfe_u32 v96, v0, 4, 1
v_lshl_add_u32 v20, v96, 5, v20
v_and_b32 v96, 3, v0
v_lshl_add_u32 v20, v96, 3, v20
v_add_u32 v20, s60, v20
v_xor_b32 v21, 64, v20
v_bfe_u32 v96, v0, 1, 2
s_lshl_b32 s60, s57, 2
v_add_u32 v96, s60, v96
v_and_b32 v97, 2, v96
v_add_u32 v97, -1, v97
v_and_b32 v98, 1, v0
v_mul_i32_i24 v97, v97, v98
v_add_u32 v97, s55, v97
v_and_b32 v97, 63, v97
v_lshl_add_u32 v96, v96, 6, v97
v_lshlrev_b32 v23, 6, v96
s_mov_b32 s96, 0x1100000
s_lshl_b32 s60, s55, 15
s_lshl_b32 s61, s56, 5
s_add_u32 s60, s60, s61
s_lshl_b32 s61, s57, 11
s_add_u32 s60, s60, s61
s_add_u32 s93, s60, 0x200000
s_lshr_b32 s61, s56, 6
s_add_u32 s61, s61, s57
s_lshl_b32 s62, s55, 4
s_add_u32 s62, s62, s61
s_lshl_b32 s60, s62, 8
s_add_u32 s94, s60, 0xd00000
s_lshl_b32 s62, s62, 6
s_add_u32 s99, s62, 0x1110000
s_lshl_b32 s60, s48, 5
v_lshrrev_b32 v96, 3, v0
v_lshrrev_b32 v97, 2, v0
v_and_b32 v97, 4, v97
v_xor_b32 v97, v0, v97
v_and_b32 v97, 7, v97
v_lshlrev_b32 v97, 4, v97
v_add_u32 v96, s60, v96
v_mul_u32_u24 v96, 0xe00, v96
v_add_u32 v98, v96, v97
v_accvgpr_write_b32 a91, v98
s_lshl_b32 s60, s57, 8
s_lshl_b32 s61, s58, 5
s_add_u32 s60, s60, s61
v_lshrrev_b32 v96, 3, v0
v_lshrrev_b32 v97, 2, v0
v_and_b32 v97, 4, v97
v_xor_b32 v97, v0, v97
v_and_b32 v97, 7, v97
v_lshlrev_b32 v97, 4, v97
v_add_u32 v96, s60, v96
v_mul_u32_u24 v96, 0x400, v96
v_add_u32 v98, v96, v97
v_accvgpr_write_b32 a90, v98
s_lshl_b32 s60, s57, 7
v_lshrrev_b32 v96, 3, v0
v_lshrrev_b32 v97, 2, v0
v_and_b32 v97, 4, v97
v_xor_b32 v97, v0, v97
v_and_b32 v97, 7, v97
v_lshlrev_b32 v97, 4, v97
v_add_u32 v96, s60, v96
v_mul_u32_u24 v96, 0x400, v96
v_add_u32 v98, v96, v97
v_accvgpr_write_b32 a242, v98
s_lshl_b32 s60, s55, 15
s_add_u32 s60, s60, s56
s_lshl_b32 s61, s57, 6
s_add_u32 s60, s60, s61
v_and_b32 v96, 31, v0
v_lshrrev_b32 v97, 5, v0
v_lshlrev_b32 v98, 10, v96
v_add_u32 v98, s60, v98
v_lshl_add_u32 v99, v97, 4, v98
v_accvgpr_write_b32 a241, v99
s_lshl_b32 s60, s48, 14
v_subrev_u32 v99, s60, v6
v_accvgpr_write_b32 a94, v99
v_bfe_u32 v99, v0, 1, 3
s_lshl_b32 s60, s57, 2
v_xor_b32 v99, s60, v99
v_lshlrev_b32 v99, 4, v99
v_lshl_add_u32 v99, v97, 3, v99
v_lshl_add_u32 v99, v96, 7, v99
s_lshl_b32 s60, s58, 12
s_add_u32 s60, s60, 0x26000
v_add_u32 v99, s60, v99
v_accvgpr_write_b32 a87, v99
v_lshlrev_b32 v99, 4, v96
v_accvgpr_write_b32 a88, v99
v_bfe_u32 v96, v0, 2, 2
v_lshl_add_u32 v96, v97, 2, v96
v_lshlrev_b32 v96, 5, v96
v_bfe_u32 v98, v0, 4, 1
v_lshl_add_u32 v96, v98, 9, v96
v_and_b32 v98, 3, v0
v_lshl_add_u32 v96, v98, 3, v96
v_add_u32 v96, 0x24000, v96
v_accvgpr_write_b32 a92, v96
v_and_b32 v96, 7, v0
v_min_u32 v96, 6, v96
v_lshlrev_b32 v96, 7, v96
s_lshl_b32 s60, s55, 12
s_lshl_b32 s61, s57, 6
s_add_u32 s60, s60, s61
v_add_u32 v96, s60, v96
v_accvgpr_write_b32 a240, v96
s_mul_i32 s60, s55, 0x1c000
s_lshl_b32 s61, s57, 13
s_add_u32 s60, s60, s61
s_add_u32 s60, s60, 0x600000
v_add_u32 v96, s60, v1
v_accvgpr_write_b32 a93, v96
v_and_b32 v96, 31, v0
v_bfe_u32 v97, v0, 1, 3
v_lshrrev_b32 v98, 5, v0
v_xor_b32 v97, v97, v98
v_lshlrev_b32 v97, 3, v97
v_lshl_add_u32 v97, v96, 6, v97
s_lshl_b32 s60, s48, 11
s_add_u32 s60, s60, 0x4000
v_add_u32 v97, s60, v97
v_accvgpr_write_b32 a80, v97
v_and_b32 v97, 3, v0
v_lshlrev_b32 v97, 2, v97
v_bfe_u32 v99, v0, 2, 2
v_or_b32 v97, v97, v99
v_xor_b32 v97, v97, v98
v_lshlrev_b32 v97, 3, v97
v_lshl_add_u32 v97, v96, 7, v97
s_add_u32 s60, s59, 0xc000
v_add_u32 v97, s60, v97
v_accvgpr_write_b32 a81, v97
v_and_b32 v100, 3, v0
v_bfe_u32 v101, v0, 4, 1
s_mul_i32 s60, s57, 0x1c000
s_lshl_b32 s61, s58, 13
s_add_u32 s60, s60, s61
s_add_u32 s60, s60, 0x4000
s_lshl_b32 s61, s48, 2
v_lshl_add_u32 v102, v98, 3, v99
v_lshl_add_u32 v103, v101, 2, v100
v_lshrrev_b32 v104, 1, v102
v_xor_b32 v103, v103, v104
v_lshlrev_b32 v103, 3, v103
v_lshl_add_u32 v103, v102, 6, v103
v_add_u32 v103, s60, v103
v_accvgpr_write_b32 a82, v103
v_lshrrev_b32 v104, 2, v102
v_lshl_add_u32 v104, v99, 2, v104
v_add_u32 v103, s61, v100
v_xor_b32 v103, v103, v104
v_lshlrev_b32 v103, 3, v103
v_lshl_add_u32 v103, v102, 7, v103
v_add_u32 v103, 0xc000, v103
v_accvgpr_write_b32 a84, v103
v_lshl_add_u32 v102, v98, 3, v99
v_add_u32 v102, 4, v102
v_lshl_add_u32 v103, v101, 2, v100
v_lshrrev_b32 v104, 1, v102
v_xor_b32 v103, v103, v104
v_lshlrev_b32 v103, 3, v103
v_lshl_add_u32 v103, v102, 6, v103
v_add_u32 v103, s60, v103
v_accvgpr_write_b32 a83, v103
v_lshrrev_b32 v104, 2, v102
v_lshl_add_u32 v104, v99, 2, v104
v_add_u32 v103, s61, v100
v_xor_b32 v103, v103, v104
v_lshlrev_b32 v103, 3, v103
v_lshl_add_u32 v103, v102, 7, v103
v_add_u32 v103, 0xc000, v103
v_accvgpr_write_b32 a85, v103
v_and_b32 v96, 27, v0
v_cmp_eq_u32 vcc, 16, v96
v_mov_b32 v97, s95
s_nop 0
v_cndmask_b32 v96, 0, v97, vcc
v_accvgpr_write_b32 a86, v96
s_lshl_b32 s60, s51, 2
s_add_u32 s60, s60, s48
s_lshl_b32 s60, s60, 4
s_add_u32 s60, s60, s49
s_lshl_b32 s60, s60, 6
s_add_u32 s92, s60, 0x1120000
s_add_u32 m0, s59, 0x4000
s_add_u32 s64, s65, 0x80
buffer_load_dwordx4 v6, s[4:7], s64 offen offset:0 lds
buffer_load_dwordx4 v7, s[4:7], s64 offen offset:1024 lds
buffer_load_dwordx4 v8, s[4:7], s64 offen offset:2048 lds
buffer_load_dwordx4 v9, s[4:7], s64 offen offset:3072 lds
s_add_u32 m0, s59, 0x14000
s_mul_i32 s64, s70, 3072
s_add_u32 s64, s64, s76
s_add_u32 s64, s64, 0x400
buffer_load_dwordx4 v2, s[8:11], s64 offen offset:0 lds
buffer_load_dwordx4 v3, s[8:11], s64 offen offset:1024 lds
buffer_load_dwordx4 v4, s[8:11], s64 offen offset:2048 lds
buffer_load_dwordx4 v5, s[8:11], s64 offen offset:3072 lds
s_waitcnt vmcnt(16)
s_barrier
ds_read_b64_tr_b16 v[32:33], v16 offset:32768
ds_read_b64_tr_b16 v[34:35], v16 offset:33792
ds_read_b64_tr_b16 v[36:37], v17 offset:32768
ds_read_b64_tr_b16 v[38:39], v17 offset:33792
ds_read_b64_tr_b16 v[40:41], v16 offset:34816
ds_read_b64_tr_b16 v[42:43], v16 offset:35840
ds_read_b64_tr_b16 v[44:45], v17 offset:34816
ds_read_b64_tr_b16 v[46:47], v17 offset:35840
s_waitcnt vmcnt(12)
ds_read_b128 v[128:131], v10 offset:0
ds_read_b128 v[132:135], v11 offset:0
ds_read_b128 v[136:139], v12 offset:0
ds_read_b128 v[140:143], v13 offset:0
s_waitcnt lgkmcnt(10)
v_mfma_f32_32x32x16_bf16 a[0:15], a[252:255], v[32:35], 0
ds_read_b64_tr_b16 v[48:49], v14 offset:32768
ds_read_b64_tr_b16 v[50:51], v14 offset:33280
s_add_u32 m0, s59, 0xc000
s_nop 0
buffer_load_dwordx4 v6, s[4:7], s66 offen offset:0 lds
s_waitcnt lgkmcnt(10)
v_mfma_f32_32x32x16_bf16 a[16:31], a[252:255], v[36:39], 0
ds_read_b64_tr_b16 v[52:53], v15 offset:32768
ds_read_b64_tr_b16 v[54:55], v15 offset:33280
buffer_load_dwordx4 v7, s[4:7], s66 offen offset:1024 lds
s_waitcnt lgkmcnt(10)
v_mfma_f32_32x32x16_bf16 a[0:15], a[252:255], v[40:43], a[0:15]
ds_read_b64_tr_b16 v[56:57], v14 offset:34816
ds_read_b64_tr_b16 v[58:59], v14 offset:35328
buffer_load_dwordx4 v8, s[4:7], s66 offen offset:2048 lds
s_waitcnt lgkmcnt(10)
v_mfma_f32_32x32x16_bf16 a[16:31], a[252:255], v[44:47], a[16:31]
ds_read_b64_tr_b16 v[60:61], v15 offset:34816
ds_read_b64_tr_b16 v[62:63], v15 offset:35328
s_waitcnt lgkmcnt(8)
s_mov_b32 s60, 1664525
s_waitcnt vmcnt(14)
v_mul_lo_u32 v30, v30, s60
v_add_u32 v30, 1013904223, v30
s_nop 0
v_readfirstlane_b32 s52, v30
v_mov_b32 v100, 0
v_mov_b32 v101, 0
v_mov_b32 v102, 0
v_mov_b32 v103, 0
s_waitcnt vmcnt(13)
v_dot2c_f32_bf16 v100, s95, v240
v_dot2c_f32_bf16 v101, v240, v240
s_waitcnt vmcnt(12)
v_dot2c_f32_bf16 v102, s95, v244
v_dot2c_f32_bf16 v103, v244, v244
v_dot2c_f32_bf16 v100, s95, v241
v_dot2c_f32_bf16 v101, v241, v241
v_dot2c_f32_bf16 v102, s95, v245
v_dot2c_f32_bf16 v103, v245, v245
v_dot2c_f32_bf16 v100, s95, v242
v_dot2c_f32_bf16 v101, v242, v242
v_dot2c_f32_bf16 v102, s95, v246
v_dot2c_f32_bf16 v103, v246, v246
v_dot2c_f32_bf16 v100, s95, v243
v_dot2c_f32_bf16 v101, v243, v243
v_dot2c_f32_bf16 v102, s95, v247
v_dot2c_f32_bf16 v103, v247, v247
s_nop 1
v_permlane32_swap_b32 v100, v102
v_permlane32_swap_b32 v101, v103
v_add_f32 v100, v100, v102
v_add_f32 v101, v101, v103
s_nop 0
v_add_f32_dpp v100, v100, v100 row_ror:8 row_mask:0xf bank_mask:0xf
v_add_f32_dpp v101, v101, v101 row_ror:8 row_mask:0xf bank_mask:0xf
s_nop 0
v_add_f32_dpp v100, v100, v100 row_ror:4 row_mask:0xf bank_mask:0xf
v_add_f32_dpp v101, v101, v101 row_ror:4 row_mask:0xf bank_mask:0xf
s_nop 0
v_add_f32_dpp v100, v100, v100 row_ror:2 row_mask:0xf bank_mask:0xf
v_add_f32_dpp v101, v101, v101 row_ror:2 row_mask:0xf bank_mask:0xf
s_nop 0
v_add_f32_dpp v100, v100, v100 row_ror:1 row_mask:0xf bank_mask:0xf
v_add_f32_dpp v101, v101, v101 row_ror:1 row_mask:0xf bank_mask:0xf
s_nop 1
v_permlane16_swap_b32 v100, v101
v_add_f32 v100, v100, v101
v_mov_b32 v101, v100
s_nop 1
v_permlane16_swap_b32 v100, v101
v_mul_f32 v104, 0xbb000000, v100
v_mul_f32 v101, 0x3b000000, v101
v_fma_f32 v101, -v104, v104, v101
v_max_f32 v101, 0, v101
v_add_f32 v105, 0x3727c5ac, v101
v_rsq_f32 v105, v105
v_mov_b32 v102, 0x3727c5ac
v_mov_b32 v107, v30
v_mul_f32 v100, v105, v105
v_fma_f32 v100, v100, v101, v102
v_rsq_f32 v100, v100
v_lshrrev_b32 v102, 1, v0
s_add_u32 s73, s73, 0xd80000
v_mul_f32 v106, v100, v105
s_mov_b32 exec_lo, 1
s_mov_b32 exec_hi, 1
buffer_store_dwordx4 v[104:107], v102, s[40:43], s73 offen sc1
s_mov_b64 exec, -1
v_and_b32 v25, 0x7c, v29
s_lshl_b32 s60, s48, 9
s_add_u32 s60, s60, 0x24c00
v_add_u32 v25, s60, v25
ds_write_b32 v25, a0 offset:0
ds_write_b32 v25, a16 offset:128
s_waitcnt lgkmcnt(8)
v_mfma_f32_32x32x16_bf16 v[64:79], v[48:51], v[128:131], 0
ds_read_b64_tr_b16 v[32:33], v14 offset:36864
ds_read_b64_tr_b16 v[34:35], v14 offset:37376
buffer_load_dwordx4 v9, s[4:7], s66 offen offset:3072 lds
s_waitcnt lgkmcnt(8)
v_mfma_f32_32x32x16_bf16 v[80:95], v[52:55], v[128:131], 0
ds_read_b64_tr_b16 v[36:37], v15 offset:36864
ds_read_b64_tr_b16 v[38:39], v15 offset:37376
s_add_u32 m0, s59, 0x10000
s_add_u32 s64, s66, 0x80
buffer_load_dwordx4 v6, s[4:7], s64 offen offset:0 lds
s_waitcnt lgkmcnt(8)
v_mfma_f32_32x32x16_bf16 v[64:79], v[56:59], v[132:135], v[64:79]
ds_read_b64_tr_b16 v[40:41], v14 offset:38912
ds_read_b64_tr_b16 v[42:43], v14 offset:39424
buffer_load_dwordx4 v7, s[4:7], s64 offen offset:1024 lds
s_waitcnt vmcnt(11)
ds_read_b128 v[144:147], v10 offset:16384
ds_read_b128 v[148:151], v11 offset:16384
ds_read_b128 v[152:155], v12 offset:16384
ds_read_b128 v[156:159], v13 offset:16384
s_waitcnt lgkmcnt(12)
v_mfma_f32_32x32x16_bf16 v[80:95], v[60:63], v[132:135], v[80:95]
ds_read_b64_tr_b16 v[44:45], v15 offset:38912
ds_read_b64_tr_b16 v[46:47], v15 offset:39424
buffer_load_dwordx4 v8, s[4:7], s64 offen offset:2048 lds
s_waitcnt lgkmcnt(10)
v_mfma_f32_32x32x16_bf16 v[64:79], v[32:35], v[136:139], v[64:79]
ds_read_b64_tr_b16 v[48:49], v14 offset:40960
ds_read_b64_tr_b16 v[50:51], v14 offset:41472
s_waitcnt lgkmcnt(10)
v_mfma_f32_32x32x16_bf16 v[80:95], v[36:39], v[136:139], v[80:95]
ds_read_b64_tr_b16 v[52:53], v15 offset:40960
ds_read_b64_tr_b16 v[54:55], v15 offset:41472
buffer_load_dwordx4 v9, s[4:7], s64 offen offset:3072 lds
s_waitcnt lgkmcnt(10)
v_mfma_f32_32x32x16_bf16 v[64:79], v[40:43], v[140:143], v[64:79]
ds_read_b64_tr_b16 v[56:57], v14 offset:43008
ds_read_b64_tr_b16 v[58:59], v14 offset:43520
s_add_u32 m0, s59, 0x20000
s_mul_i32 s64, s71, 3072
s_add_u32 s64, s64, s76
s_add_u32 s64, s64, 0x400
buffer_load_dwordx4 v2, s[8:11], s64 offen offset:0 lds
s_waitcnt lgkmcnt(6)
v_mfma_f32_32x32x16_bf16 v[80:95], v[44:47], v[140:143], v[80:95]
ds_read_b64_tr_b16 v[60:61], v15 offset:43008
ds_read_b64_tr_b16 v[62:63], v15 offset:43520
buffer_load_dwordx4 v3, s[8:11], s64 offen offset:1024 lds
s_waitcnt lgkmcnt(6)
v_mfma_f32_32x32x16_bf16 v[64:79], v[48:51], v[144:147], v[64:79]
ds_read_b64_tr_b16 v[32:33], v14 offset:45056
ds_read_b64_tr_b16 v[34:35], v14 offset:45568
buffer_load_dwordx4 v4, s[8:11], s64 offen offset:2048 lds
s_waitcnt lgkmcnt(6)
v_mfma_f32_32x32x16_bf16 v[80:95], v[52:55], v[144:147], v[80:95]
ds_read_b64_tr_b16 v[36:37], v15 offset:45056
ds_read_b64_tr_b16 v[38:39], v15 offset:45568
s_waitcnt lgkmcnt(6)
v_mfma_f32_32x32x16_bf16 v[64:79], v[56:59], v[148:151], v[64:79]
ds_read_b64_tr_b16 v[40:41], v14 offset:47104
ds_read_b64_tr_b16 v[42:43], v14 offset:47616
buffer_load_dwordx4 v5, s[8:11], s64 offen offset:3072 lds
s_waitcnt vmcnt(13)
s_barrier
s_waitcnt vmcnt(8)
ds_read_b128 v[160:163], v10 offset:49152
ds_read_b128 v[164:167], v11 offset:49152
ds_read_b128 v[168:171], v12 offset:49152
ds_read_b128 v[172:175], v13 offset:49152
s_waitcnt lgkmcnt(10)
v_mfma_f32_32x32x16_bf16 v[80:95], v[60:63], v[148:151], v[80:95]
ds_read_b64_tr_b16 v[44:45], v15 offset:47104
ds_read_b64_tr_b16 v[46:47], v15 offset:47616
s_add_u32 m0, s59, 0x18000
s_nop 0
buffer_load_dwordx4 v6, s[4:7], s67 offen offset:0 lds
s_waitcnt lgkmcnt(10)
v_mfma_f32_32x32x16_bf16 v[64:79], v[32:35], v[152:155], v[64:79]
v_add_u32 v14, 0x14000, v14
ds_read_b64_tr_b16 v[48:49], v14 offset:0
ds_read_b64_tr_b16 v[50:51], v14 offset:512
buffer_load_dwordx4 v7, s[4:7], s67 offen offset:1024 lds
v_add_u32 v25, 0x24c00, v29
ds_read2st64_b32 v[108:109], v25 offset0:0 offset1:2
s_waitcnt lgkmcnt(11)
v_mfma_f32_32x32x16_bf16 v[80:95], v[36:39], v[152:155], v[80:95]
v_add_u32 v15, 0x14000, v15
ds_read_b64_tr_b16 v[52:53], v15 offset:0
ds_read_b64_tr_b16 v[54:55], v15 offset:512
buffer_load_dwordx4 v8, s[4:7], s67 offen offset:2048 lds
ds_read2st64_b32 v[110:111], v25 offset0:4 offset1:6
s_waitcnt lgkmcnt(12)
v_mfma_f32_32x32x16_bf16 v[64:79], v[40:43], v[156:159], v[64:79]
ds_read_b64_tr_b16 v[56:57], v14 offset:2048
ds_read_b64_tr_b16 v[58:59], v14 offset:2560
s_waitcnt lgkmcnt(8)
v_mfma_f32_32x32x16_bf16 v[80:95], v[44:47], v[156:159], v[80:95]
ds_read_b64_tr_b16 v[60:61], v15 offset:2048
ds_read_b64_tr_b16 v[62:63], v15 offset:2560
buffer_load_dwordx4 v9, s[4:7], s67 offen offset:3072 lds
s_waitcnt lgkmcnt(8)
v_mfma_f32_32x32x16_bf16 v[64:79], v[48:51], v[160:163], v[64:79]
ds_read_b64_tr_b16 v[32:33], v14 offset:4096
ds_read_b64_tr_b16 v[34:35], v14 offset:4608
s_add_u32 m0, s59, 0x1c000
s_add_u32 s64, s67, 0x80
buffer_load_dwordx4 v6, s[4:7], s64 offen offset:0 lds
s_waitcnt lgkmcnt(7)
v_mfma_f32_32x32x16_bf16 v[80:95], v[52:55], v[160:163], v[80:95]
ds_read_b64_tr_b16 v[36:37], v15 offset:4096
ds_read_b64_tr_b16 v[38:39], v15 offset:4608
buffer_load_dwordx4 v7, s[4:7], s64 offen offset:1024 lds
v_lshlrev_b32 v25, 3, v0
v_add_f32 v108, v108, v109
s_waitcnt lgkmcnt(6)
v_mfma_f32_32x32x16_bf16 v[64:79], v[56:59], v[164:167], v[64:79]
ds_read_b64_tr_b16 v[40:41], v14 offset:6144
ds_read_b64_tr_b16 v[42:43], v14 offset:6656
buffer_load_dwordx4 v8, s[4:7], s64 offen offset:2048 lds
v_add_f32 v110, v110, v111
v_mov_b32 v109, v30
s_waitcnt vmcnt(11)
v_add_u32 v10, 0x10000, v10
ds_read_b128 v[176:179], v10 offset:0
v_add_u32 v11, 0x10000, v11
ds_read_b128 v[180:183], v11 offset:0
v_add_u32 v12, 0x10000, v12
ds_read_b128 v[184:187], v12 offset:0
v_add_u32 v13, 0x10000, v13
ds_read_b128 v[188:191], v13 offset:0
s_waitcnt lgkmcnt(10)
v_mfma_f32_32x32x16_bf16 v[80:95], v[60:63], v[164:167], v[80:95]
ds_read_b64_tr_b16 v[44:45], v15 offset:6144
ds_read_b64_tr_b16 v[46:47], v15 offset:6656
v_add_f32 v108, v108, v110
s_lshl_b32 s60, s49, 4
s_add_u32 s60, s60, s50
s_lshl_b32 s60, s60, 10
s_add_u32 s60, s60, 0xda0000
s_mov_b64 exec, s[84:85]
buffer_store_dwordx2 v[108:109], v25, s[40:43], s60 offen offset:0 sc1
s_mov_b64 exec, -1
s_waitcnt lgkmcnt(10)
v_mfma_f32_32x32x16_bf16 v[64:79], v[32:35], v[168:171], v[64:79]
ds_read_b64_tr_b16 v[48:49], v14 offset:8192
ds_read_b64_tr_b16 v[50:51], v14 offset:8704
buffer_load_dwordx4 v9, s[4:7], s64 offen offset:3072 lds
s_waitcnt lgkmcnt(10)
v_mfma_f32_32x32x16_bf16 v[80:95], v[36:39], v[168:171], v[80:95]
ds_read_b64_tr_b16 v[52:53], v15 offset:8192
ds_read_b64_tr_b16 v[54:55], v15 offset:8704
s_add_u32 m0, s59, 0x0
s_mul_i32 s64, s72, 3072
s_add_u32 s64, s64, s76
s_add_u32 s64, s64, 0x400
buffer_load_dwordx4 v2, s[8:11], s64 offen offset:0 lds
s_waitcnt lgkmcnt(10)
v_mfma_f32_32x32x16_bf16 v[64:79], v[40:43], v[172:175], v[64:79]
ds_read_b64_tr_b16 v[56:57], v14 offset:10240
ds_read_b64_tr_b16 v[58:59], v14 offset:10752
buffer_load_dwordx4 v3, s[8:11], s64 offen offset:1024 lds
s_waitcnt lgkmcnt(6)
v_mfma_f32_32x32x16_bf16 v[80:95], v[44:47], v[172:175], v[80:95]
ds_read_b64_tr_b16 v[60:61], v15 offset:10240
ds_read_b64_tr_b16 v[62:63], v15 offset:10752
buffer_load_dwordx4 v4, s[8:11], s64 offen offset:2048 lds
s_waitcnt lgkmcnt(6)
v_mfma_f32_32x32x16_bf16 v[64:79], v[48:51], v[176:179], v[64:79]
ds_read_b64_tr_b16 v[32:33], v14 offset:12288
ds_read_b64_tr_b16 v[34:35], v14 offset:12800
s_waitcnt lgkmcnt(6)
v_mfma_f32_32x32x16_bf16 v[80:95], v[52:55], v[176:179], v[80:95]
ds_read_b64_tr_b16 v[36:37], v15 offset:12288
ds_read_b64_tr_b16 v[38:39], v15 offset:12800
buffer_load_dwordx4 v5, s[8:11], s64 offen offset:3072 lds
s_waitcnt lgkmcnt(6)
v_mfma_f32_32x32x16_bf16 v[64:79], v[56:59], v[180:183], v[64:79]
ds_read_b64_tr_b16 v[40:41], v14 offset:14336
ds_read_b64_tr_b16 v[42:43], v14 offset:14848
s_add_u32 m0, s59, 0x4000
s_nop 0
buffer_load_dwordx4 v6, s[4:7], s68 offen offset:0 lds
s_waitcnt vmcnt(14)
s_barrier
s_waitcnt vmcnt(10)
ds_read_b128 v[192:195], v10 offset:32768
ds_read_b128 v[196:199], v11 offset:32768
ds_read_b128 v[200:203], v12 offset:32768
ds_read_b128 v[204:207], v13 offset:32768
s_waitcnt lgkmcnt(10)
v_mfma_f32_32x32x16_bf16 v[80:95], v[60:63], v[180:183], v[80:95]
ds_read_b64_tr_b16 v[44:45], v15 offset:14336
ds_read_b64_tr_b16 v[46:47], v15 offset:14848
buffer_load_dwordx4 v7, s[4:7], s68 offen offset:1024 lds
s_waitcnt lgkmcnt(10)
v_mfma_f32_32x32x16_bf16 v[64:79], v[32:35], v[184:187], v[64:79]
ds_read_b64_tr_b16 v[48:49], v14 offset:49152
ds_read_b64_tr_b16 v[50:51], v14 offset:49664
buffer_load_dwordx4 v8, s[4:7], s68 offen offset:2048 lds
s_waitcnt lgkmcnt(10)
v_mfma_f32_32x32x16_bf16 v[80:95], v[36:39], v[184:187], v[80:95]
ds_read_b64_tr_b16 v[52:53], v15 offset:49152
ds_read_b64_tr_b16 v[54:55], v15 offset:49664
s_waitcnt lgkmcnt(10)
v_mfma_f32_32x32x16_bf16 v[64:79], v[40:43], v[188:191], v[64:79]
ds_read_b64_tr_b16 v[56:57], v14 offset:51200
ds_read_b64_tr_b16 v[58:59], v14 offset:51712
buffer_load_dwordx4 v9, s[4:7], s68 offen offset:3072 lds
s_waitcnt lgkmcnt(6)
v_mfma_f32_32x32x16_bf16 v[80:95], v[44:47], v[188:191], v[80:95]
ds_read_b64_tr_b16 v[60:61], v15 offset:51200
ds_read_b64_tr_b16 v[62:63], v15 offset:51712
s_add_u32 m0, s59, 0xc000
s_add_u32 s64, s68, 0x80
buffer_load_dwordx4 v6, s[4:7], s64 offen offset:0 lds
s_waitcnt lgkmcnt(6)
v_mfma_f32_32x32x16_bf16 v[64:79], v[48:51], v[192:195], v[64:79]
ds_read_b64_tr_b16 v[32:33], v14 offset:53248
ds_read_b64_tr_b16 v[34:35], v14 offset:53760
buffer_load_dwordx4 v7, s[4:7], s64 offen offset:1024 lds
s_waitcnt lgkmcnt(6)
v_mfma_f32_32x32x16_bf16 v[80:95], v[52:55], v[192:195], v[80:95]
ds_read_b64_tr_b16 v[36:37], v15 offset:53248
ds_read_b64_tr_b16 v[38:39], v15 offset:53760
buffer_load_dwordx4 v8, s[4:7], s64 offen offset:2048 lds
s_waitcnt lgkmcnt(6)
v_mfma_f32_32x32x16_bf16 v[64:79], v[56:59], v[196:199], v[64:79]
ds_read_b64_tr_b16 v[40:41], v14 offset:55296
ds_read_b64_tr_b16 v[42:43], v14 offset:55808
s_waitcnt vmcnt(11)
ds_read_b128 v[208:211], v10 offset:49152
ds_read_b128 v[212:215], v11 offset:49152
ds_read_b128 v[216:219], v12 offset:49152
ds_read_b128 v[220:223], v13 offset:49152
s_waitcnt lgkmcnt(10)
v_mfma_f32_32x32x16_bf16 v[80:95], v[60:63], v[196:199], v[80:95]
ds_read_b64_tr_b16 v[44:45], v15 offset:55296
ds_read_b64_tr_b16 v[46:47], v15 offset:55808
buffer_load_dwordx4 v9, s[4:7], s64 offen offset:3072 lds
s_waitcnt lgkmcnt(10)
v_mfma_f32_32x32x16_bf16 v[64:79], v[32:35], v[200:203], v[64:79]
ds_read_b64_tr_b16 v[48:49], v14 offset:57344
ds_read_b64_tr_b16 v[50:51], v14 offset:57856
s_lshl_b32 s88, s58, 10
s_add_u32 m0, s88, 0x24000
s_lshl_b32 s64, s51, 11
s_add_u32 s64, s64, s88
buffer_load_dwordx4 v1, s[12:15], s64 offen lds
s_waitcnt lgkmcnt(10)
v_mfma_f32_32x32x16_bf16 v[80:95], v[36:39], v[200:203], v[80:95]
ds_read_b64_tr_b16 v[52:53], v15 offset:57344
ds_read_b64_tr_b16 v[54:55], v15 offset:57856
s_waitcnt lgkmcnt(10)
v_mfma_f32_32x32x16_bf16 v[64:79], v[40:43], v[204:207], v[64:79]
ds_read_b64_tr_b16 v[56:57], v14 offset:59392
ds_read_b64_tr_b16 v[58:59], v14 offset:59904
v_accvgpr_read_b32 v126, a94
s_lshl_b32 s88, s48, 11
s_add_u32 m0, s88, 0x26000
s_lshr_b32 s64, s55, 1
s_lshl_b32 s64, s64, 16
s_add_u32 s64, s64, s56
buffer_load_dwordx4 v126, s[4:7], s64 offen offset:0 lds
v_accvgpr_read_b32 v28, a88
s_lshl_b32 s62, s74, 9
s_add_u32 s62, s62, 0xd80000
buffer_load_dwordx4 v[112:115], v28, s[40:43], s62 offen sc1
s_waitcnt lgkmcnt(6)
v_mfma_f32_32x32x16_bf16 v[80:95], v[44:47], v[204:207], v[80:95]
ds_read_b64_tr_b16 v[60:61], v15 offset:59392
ds_read_b64_tr_b16 v[62:63], v15 offset:59904
s_waitcnt lgkmcnt(6)
v_mfma_f32_32x32x16_bf16 v[64:79], v[48:51], v[208:211], v[64:79]
ds_read_b64_tr_b16 v[32:33], v14 offset:61440
ds_read_b64_tr_b16 v[34:35], v14 offset:61952
v_xor_b32 v126, 64, v126
v_add_u32 v126, 0x1c00, v126
buffer_load_dwordx4 v126, s[4:7], s64 offen offset:1024 lds
v_lshlrev_b32 v22, 3, v0
s_and_b32 s97, s49, 12
s_lshl_b32 s97, s97, 4
s_add_u32 s97, s97, s50
s_lshl_b32 s97, s97, 10
s_add_u32 s97, s97, 0xda0000
s_add_u32 s98, s97, 0x4000
s_add_u32 s100, s97, 0x8000
s_add_u32 s101, s97, 0xc000
buffer_load_dwordx2 v[96:97], v22, s[40:43], s97 offen offset:0 sc1
buffer_load_dwordx2 v[98:99], v22, s[40:43], s98 offen offset:0 sc1
buffer_load_dwordx2 v[100:101], v22, s[40:43], s100 offen offset:0 sc1
buffer_load_dwordx2 v[102:103], v22, s[40:43], s101 offen offset:0 sc1
s_waitcnt lgkmcnt(6)
v_mfma_f32_32x32x16_bf16 v[80:95], v[52:55], v[208:211], v[80:95]
ds_read_b64_tr_b16 v[36:37], v15 offset:61440
ds_read_b64_tr_b16 v[38:39], v15 offset:61952
s_add_u32 m0, s59, 0x10000
s_mul_i32 s64, s69, 3072
s_add_u32 s64, s64, s76
s_add_u32 s64, s64, 0x800
buffer_load_dwordx4 v2, s[8:11], s64 offen offset:0 lds
s_waitcnt lgkmcnt(6)
v_mfma_f32_32x32x16_bf16 v[64:79], v[56:59], v[212:215], v[64:79]
ds_read_b64_tr_b16 v[40:41], v14 offset:63488
ds_read_b64_tr_b16 v[42:43], v14 offset:64000
buffer_load_dwordx4 v3, s[8:11], s64 offen offset:1024 lds
s_waitcnt vmcnt(9)
s_barrier
v_add_u32 v10, 0xffff4000, v10
ds_read_b128 v[224:227], v10 offset:0
v_add_u32 v11, 0xffff4000, v11
ds_read_b128 v[228:231], v11 offset:0
v_add_u32 v12, 0xffff4000, v12
ds_read_b128 v[232:235], v12 offset:0
v_add_u32 v13, 0xffff4000, v13
ds_read_b128 v[236:239], v13 offset:0
s_waitcnt lgkmcnt(10)
v_mfma_f32_32x32x16_bf16 v[80:95], v[60:63], v[212:215], v[80:95]
ds_read_b64_tr_b16 v[44:45], v15 offset:63488
ds_read_b64_tr_b16 v[46:47], v15 offset:64000
buffer_load_dwordx4 v4, s[8:11], s64 offen offset:2048 lds
s_waitcnt lgkmcnt(10)
v_mfma_f32_32x32x16_bf16 v[64:79], v[32:35], v[216:219], v[64:79]
v_add_u32 v14, 0xfffec000, v14
ds_read_b64_tr_b16 v[48:49], v14 offset:0
ds_read_b64_tr_b16 v[50:51], v14 offset:512
s_waitcnt lgkmcnt(10)
v_mfma_f32_32x32x16_bf16 v[80:95], v[36:39], v[216:219], v[80:95]
v_add_u32 v15, 0xfffec000, v15
ds_read_b64_tr_b16 v[52:53], v15 offset:0
ds_read_b64_tr_b16 v[54:55], v15 offset:512
buffer_load_dwordx4 v5, s[8:11], s64 offen offset:3072 lds
s_waitcnt lgkmcnt(10)
v_mfma_f32_32x32x16_bf16 v[64:79], v[40:43], v[220:223], v[64:79]
ds_read_b64_tr_b16 v[56:57], v14 offset:2048
ds_read_b64_tr_b16 v[58:59], v14 offset:2560
s_add_u32 m0, s59, 0x8000
s_mul_i32 s64, s70, 3072
s_add_u32 s64, s64, s76
s_add_u32 s64, s64, 0x800
buffer_load_dwordx4 v2, s[8:11], s64 offen offset:0 lds
s_waitcnt lgkmcnt(6)
v_mfma_f32_32x32x16_bf16 v[80:95], v[44:47], v[220:223], v[80:95]
ds_read_b64_tr_b16 v[60:61], v15 offset:2048
ds_read_b64_tr_b16 v[62:63], v15 offset:2560
buffer_load_dwordx4 v3, s[8:11], s64 offen offset:1024 lds
s_waitcnt lgkmcnt(6)
v_mfma_f32_32x32x16_bf16 v[64:79], v[48:51], v[224:227], v[64:79]
ds_read_b64_tr_b16 v[32:33], v14 offset:4096
ds_read_b64_tr_b16 v[34:35], v14 offset:4608
buffer_load_dwordx4 v4, s[8:11], s64 offen offset:2048 lds
s_waitcnt lgkmcnt(6)
v_mfma_f32_32x32x16_bf16 v[80:95], v[52:55], v[224:227], v[80:95]
ds_read_b64_tr_b16 v[36:37], v15 offset:4096
ds_read_b64_tr_b16 v[38:39], v15 offset:4608
s_waitcnt lgkmcnt(6)
v_mfma_f32_32x32x16_bf16 v[64:79], v[56:59], v[228:231], v[64:79]
ds_read_b64_tr_b16 v[40:41], v14 offset:6144
ds_read_b64_tr_b16 v[42:43], v14 offset:6656
buffer_load_dwordx4 v5, s[8:11], s64 offen offset:3072 lds
ds_read_b128 v[240:243], v10 offset:32768
ds_read_b128 v[244:247], v11 offset:32768
ds_read_b128 v[248:251], v12 offset:32768
ds_read_b128 v[252:255], v13 offset:32768
s_waitcnt lgkmcnt(10)
v_mfma_f32_32x32x16_bf16 v[80:95], v[60:63], v[228:231], v[80:95]
ds_read_b64_tr_b16 v[44:45], v15 offset:6144
ds_read_b64_tr_b16 v[46:47], v15 offset:6656
s_add_u32 m0, s59, 0x18000
s_mul_i32 s64, s71, 3072
s_add_u32 s64, s64, s76
s_add_u32 s64, s64, 0x800
buffer_load_dwordx4 v2, s[8:11], s64 offen offset:0 lds
s_waitcnt lgkmcnt(10)
v_mfma_f32_32x32x16_bf16 v[64:79], v[32:35], v[232:235], v[64:79]
ds_read_b64_tr_b16 v[48:49], v14 offset:8192
ds_read_b64_tr_b16 v[50:51], v14 offset:8704
buffer_load_dwordx4 v3, s[8:11], s64 offen offset:1024 lds
s_waitcnt lgkmcnt(10)
v_mfma_f32_32x32x16_bf16 v[80:95], v[36:39], v[232:235], v[80:95]
ds_read_b64_tr_b16 v[52:53], v15 offset:8192
ds_read_b64_tr_b16 v[54:55], v15 offset:8704
buffer_load_dwordx4 v4, s[8:11], s64 offen offset:2048 lds
s_waitcnt lgkmcnt(10)
v_mfma_f32_32x32x16_bf16 v[64:79], v[40:43], v[236:239], v[64:79]
ds_read_b64_tr_b16 v[56:57], v14 offset:10240
ds_read_b64_tr_b16 v[58:59], v14 offset:10752
s_waitcnt lgkmcnt(6)
v_mfma_f32_32x32x16_bf16 v[80:95], v[44:47], v[236:239], v[80:95]
ds_read_b64_tr_b16 v[60:61], v15 offset:10240
ds_read_b64_tr_b16 v[62:63], v15 offset:10752
buffer_load_dwordx4 v5, s[8:11], s64 offen offset:3072 lds
s_waitcnt lgkmcnt(6)
v_mfma_f32_32x32x16_bf16 v[64:79], v[48:51], v[240:243], v[64:79]
ds_read_b64_tr_b16 v[32:33], v14 offset:12288
ds_read_b64_tr_b16 v[34:35], v14 offset:12800
s_add_u32 m0, s59, 0x1c000
s_mul_i32 s64, s72, 3072
s_add_u32 s64, s64, s76
s_add_u32 s64, s64, 0x800
buffer_load_dwordx4 v2, s[8:11], s64 offen offset:0 lds
s_waitcnt vmcnt(16)
v_xor_b32 v104, s52, v97
s_waitcnt vmcnt(15)
v_xor_b32 v105, s52, v99
v_or_b32 v104, v104, v105
s_waitcnt vmcnt(14)
v_xor_b32 v105, s52, v101
v_or_b32 v104, v104, v105
s_waitcnt vmcnt(13)
v_xor_b32 v105, s52, v103
v_or_b32 v104, v104, v105
v_cmp_ne_u32 vcc, 0, v104
s_nop 4
s_cbranch_vccz Lok_12
s_mov_b32 s73, 0x8000
Lpoll_13:
buffer_load_dwordx2 v[96:97], v22, s[40:43], s97 offen offset:0 sc1
buffer_load_dwordx2 v[98:99], v22, s[40:43], s98 offen offset:0 sc1
buffer_load_dwordx2 v[100:101], v22, s[40:43], s100 offen offset:0 sc1
buffer_load_dwordx2 v[102:103], v22, s[40:43], s101 offen offset:0 sc1
s_waitcnt vmcnt(0)
s_sub_u32 s73, s73, 1
s_cbranch_scc1 Lok_12
v_xor_b32 v104, s52, v97
v_xor_b32 v105, s52, v99
v_or_b32 v104, v104, v105
v_xor_b32 v105, s52, v101
v_or_b32 v104, v104, v105
v_xor_b32 v105, s52, v103
v_or_b32 v104, v104, v105
v_cmp_ne_u32 vcc, 0, v104
s_nop 4
s_cbranch_vccnz Lpoll_13
Lok_12:
s_lshl_b32 s60, s48, 9
s_add_u32 s60, s60, 0x25400
v_add_u32 v22, s60, v29
v_add_f32 v96, v96, v98
v_add_f32 v100, v100, v102
v_lshrrev_b32 v25, 5, v0
v_add_f32 v96, v96, v100
ds_write_b32 v22, v96 offset:0
v_lshl_add_u32 v25, v25, 4, s60
s_waitcnt lgkmcnt(7)
v_mfma_f32_32x32x16_bf16 v[80:95], v[52:55], v[240:243], v[80:95]
ds_read_b64_tr_b16 v[36:37], v15 offset:12288
ds_read_b64_tr_b16 v[38:39], v15 offset:12800
buffer_load_dwordx4 v3, s[8:11], s64 offen offset:1024 lds
ds_read_b128 v[96:99], v25 offset:0
ds_read_b128 v[100:103], v25 offset:32
s_waitcnt lgkmcnt(9)
v_mfma_f32_32x32x16_bf16 v[64:79], v[56:59], v[244:247], v[64:79]
ds_read_b64_tr_b16 v[40:41], v14 offset:14336
ds_read_b64_tr_b16 v[42:43], v14 offset:14848
ds_read_b128 v[104:107], v25 offset:64
ds_read_b128 v[108:111], v25 offset:96
s_waitcnt lgkmcnt(11)
v_mfma_f32_32x32x16_bf16 v[80:95], v[60:63], v[244:247], v[80:95]
ds_read_b64_tr_b16 v[44:45], v15 offset:14336
ds_read_b64_tr_b16 v[46:47], v15 offset:14848
v_cmp_ne_u32 vcc, s52, v115
s_nop 4
s_cbranch_vccz Lok_14
s_mov_b32 s73, 0x8000
Lpoll_15:
buffer_load_dwordx4 v[112:115], v28, s[40:43], s62 offen sc1
s_sub_u32 s73, s73, 1
s_waitcnt vmcnt(0)
s_cbranch_scc1 Lok_14
v_cmp_ne_u32 vcc, s52, v115
s_nop 4
s_cbranch_vccnz Lpoll_15
Lok_14:
s_waitcnt lgkmcnt(11)
v_mfma_f32_32x32x16_bf16 v[64:79], v[32:35], v[248:251], v[64:79]
v_mov_b32 v26, v112
s_waitcnt lgkmcnt(8)
v_mfma_f32_32x32x16_bf16 v[80:95], v[36:39], v[248:251], v[80:95]
s_waitcnt lgkmcnt(4)
v_mfma_f32_32x32x16_bf16 v[64:79], v[40:43], v[252:255], v[64:79]
v_mov_b32 v27, v113
s_waitcnt lgkmcnt(0)
v_mfma_f32_32x32x16_bf16 v[80:95], v[44:47], v[252:255], v[80:95]
s_nop 8
v_pk_fma_f32 v[64:65], v[96:97], v[26:27], v[64:65] op_sel_hi:[1,0,1]
v_pk_fma_f32 v[66:67], v[98:99], v[26:27], v[66:67] op_sel_hi:[1,0,1]
v_pk_fma_f32 v[68:69], v[100:101], v[26:27], v[68:69] op_sel_hi:[1,0,1]
v_pk_fma_f32 v[70:71], v[102:103], v[26:27], v[70:71] op_sel_hi:[1,0,1]
v_pk_fma_f32 v[72:73], v[104:105], v[26:27], v[72:73] op_sel_hi:[1,0,1]
v_pk_fma_f32 v[74:75], v[106:107], v[26:27], v[74:75] op_sel_hi:[1,0,1]
v_pk_fma_f32 v[76:77], v[108:109], v[26:27], v[76:77] op_sel_hi:[1,0,1]
v_pk_fma_f32 v[78:79], v[110:111], v[26:27], v[78:79] op_sel_hi:[1,0,1]
v_pk_mul_f32 v[64:65], v[64:65], v[26:27] op_sel:[0,1] op_sel_hi:[1,1]
v_pk_mul_f32 v[66:67], v[66:67], v[26:27] op_sel:[0,1] op_sel_hi:[1,1]
v_pk_mul_f32 v[68:69], v[68:69], v[26:27] op_sel:[0,1] op_sel_hi:[1,1]
v_pk_mul_f32 v[70:71], v[70:71], v[26:27] op_sel:[0,1] op_sel_hi:[1,1]
v_pk_mul_f32 v[72:73], v[72:73], v[26:27] op_sel:[0,1] op_sel_hi:[1,1]
v_pk_mul_f32 v[74:75], v[74:75], v[26:27] op_sel:[0,1] op_sel_hi:[1,1]
v_pk_mul_f32 v[76:77], v[76:77], v[26:27] op_sel:[0,1] op_sel_hi:[1,1]
v_pk_mul_f32 v[78:79], v[78:79], v[26:27] op_sel:[0,1] op_sel_hi:[1,1]
ds_read_b128 v[96:99], v25 offset:128
ds_read_b128 v[100:103], v25 offset:160
ds_read_b128 v[104:107], v25 offset:192
ds_read_b128 v[108:111], v25 offset:224
v_accvgpr_read_b32 v22, a92
ds_read_b64_tr_b16 v[112:113], v22 offset:0
ds_read_b64_tr_b16 v[114:115], v22 offset:256
ds_read_b64_tr_b16 v[116:117], v22 offset:1024
ds_read_b64_tr_b16 v[118:119], v22 offset:1280
v_cvt_pk_bf16_f32 v48, v64, v65
v_cvt_pk_bf16_f32 v49, v66, v67
v_cvt_pk_bf16_f32 v50, v68, v69
v_cvt_pk_bf16_f32 v51, v70, v71
v_cvt_pk_bf16_f32 v52, v72, v73
v_cvt_pk_bf16_f32 v53, v74, v75
v_cvt_pk_bf16_f32 v54, v76, v77
v_cvt_pk_bf16_f32 v55, v78, v79
s_waitcnt lgkmcnt(7)
v_pk_fma_f32 v[80:81], v[96:97], v[26:27], v[80:81] op_sel_hi:[1,0,1]
v_pk_fma_f32 v[82:83], v[98:99], v[26:27], v[82:83] op_sel_hi:[1,0,1]
s_waitcnt lgkmcnt(6)
v_pk_fma_f32 v[84:85], v[100:101], v[26:27], v[84:85] op_sel_hi:[1,0,1]
v_pk_fma_f32 v[86:87], v[102:103], v[26:27], v[86:87] op_sel_hi:[1,0,1]
s_waitcnt lgkmcnt(5)
v_pk_fma_f32 v[88:89], v[104:105], v[26:27], v[88:89] op_sel_hi:[1,0,1]
v_pk_fma_f32 v[90:91], v[106:107], v[26:27], v[90:91] op_sel_hi:[1,0,1]
s_waitcnt lgkmcnt(4)
v_pk_fma_f32 v[92:93], v[108:109], v[26:27], v[92:93] op_sel_hi:[1,0,1]
v_pk_fma_f32 v[94:95], v[110:111], v[26:27], v[94:95] op_sel_hi:[1,0,1]
v_pk_mul_f32 v[80:81], v[80:81], v[26:27] op_sel:[0,1] op_sel_hi:[1,1]
v_pk_mul_f32 v[82:83], v[82:83], v[26:27] op_sel:[0,1] op_sel_hi:[1,1]
v_pk_mul_f32 v[84:85], v[84:85], v[26:27] op_sel:[0,1] op_sel_hi:[1,1]
v_pk_mul_f32 v[86:87], v[86:87], v[26:27] op_sel:[0,1] op_sel_hi:[1,1]
v_pk_mul_f32 v[88:89], v[88:89], v[26:27] op_sel:[0,1] op_sel_hi:[1,1]
v_pk_mul_f32 v[90:91], v[90:91], v[26:27] op_sel:[0,1] op_sel_hi:[1,1]
v_pk_mul_f32 v[92:93], v[92:93], v[26:27] op_sel:[0,1] op_sel_hi:[1,1]
v_pk_mul_f32 v[94:95], v[94:95], v[26:27] op_sel:[0,1] op_sel_hi:[1,1]
s_waitcnt lgkmcnt(3)
v_cndmask_b32 v32, v112, 0, s[80:81]
v_cndmask_b32 v36, 0, v112, s[80:81]
v_cndmask_b32 v33, v113, 0, s[80:81]
v_cndmask_b32 v37, 0, v113, s[80:81]
s_waitcnt lgkmcnt(2)
v_cndmask_b32 v34, v114, 0, s[80:81]
v_cndmask_b32 v38, 0, v114, s[80:81]
v_cndmask_b32 v35, v115, 0, s[80:81]
v_cndmask_b32 v39, 0, v115, s[80:81]
s_waitcnt lgkmcnt(1)
v_cndmask_b32 v40, v116, 0, s[80:81]
v_cndmask_b32 v44, 0, v116, s[80:81]
v_cndmask_b32 v41, v117, 0, s[80:81]
v_cndmask_b32 v45, 0, v117, s[80:81]
s_waitcnt lgkmcnt(0)
v_cndmask_b32 v42, v118, 0, s[80:81]
v_cndmask_b32 v46, 0, v118, s[80:81]
v_cndmask_b32 v43, v119, 0, s[80:81]
v_cndmask_b32 v47, 0, v119, s[80:81]
v_cvt_pk_bf16_f32 v56, v80, v81
v_cvt_pk_bf16_f32 v57, v82, v83
v_cvt_pk_bf16_f32 v58, v84, v85
v_cvt_pk_bf16_f32 v59, v86, v87
v_cvt_pk_bf16_f32 v60, v88, v89
v_cvt_pk_bf16_f32 v61, v90, v91
v_cvt_pk_bf16_f32 v62, v92, v93
v_cvt_pk_bf16_f32 v63, v94, v95
v_mfma_f32_32x32x16_bf16 v[64:79], v[32:35], v[48:51], 0
v_mfma_f32_32x32x16_bf16 v[96:111], v[40:43], v[56:59], 0
v_mfma_f32_32x32x16_bf16 v[64:79], v[36:39], v[52:55], v[64:79]
v_mfma_f32_32x32x16_bf16 v[96:111], v[44:47], v[60:63], v[96:111]
buffer_load_dwordx4 v4, s[8:11], s64 offen offset:2048 lds
buffer_load_dwordx4 v5, s[8:11], s64 offen offset:3072 lds
s_add_u32 s88, s49, 0
s_add_u32 s65, s88, 0
s_and_b32 s65, s65, 3
s_lshl_b32 s65, s65, 7
s_add_u32 s66, s88, 1
s_and_b32 s66, s66, 3
s_lshl_b32 s66, s66, 7
s_add_u32 s67, s88, 2
s_and_b32 s67, s67, 3
s_lshl_b32 s67, s67, 7
s_add_u32 s68, s88, 3
s_and_b32 s68, s68, 3
s_lshl_b32 s68, s68, 7
v_accvgpr_read_b32 v6, a90
v_add_u32 v7, 0x1c00, v6
v_add_u32 v8, 0x3800, v6
v_add_u32 v9, 0x5400, v6
s_add_u32 m0, s59, 0x14000
s_mul_i32 s64, s65, 512
s_add_u32 s64, s64, s56
buffer_load_dwordx4 v6, s[24:27], s64 offen offset:0 lds
v_max3_f32 v48, v64, v65, v66
v_max3_f32 v52, v72, v73, v74
v_min3_f32 v49, v64, v65, v66
v_min3_f32 v53, v72, v73, v74
v_max3_f32 v48, v48, v67, v68
v_max3_f32 v52, v52, v75, v76
v_min3_f32 v49, v49, v67, v68
v_min3_f32 v53, v53, v75, v76
v_max3_f32 v48, v48, v69, v70
v_max3_f32 v52, v52, v77, v78
v_min3_f32 v49, v49, v69, v70
v_min3_f32 v53, v53, v77, v78
v_max_f32 v48, v48, v71
v_max_f32 v52, v52, v79
v_min_f32 v49, v49, v71
v_min_f32 v53, v53, v79
v_mul_f32 v48, 0x3fb8aa3b, v48
v_mul_f32 v52, 0x3fb8aa3b, v52
v_mul_f32 v49, 0xbfb8aa3b, v49
v_mul_f32 v53, 0xbfb8aa3b, v53
s_nop 0
v_permlane32_swap_b32 v48, v49
v_permlane32_swap_b32 v52, v53
v_max_f32 v48, v48, v49
v_max_f32 v52, v52, v53
buffer_load_dwordx4 v7, s[24:27], s64 offen offset:1024 lds
v_mov_b32 v49, v48
v_mov_b32 v53, v52
s_nop 0
v_permlane32_swap_b32 v48, v49
v_permlane32_swap_b32 v52, v53
v_pk_fma_f32 v[32:33], v[64:65], s[78:79], v[48:49] op_sel_hi:[1,0,0] neg_lo:[0,0,1] neg_hi:[0,0,1]
v_pk_fma_f32 v[80:81], v[72:73], s[78:79], v[52:53] op_sel_hi:[1,0,0] neg_lo:[0,0,1] neg_hi:[0,0,1]
v_pk_fma_f32 v[40:41], v[64:65], s[78:79], v[48:49] op_sel:[0,0,1] op_sel_hi:[1,0,1] neg_lo:[1,0,1] neg_hi:[1,0,1]
v_pk_fma_f32 v[88:89], v[72:73], s[78:79], v[52:53] op_sel:[0,0,1] op_sel_hi:[1,0,1] neg_lo:[1,0,1] neg_hi:[1,0,1]
v_pk_fma_f32 v[34:35], v[66:67], s[78:79], v[48:49] op_sel_hi:[1,0,0] neg_lo:[0,0,1] neg_hi:[0,0,1]
v_pk_fma_f32 v[82:83], v[74:75], s[78:79], v[52:53] op_sel_hi:[1,0,0] neg_lo:[0,0,1] neg_hi:[0,0,1]
v_pk_fma_f32 v[42:43], v[66:67], s[78:79], v[48:49] op_sel:[0,0,1] op_sel_hi:[1,0,1] neg_lo:[1,0,1] neg_hi:[1,0,1]
v_pk_fma_f32 v[90:91], v[74:75], s[78:79], v[52:53] op_sel:[0,0,1] op_sel_hi:[1,0,1] neg_lo:[1,0,1] neg_hi:[1,0,1]
v_pk_fma_f32 v[36:37], v[68:69], s[78:79], v[48:49] op_sel_hi:[1,0,0] neg_lo:[0,0,1] neg_hi:[0,0,1]
v_pk_fma_f32 v[84:85], v[76:77], s[78:79], v[52:53] op_sel_hi:[1,0,0] neg_lo:[0,0,1] neg_hi:[0,0,1]
v_pk_fma_f32 v[44:45], v[68:69], s[78:79], v[48:49] op_sel:[0,0,1] op_sel_hi:[1,0,1] neg_lo:[1,0,1] neg_hi:[1,0,1]
v_pk_fma_f32 v[92:93], v[76:77], s[78:79], v[52:53] op_sel:[0,0,1] op_sel_hi:[1,0,1] neg_lo:[1,0,1] neg_hi:[1,0,1]
v_pk_fma_f32 v[38:39], v[70:71], s[78:79], v[48:49] op_sel_hi:[1,0,0] neg_lo:[0,0,1] neg_hi:[0,0,1]
v_pk_fma_f32 v[86:87], v[78:79], s[78:79], v[52:53] op_sel_hi:[1,0,0] neg_lo:[0,0,1] neg_hi:[0,0,1]
v_pk_fma_f32 v[46:47], v[70:71], s[78:79], v[48:49] op_sel:[0,0,1] op_sel_hi:[1,0,1] neg_lo:[1,0,1] neg_hi:[1,0,1]
v_pk_fma_f32 v[94:95], v[78:79], s[78:79], v[52:53] op_sel:[0,0,1] op_sel_hi:[1,0,1] neg_lo:[1,0,1] neg_hi:[1,0,1]
v_exp_f32 v32, v32
v_exp_f32 v80, v80
v_exp_f32 v33, v33
v_exp_f32 v81, v81
buffer_load_dwordx4 v8, s[24:27], s64 offen offset:2048 lds
v_exp_f32 v34, v34
v_exp_f32 v82, v82
v_exp_f32 v35, v35
v_exp_f32 v83, v83
v_exp_f32 v36, v36
v_exp_f32 v84, v84
v_exp_f32 v37, v37
v_exp_f32 v85, v85
v_exp_f32 v38, v38
v_exp_f32 v86, v86
v_exp_f32 v39, v39
v_exp_f32 v87, v87
v_exp_f32 v40, v40
v_exp_f32 v88, v88
v_exp_f32 v41, v41
v_exp_f32 v89, v89
v_exp_f32 v42, v42
v_exp_f32 v90, v90
v_exp_f32 v43, v43
v_exp_f32 v91, v91
v_exp_f32 v44, v44
v_exp_f32 v92, v92
v_exp_f32 v45, v45
v_exp_f32 v93, v93
buffer_load_dwordx4 v9, s[24:27], s64 offen offset:3072 lds
v_exp_f32 v46, v46
v_exp_f32 v94, v94
v_exp_f32 v47, v47
v_exp_f32 v95, v95
v_pk_add_f32 v[48:49], v[32:33], v[34:35]
v_pk_add_f32 v[52:53], v[80:81], v[82:83]
v_pk_add_f32 v[50:51], v[40:41], v[42:43]
v_pk_add_f32 v[54:55], v[88:89], v[90:91]
v_pk_add_f32 v[48:49], v[48:49], v[36:37]
v_pk_add_f32 v[52:53], v[52:53], v[84:85]
v_pk_add_f32 v[50:51], v[50:51], v[44:45]
v_pk_add_f32 v[54:55], v[54:55], v[92:93]
v_pk_add_f32 v[48:49], v[48:49], v[38:39]
v_pk_add_f32 v[52:53], v[52:53], v[86:87]
v_pk_add_f32 v[50:51], v[50:51], v[46:47]
v_pk_add_f32 v[54:55], v[54:55], v[94:95]
v_add_f32 v48, v48, v49
v_add_f32 v52, v52, v53
v_add_f32 v49, v50, v51
v_add_f32 v53, v54, v55
s_nop 0
v_permlane32_swap_b32 v48, v49
v_permlane32_swap_b32 v52, v53
v_add_f32 v48, v48, v49
v_add_f32 v52, v52, v53
s_add_u32 m0, s59, 0x4000
s_mul_i32 s64, s67, 512
s_add_u32 s64, s64, s56
buffer_load_dwordx4 v6, s[24:27], s64 offen offset:0 lds
v_mov_b32 v49, v48
v_mov_b32 v53, v52
s_nop 0
v_permlane32_swap_b32 v48, v49
v_permlane32_swap_b32 v52, v53
v_rcp_f32 v48, v48
v_rcp_f32 v52, v52
v_rcp_f32 v49, v49
v_rcp_f32 v53, v53
v_pk_mul_f32 v[32:33], v[32:33], v[48:49] op_sel_hi:[1,0]
v_pk_mul_f32 v[80:81], v[80:81], v[52:53] op_sel_hi:[1,0]
v_pk_mul_f32 v[40:41], v[40:41], v[48:49] op_sel:[0,1] op_sel_hi:[1,1]
v_pk_mul_f32 v[88:89], v[88:89], v[52:53] op_sel:[0,1] op_sel_hi:[1,1]
v_pk_mul_f32 v[34:35], v[34:35], v[48:49] op_sel_hi:[1,0]
v_pk_mul_f32 v[82:83], v[82:83], v[52:53] op_sel_hi:[1,0]
v_pk_mul_f32 v[42:43], v[42:43], v[48:49] op_sel:[0,1] op_sel_hi:[1,1]
v_pk_mul_f32 v[90:91], v[90:91], v[52:53] op_sel:[0,1] op_sel_hi:[1,1]
v_pk_mul_f32 v[36:37], v[36:37], v[48:49] op_sel_hi:[1,0]
v_pk_mul_f32 v[84:85], v[84:85], v[52:53] op_sel_hi:[1,0]
v_pk_mul_f32 v[44:45], v[44:45], v[48:49] op_sel:[0,1] op_sel_hi:[1,1]
v_pk_mul_f32 v[92:93], v[92:93], v[52:53] op_sel:[0,1] op_sel_hi:[1,1]
v_pk_mul_f32 v[38:39], v[38:39], v[48:49] op_sel_hi:[1,0]
v_pk_mul_f32 v[86:87], v[86:87], v[52:53] op_sel_hi:[1,0]
v_pk_mul_f32 v[46:47], v[46:47], v[48:49] op_sel:[0,1] op_sel_hi:[1,1]
v_pk_mul_f32 v[94:95], v[94:95], v[52:53] op_sel:[0,1] op_sel_hi:[1,1]
buffer_load_dwordx4 v7, s[24:27], s64 offen offset:1024 lds
v_cvt_pk_bf16_f32 v56, v32, v33
v_cvt_pk_bf16_f32 v112, v80, v81
v_cvt_pk_bf16_f32 v57, v34, v35
v_cvt_pk_bf16_f32 v113, v82, v83
v_cvt_pk_bf16_f32 v58, v36, v37
v_cvt_pk_bf16_f32 v114, v84, v85
v_cvt_pk_bf16_f32 v59, v38, v39
v_cvt_pk_bf16_f32 v115, v86, v87
v_cvt_pk_bf16_f32 v60, v40, v41
v_cvt_pk_bf16_f32 v116, v88, v89
v_cvt_pk_bf16_f32 v61, v42, v43
v_cvt_pk_bf16_f32 v117, v90, v91
v_cvt_pk_bf16_f32 v62, v44, v45
v_cvt_pk_bf16_f32 v118, v92, v93
v_cvt_pk_bf16_f32 v63, v46, v47
v_cvt_pk_bf16_f32 v119, v94, v95
v_accvgpr_write_b32 a64, v56
v_accvgpr_write_b32 a72, v112
v_accvgpr_write_b32 a65, v57
v_accvgpr_write_b32 a73, v113
v_accvgpr_write_b32 a66, v58
v_accvgpr_write_b32 a74, v114
v_accvgpr_write_b32 a67, v59
v_accvgpr_write_b32 a75, v115
v_accvgpr_write_b32 a68, v60
v_accvgpr_write_b32 a76, v116
v_accvgpr_write_b32 a69, v61
v_accvgpr_write_b32 a77, v117
v_accvgpr_write_b32 a70, v62
v_accvgpr_write_b32 a78, v118
v_accvgpr_write_b32 a71, v63
v_accvgpr_write_b32 a79, v119
s_waitcnt vmcnt(6)
s_barrier
v_add_u32 v16, 0x10000, v16
ds_read_b64_tr_b16 v[48:49], v16 offset:0
ds_read_b64_tr_b16 v[50:51], v16 offset:1024
v_add_u32 v17, 0x10000, v17
ds_read_b64_tr_b16 v[52:53], v17 offset:0
ds_read_b64_tr_b16 v[54:55], v17 offset:1024
ds_read_b64_tr_b16 v[56:57], v16 offset:2048
ds_read_b64_tr_b16 v[58:59], v16 offset:3072
ds_read_b64_tr_b16 v[60:61], v17 offset:2048
ds_read_b64_tr_b16 v[62:63], v17 offset:3072
s_waitcnt lgkmcnt(6)
v_mfma_f32_32x32x16_bf16 a[0:15], a[252:255], v[48:51], 0
v_add_u32 v14, 0x10000, v14
ds_read_b64_tr_b16 v[32:33], v14 offset:0
ds_read_b64_tr_b16 v[34:35], v14 offset:512
s_waitcnt lgkmcnt(6)
v_mfma_f32_32x32x16_bf16 a[16:31], a[252:255], v[52:55], 0
v_add_u32 v15, 0x10000, v15
ds_read_b64_tr_b16 v[36:37], v15 offset:0
ds_read_b64_tr_b16 v[38:39], v15 offset:512
buffer_load_dwordx4 v8, s[24:27], s64 offen offset:2048 lds
s_waitcnt lgkmcnt(6)
v_mfma_f32_32x32x16_bf16 a[0:15], a[252:255], v[56:59], a[0:15]
ds_read_b64_tr_b16 v[40:41], v14 offset:2048
ds_read_b64_tr_b16 v[42:43], v14 offset:2560
s_waitcnt lgkmcnt(6)
v_mfma_f32_32x32x16_bf16 a[16:31], a[252:255], v[60:63], a[16:31]
ds_read_b64_tr_b16 v[44:45], v15 offset:2048
ds_read_b64_tr_b16 v[46:47], v15 offset:2560
buffer_load_dwordx4 v9, s[24:27], s64 offen offset:3072 lds
s_waitcnt lgkmcnt(6)
v_mfma_f32_32x32x16_bf16 v[64:79], v[32:35], v[128:131], 0
ds_read_b64_tr_b16 v[48:49], v14 offset:4096
ds_read_b64_tr_b16 v[50:51], v14 offset:4608
s_waitcnt lgkmcnt(6)
v_mfma_f32_32x32x16_bf16 v[80:95], v[36:39], v[128:131], 0
ds_read_b64_tr_b16 v[52:53], v15 offset:4096
ds_read_b64_tr_b16 v[54:55], v15 offset:4608
s_add_u32 m0, s59, 0xc000
s_mul_i32 s64, s68, 512
s_add_u32 s64, s64, s56
buffer_load_dwordx4 v6, s[24:27], s64 offen offset:0 lds
s_waitcnt lgkmcnt(6)
v_mfma_f32_32x32x16_bf16 v[64:79], v[40:43], v[132:135], v[64:79]
ds_read_b64_tr_b16 v[56:57], v14 offset:6144
ds_read_b64_tr_b16 v[58:59], v14 offset:6656
s_waitcnt lgkmcnt(6)
v_mfma_f32_32x32x16_bf16 v[80:95], v[44:47], v[132:135], v[80:95]
ds_read_b64_tr_b16 v[60:61], v15 offset:6144
ds_read_b64_tr_b16 v[62:63], v15 offset:6656
buffer_load_dwordx4 v7, s[24:27], s64 offen offset:1024 lds
v_and_b32 v25, 0x7c, v29
s_lshl_b32 s60, s48, 9
s_add_u32 s60, s60, 0x24c00
v_add_u32 v25, s60, v25
ds_write_b32 v25, a0 offset:0
ds_write_b32 v25, a16 offset:128
s_waitcnt lgkmcnt(8)
v_mfma_f32_32x32x16_bf16 v[64:79], v[48:51], v[136:139], v[64:79]
ds_read_b64_tr_b16 v[32:33], v14 offset:8192
ds_read_b64_tr_b16 v[34:35], v14 offset:8704
s_waitcnt lgkmcnt(8)
v_mfma_f32_32x32x16_bf16 v[80:95], v[52:55], v[136:139], v[80:95]
ds_read_b64_tr_b16 v[36:37], v15 offset:8192
ds_read_b64_tr_b16 v[38:39], v15 offset:8704
buffer_load_dwordx4 v8, s[24:27], s64 offen offset:2048 lds
s_waitcnt lgkmcnt(8)
v_mfma_f32_32x32x16_bf16 v[64:79], v[56:59], v[140:143], v[64:79]
ds_read_b64_tr_b16 v[40:41], v14 offset:10240
ds_read_b64_tr_b16 v[42:43], v14 offset:10752
s_waitcnt lgkmcnt(6)
s_barrier
v_mfma_f32_32x32x16_bf16 v[80:95], v[60:63], v[140:143], v[80:95]
ds_read_b64_tr_b16 v[44:45], v15 offset:10240
ds_read_b64_tr_b16 v[46:47], v15 offset:10752
buffer_load_dwordx4 v9, s[24:27], s64 offen offset:3072 lds
s_waitcnt lgkmcnt(6)
v_mfma_f32_32x32x16_bf16 v[64:79], v[32:35], v[144:147], v[64:79]
ds_read_b64_tr_b16 v[48:49], v14 offset:12288
ds_read_b64_tr_b16 v[50:51], v14 offset:12800
v_add_u32 v25, 0x24c00, v29
s_waitcnt lgkmcnt(6)
v_mfma_f32_32x32x16_bf16 v[80:95], v[36:39], v[144:147], v[80:95]
ds_read_b64_tr_b16 v[52:53], v15 offset:12288
ds_read_b64_tr_b16 v[54:55], v15 offset:12800
s_add_u32 m0, s59, 0x20000
s_mul_i32 s64, s66, 512
s_add_u32 s64, s64, s56
buffer_load_dwordx4 v6, s[24:27], s64 offen offset:0 lds
ds_read2st64_b32 v[112:113], v25 offset0:0 offset1:2
s_waitcnt lgkmcnt(7)
v_mfma_f32_32x32x16_bf16 v[64:79], v[40:43], v[148:151], v[64:79]
ds_read_b64_tr_b16 v[56:57], v14 offset:14336
ds_read_b64_tr_b16 v[58:59], v14 offset:14848
ds_read2st64_b32 v[114:115], v25 offset0:4 offset1:6
s_waitcnt lgkmcnt(8)
v_mfma_f32_32x32x16_bf16 v[80:95], v[44:47], v[148:151], v[80:95]
ds_read_b64_tr_b16 v[60:61], v15 offset:14336
ds_read_b64_tr_b16 v[62:63], v15 offset:14848
buffer_load_dwordx4 v7, s[24:27], s64 offen offset:1024 lds
s_waitcnt lgkmcnt(8)
v_mfma_f32_32x32x16_bf16 v[64:79], v[48:51], v[152:155], v[64:79]
v_add_u32 v14, 0xffff8000, v14
ds_read_b64_tr_b16 v[32:33], v14 offset:0
ds_read_b64_tr_b16 v[34:35], v14 offset:512
s_waitcnt lgkmcnt(8)
v_mfma_f32_32x32x16_bf16 v[80:95], v[52:55], v[152:155], v[80:95]
v_add_u32 v15, 0xffff8000, v15
ds_read_b64_tr_b16 v[36:37], v15 offset:0
ds_read_b64_tr_b16 v[38:39], v15 offset:512
buffer_load_dwordx4 v8, s[24:27], s64 offen offset:2048 lds
v_lshlrev_b32 v25, 3, v0
s_waitcnt lgkmcnt(7)
v_mfma_f32_32x32x16_bf16 v[64:79], v[56:59], v[156:159], v[64:79]
ds_read_b64_tr_b16 v[40:41], v14 offset:2048
ds_read_b64_tr_b16 v[42:43], v14 offset:2560
v_add_f32 v112, v112, v113
s_waitcnt lgkmcnt(6)
v_mfma_f32_32x32x16_bf16 v[80:95], v[60:63], v[156:159], v[80:95]
ds_read_b64_tr_b16 v[44:45], v15 offset:2048
ds_read_b64_tr_b16 v[46:47], v15 offset:2560
buffer_load_dwordx4 v9, s[24:27], s64 offen offset:3072 lds
v_add_f32 v114, v114, v115
s_waitcnt lgkmcnt(6)
v_mfma_f32_32x32x16_bf16 v[64:79], v[32:35], v[160:163], v[64:79]
ds_read_b64_tr_b16 v[48:49], v14 offset:4096
ds_read_b64_tr_b16 v[50:51], v14 offset:4608
v_mov_b32 v113, v30
s_waitcnt lgkmcnt(6)
v_mfma_f32_32x32x16_bf16 v[80:95], v[36:39], v[160:163], v[80:95]
ds_read_b64_tr_b16 v[52:53], v15 offset:4096
ds_read_b64_tr_b16 v[54:55], v15 offset:4608
v_add_f32 v112, v112, v114
s_waitcnt lgkmcnt(6)
v_mfma_f32_32x32x16_bf16 v[64:79], v[40:43], v[164:167], v[64:79]
ds_read_b64_tr_b16 v[56:57], v14 offset:6144
ds_read_b64_tr_b16 v[58:59], v14 offset:6656
s_lshl_b32 s60, s49, 4
s_add_u32 s60, s60, s50
s_lshl_b32 s60, s60, 10
s_add_u32 s60, s60, 0xde0000
s_mov_b64 exec, s[84:85]
buffer_store_dwordx2 v[112:113], v25, s[40:43], s60 offen offset:0 sc1
s_mov_b64 exec, -1
s_waitcnt lgkmcnt(6)
v_mfma_f32_32x32x16_bf16 v[80:95], v[44:47], v[164:167], v[80:95]
ds_read_b64_tr_b16 v[60:61], v15 offset:6144
ds_read_b64_tr_b16 v[62:63], v15 offset:6656
s_waitcnt lgkmcnt(6)
v_mfma_f32_32x32x16_bf16 v[64:79], v[48:51], v[168:171], v[64:79]
ds_read_b64_tr_b16 v[32:33], v14 offset:8192
ds_read_b64_tr_b16 v[34:35], v14 offset:8704
s_waitcnt lgkmcnt(6)
v_mfma_f32_32x32x16_bf16 v[80:95], v[52:55], v[168:171], v[80:95]
ds_read_b64_tr_b16 v[36:37], v15 offset:8192
ds_read_b64_tr_b16 v[38:39], v15 offset:8704
v_accvgpr_read_b32 v2, a91
s_waitcnt lgkmcnt(6)
v_mfma_f32_32x32x16_bf16 v[64:79], v[56:59], v[172:175], v[64:79]
ds_read_b64_tr_b16 v[40:41], v14 offset:10240
ds_read_b64_tr_b16 v[42:43], v14 offset:10752
v_add_u32 v3, 0x6c00, v2
s_waitcnt lgkmcnt(6)
v_mfma_f32_32x32x16_bf16 v[80:95], v[60:63], v[172:175], v[80:95]
ds_read_b64_tr_b16 v[44:45], v15 offset:10240
ds_read_b64_tr_b16 v[46:47], v15 offset:10752
v_add_u32 v4, 0xd800, v2
s_waitcnt lgkmcnt(6)
v_mfma_f32_32x32x16_bf16 v[64:79], v[32:35], v[176:179], v[64:79]
ds_read_b64_tr_b16 v[48:49], v14 offset:12288
ds_read_b64_tr_b16 v[50:51], v14 offset:12800
v_add_u32 v5, 0x14400, v2
s_waitcnt lgkmcnt(6)
v_mfma_f32_32x32x16_bf16 v[80:95], v[36:39], v[176:179], v[80:95]
ds_read_b64_tr_b16 v[52:53], v15 offset:12288
ds_read_b64_tr_b16 v[54:55], v15 offset:12800
s_waitcnt lgkmcnt(6)
v_mfma_f32_32x32x16_bf16 v[64:79], v[40:43], v[180:183], v[64:79]
ds_read_b64_tr_b16 v[56:57], v14 offset:14336
ds_read_b64_tr_b16 v[58:59], v14 offset:14848
s_waitcnt lgkmcnt(6)
v_mfma_f32_32x32x16_bf16 v[80:95], v[44:47], v[180:183], v[80:95]
ds_read_b64_tr_b16 v[60:61], v15 offset:14336
ds_read_b64_tr_b16 v[62:63], v15 offset:14848
s_add_u32 m0, s59, 0x0
s_mul_i32 s64, s65, 3584
s_add_u32 s64, s64, s77
s_add_u32 s64, s64, 0x80
buffer_load_dwordx4 v2, s[28:31], s64 offen offset:0 lds
s_waitcnt lgkmcnt(6)
v_mfma_f32_32x32x16_bf16 v[64:79], v[48:51], v[184:187], v[64:79]
v_add_u32 v14, 0x10000, v14
ds_read_b64_tr_b16 v[32:33], v14 offset:0
ds_read_b64_tr_b16 v[34:35], v14 offset:512
s_waitcnt lgkmcnt(6)
v_mfma_f32_32x32x16_bf16 v[80:95], v[52:55], v[184:187], v[80:95]
v_add_u32 v15, 0x10000, v15
ds_read_b64_tr_b16 v[36:37], v15 offset:0
ds_read_b64_tr_b16 v[38:39], v15 offset:512
buffer_load_dwordx4 v3, s[28:31], s64 offen offset:1024 lds
s_waitcnt lgkmcnt(6)
v_mfma_f32_32x32x16_bf16 v[64:79], v[56:59], v[188:191], v[64:79]
ds_read_b64_tr_b16 v[40:41], v14 offset:2048
ds_read_b64_tr_b16 v[42:43], v14 offset:2560
s_waitcnt lgkmcnt(6)
v_mfma_f32_32x32x16_bf16 v[80:95], v[60:63], v[188:191], v[80:95]
ds_read_b64_tr_b16 v[44:45], v15 offset:2048
ds_read_b64_tr_b16 v[46:47], v15 offset:2560
buffer_load_dwordx4 v4, s[28:31], s64 offen offset:2048 lds
s_waitcnt lgkmcnt(6)
v_mfma_f32_32x32x16_bf16 v[64:79], v[32:35], v[192:195], v[64:79]
ds_read_b64_tr_b16 v[48:49], v14 offset:4096
ds_read_b64_tr_b16 v[50:51], v14 offset:4608
s_waitcnt lgkmcnt(6)
v_mfma_f32_32x32x16_bf16 v[80:95], v[36:39], v[192:195], v[80:95]
ds_read_b64_tr_b16 v[52:53], v15 offset:4096
ds_read_b64_tr_b16 v[54:55], v15 offset:4608
buffer_load_dwordx4 v5, s[28:31], s64 offen offset:3072 lds
s_waitcnt lgkmcnt(6)
v_mfma_f32_32x32x16_bf16 v[64:79], v[40:43], v[196:199], v[64:79]
ds_read_b64_tr_b16 v[56:57], v14 offset:6144
ds_read_b64_tr_b16 v[58:59], v14 offset:6656
s_waitcnt lgkmcnt(6)
v_mfma_f32_32x32x16_bf16 v[80:95], v[44:47], v[196:199], v[80:95]
ds_read_b64_tr_b16 v[60:61], v15 offset:6144
ds_read_b64_tr_b16 v[62:63], v15 offset:6656
s_waitcnt lgkmcnt(6)
v_mfma_f32_32x32x16_bf16 v[64:79], v[48:51], v[200:203], v[64:79]
ds_read_b64_tr_b16 v[32:33], v14 offset:8192
ds_read_b64_tr_b16 v[34:35], v14 offset:8704
s_waitcnt lgkmcnt(6)
v_mfma_f32_32x32x16_bf16 v[80:95], v[52:55], v[200:203], v[80:95]
ds_read_b64_tr_b16 v[36:37], v15 offset:8192
ds_read_b64_tr_b16 v[38:39], v15 offset:8704
s_waitcnt lgkmcnt(6)
v_mfma_f32_32x32x16_bf16 v[64:79], v[56:59], v[204:207], v[64:79]
ds_read_b64_tr_b16 v[40:41], v14 offset:10240
ds_read_b64_tr_b16 v[42:43], v14 offset:10752
v_accvgpr_read_b32 v113, a87
v_accvgpr_read_b32 v112, a88
ds_read_b64 v[120:121], v113
v_xor_b32 v114, 16, v113
ds_read_b64 v[122:123], v114
v_xor_b32 v114, 32, v113
ds_read_b64 v[124:125], v114
v_xor_b32 v114, 48, v113
ds_read_b64 v[126:127], v114
s_lshl_b32 s62, s55, 9
s_add_u32 s62, s62, 0xd80000
buffer_load_dwordx4 v[144:147], v112, s[40:43], s62 offen sc1
s_waitcnt lgkmcnt(10)
v_mfma_f32_32x32x16_bf16 v[80:95], v[60:63], v[204:207], v[80:95]
ds_read_b64_tr_b16 v[44:45], v15 offset:10240
ds_read_b64_tr_b16 v[46:47], v15 offset:10752
s_waitcnt lgkmcnt(10)
v_mfma_f32_32x32x16_bf16 v[64:79], v[32:35], v[208:211], v[64:79]
ds_read_b64_tr_b16 v[48:49], v14 offset:12288
ds_read_b64_tr_b16 v[50:51], v14 offset:12800
s_waitcnt lgkmcnt(10)
v_mfma_f32_32x32x16_bf16 v[80:95], v[36:39], v[208:211], v[80:95]
ds_read_b64_tr_b16 v[52:53], v15 offset:12288
ds_read_b64_tr_b16 v[54:55], v15 offset:12800
s_waitcnt lgkmcnt(10)
v_mfma_f32_32x32x16_bf16 v[64:79], v[40:43], v[212:215], v[64:79]
ds_read_b64_tr_b16 v[56:57], v14 offset:14336
ds_read_b64_tr_b16 v[58:59], v14 offset:14848
v_lshlrev_b32 v22, 3, v0
s_and_b32 s97, s49, 12
s_lshl_b32 s97, s97, 4
s_add_u32 s97, s97, s50
s_lshl_b32 s97, s97, 10
s_add_u32 s97, s97, 0xde0000
s_add_u32 s98, s97, 0x4000
s_add_u32 s100, s97, 0x8000
s_add_u32 s101, s97, 0xc000
buffer_load_dwordx2 v[128:129], v22, s[40:43], s97 offen offset:0 sc1
buffer_load_dwordx2 v[130:131], v22, s[40:43], s98 offen offset:0 sc1
buffer_load_dwordx2 v[132:133], v22, s[40:43], s100 offen offset:0 sc1
buffer_load_dwordx2 v[134:135], v22, s[40:43], s101 offen offset:0 sc1
s_waitcnt lgkmcnt(6)
v_mfma_f32_32x32x16_bf16 v[80:95], v[44:47], v[212:215], v[80:95]
ds_read_b64_tr_b16 v[60:61], v15 offset:14336
ds_read_b64_tr_b16 v[62:63], v15 offset:14848
s_waitcnt lgkmcnt(6)
v_mfma_f32_32x32x16_bf16 v[64:79], v[48:51], v[216:219], v[64:79]
ds_read_b64_tr_b16 v[32:33], v14 offset:16384
ds_read_b64_tr_b16 v[34:35], v14 offset:16896
s_waitcnt lgkmcnt(6)
v_mfma_f32_32x32x16_bf16 v[80:95], v[52:55], v[216:219], v[80:95]
ds_read_b64_tr_b16 v[36:37], v15 offset:16384
ds_read_b64_tr_b16 v[38:39], v15 offset:16896
s_waitcnt lgkmcnt(6)
v_mfma_f32_32x32x16_bf16 v[64:79], v[56:59], v[220:223], v[64:79]
ds_read_b64_tr_b16 v[40:41], v14 offset:18432
ds_read_b64_tr_b16 v[42:43], v14 offset:18944
v_mov_b32 v24, v30
s_mov_b64 exec, 0xff
buffer_load_dword v24, v23, s[40:43], s96 offen sc1
s_mov_b64 exec, -1
s_waitcnt lgkmcnt(6)
v_mfma_f32_32x32x16_bf16 v[80:95], v[60:63], v[220:223], v[80:95]
ds_read_b64_tr_b16 v[44:45], v15 offset:18432
ds_read_b64_tr_b16 v[46:47], v15 offset:18944
s_waitcnt lgkmcnt(6)
v_mfma_f32_32x32x16_bf16 v[64:79], v[32:35], v[224:227], v[64:79]
ds_read_b64_tr_b16 v[48:49], v14 offset:20480
ds_read_b64_tr_b16 v[50:51], v14 offset:20992
s_waitcnt lgkmcnt(6)
v_mfma_f32_32x32x16_bf16 v[80:95], v[36:39], v[224:227], v[80:95]
ds_read_b64_tr_b16 v[52:53], v15 offset:20480
ds_read_b64_tr_b16 v[54:55], v15 offset:20992
s_waitcnt lgkmcnt(6)
v_mfma_f32_32x32x16_bf16 v[64:79], v[40:43], v[228:231], v[64:79]
ds_read_b64_tr_b16 v[56:57], v14 offset:22528
ds_read_b64_tr_b16 v[58:59], v14 offset:23040
s_waitcnt lgkmcnt(6)
v_mfma_f32_32x32x16_bf16 v[80:95], v[44:47], v[228:231], v[80:95]
ds_read_b64_tr_b16 v[60:61], v15 offset:22528
ds_read_b64_tr_b16 v[62:63], v15 offset:23040
s_waitcnt lgkmcnt(6)
v_mfma_f32_32x32x16_bf16 v[64:79], v[48:51], v[232:235], v[64:79]
ds_read_b64_tr_b16 v[32:33], v14 offset:24576
ds_read_b64_tr_b16 v[34:35], v14 offset:25088
s_waitcnt lgkmcnt(6)
v_mfma_f32_32x32x16_bf16 v[80:95], v[52:55], v[232:235], v[80:95]
ds_read_b64_tr_b16 v[36:37], v15 offset:24576
ds_read_b64_tr_b16 v[38:39], v15 offset:25088
s_waitcnt lgkmcnt(6)
v_mfma_f32_32x32x16_bf16 v[64:79], v[56:59], v[236:239], v[64:79]
ds_read_b64_tr_b16 v[40:41], v14 offset:26624
ds_read_b64_tr_b16 v[42:43], v14 offset:27136
s_waitcnt lgkmcnt(6)
v_mfma_f32_32x32x16_bf16 v[80:95], v[60:63], v[236:239], v[80:95]
ds_read_b64_tr_b16 v[44:45], v15 offset:26624
ds_read_b64_tr_b16 v[46:47], v15 offset:27136
s_waitcnt lgkmcnt(6)
v_mfma_f32_32x32x16_bf16 v[64:79], v[32:35], v[240:243], v[64:79]
ds_read_b64_tr_b16 v[48:49], v14 offset:28672
ds_read_b64_tr_b16 v[50:51], v14 offset:29184
s_waitcnt lgkmcnt(6)
v_mfma_f32_32x32x16_bf16 v[80:95], v[36:39], v[240:243], v[80:95]
ds_read_b64_tr_b16 v[52:53], v15 offset:28672
ds_read_b64_tr_b16 v[54:55], v15 offset:29184
s_waitcnt lgkmcnt(6)
v_mfma_f32_32x32x16_bf16 v[64:79], v[40:43], v[244:247], v[64:79]
ds_read_b64_tr_b16 v[56:57], v14 offset:30720
ds_read_b64_tr_b16 v[58:59], v14 offset:31232
s_waitcnt lgkmcnt(6)
v_mfma_f32_32x32x16_bf16 v[80:95], v[44:47], v[244:247], v[80:95]
ds_read_b64_tr_b16 v[60:61], v15 offset:30720
ds_read_b64_tr_b16 v[62:63], v15 offset:31232
s_waitcnt lgkmcnt(6)
v_mfma_f32_32x32x16_bf16 v[64:79], v[48:51], v[248:251], v[64:79]
s_waitcnt lgkmcnt(4)
v_mfma_f32_32x32x16_bf16 v[80:95], v[52:55], v[248:251], v[80:95]
s_waitcnt lgkmcnt(2)
v_mfma_f32_32x32x16_bf16 v[64:79], v[56:59], v[252:255], v[64:79]
s_waitcnt lgkmcnt(0)
v_mfma_f32_32x32x16_bf16 v[80:95], v[60:63], v[252:255], v[80:95]
s_waitcnt vmcnt(0)
v_cmp_ne_u32 vcc, s52, v24
s_nop 4
s_cbranch_vccz Lok_16
s_mov_b32 s73, 0x8000
Lpoll_17:
s_mov_b64 exec, 0xff
buffer_load_dword v24, v23, s[40:43], s96 offen sc1
s_mov_b64 exec, -1
s_sub_u32 s73, s73, 1
s_waitcnt vmcnt(0)
s_cbranch_scc1 Lok_16
v_cmp_ne_u32 vcc, s52, v24
s_nop 4
s_cbranch_vccnz Lpoll_17
Lok_16:
s_lshl_b32 s88, s55, 15
s_lshl_b32 s89, s57, 14
s_add_u32 s88, s88, s89
s_lshl_b32 s89, s65, 5
s_add_u32 s89, s89, s88
buffer_load_dwordx4 a[0:3], v1, s[40:43], s89 offen offset:0 sc1
buffer_load_dwordx4 a[4:7], v1, s[40:43], s89 offen offset:1024 sc1
buffer_load_dwordx4 a[8:11], v1, s[40:43], s89 offen offset:2048 sc1
buffer_load_dwordx4 a[12:15], v1, s[40:43], s89 offen offset:3072 sc1
s_lshl_b32 s89, s66, 5
s_add_u32 s89, s89, s88
buffer_load_dwordx4 a[16:19], v1, s[40:43], s89 offen offset:0 sc1
buffer_load_dwordx4 a[20:23], v1, s[40:43], s89 offen offset:1024 sc1
buffer_load_dwordx4 a[24:27], v1, s[40:43], s89 offen offset:2048 sc1
buffer_load_dwordx4 a[28:31], v1, s[40:43], s89 offen offset:3072 sc1
s_lshl_b32 s89, s67, 5
s_add_u32 s89, s89, s88
buffer_load_dwordx4 a[32:35], v1, s[40:43], s89 offen offset:0 sc1
buffer_load_dwordx4 a[36:39], v1, s[40:43], s89 offen offset:1024 sc1
buffer_load_dwordx4 a[40:43], v1, s[40:43], s89 offen offset:2048 sc1
buffer_load_dwordx4 a[44:47], v1, s[40:43], s89 offen offset:3072 sc1
s_lshl_b32 s89, s68, 5
s_add_u32 s89, s89, s88
buffer_load_dwordx4 a[48:51], v1, s[40:43], s89 offen offset:0 sc1
buffer_load_dwordx4 a[52:55], v1, s[40:43], s89 offen offset:1024 sc1
buffer_load_dwordx4 a[56:59], v1, s[40:43], s89 offen offset:2048 sc1
buffer_load_dwordx4 a[60:63], v1, s[40:43], s89 offen offset:3072 sc1
Ljoin_2:
v_cmp_ne_u32 vcc, s52, v147
s_nop 4
s_cbranch_vccz Lok_18
s_mov_b32 s73, 0x8000
Lpoll_19:
buffer_load_dwordx4 v[144:147], v112, s[40:43], s62 offen sc1
s_sub_u32 s73, s73, 1
s_waitcnt vmcnt(0)
s_cbranch_scc1 Lok_18
v_cmp_ne_u32 vcc, s52, v147
s_nop 4
s_cbranch_vccnz Lpoll_19
Lok_18:
v_mul_f32 v144, v144, v145
v_accvgpr_write_b32 a244, v120
v_accvgpr_write_b32 a245, v121
v_accvgpr_write_b32 a246, v122
v_accvgpr_write_b32 a247, v123
v_accvgpr_write_b32 a248, v124
v_accvgpr_write_b32 a249, v125
v_accvgpr_write_b32 a250, v126
v_accvgpr_write_b32 a251, v127
v_lshlrev_b32 v112, 16, v120
v_and_b32 v113, 0xffff0000, v120
v_lshlrev_b32 v114, 16, v121
v_and_b32 v115, 0xffff0000, v121
v_lshlrev_b32 v116, 16, v122
v_and_b32 v117, 0xffff0000, v122
v_lshlrev_b32 v118, 16, v123
v_and_b32 v119, 0xffff0000, v123
v_lshlrev_b32 v120, 16, v124
v_and_b32 v121, 0xffff0000, v124
v_lshlrev_b32 v122, 16, v125
v_and_b32 v123, 0xffff0000, v125
v_lshlrev_b32 v124, 16, v126
v_and_b32 v125, 0xffff0000, v126
v_lshlrev_b32 v126, 16, v127
v_and_b32 v127, 0xffff0000, v127
v_pk_fma_f32 v[112:113], v[112:113], v[144:145], v[144:145] op_sel:[0,1,0] op_sel_hi:[1,1,0]
v_pk_fma_f32 v[114:115], v[114:115], v[144:145], v[144:145] op_sel:[0,1,0] op_sel_hi:[1,1,0]
v_pk_fma_f32 v[116:117], v[116:117], v[144:145], v[144:145] op_sel:[0,1,0] op_sel_hi:[1,1,0]
v_pk_fma_f32 v[118:119], v[118:119], v[144:145], v[144:145] op_sel:[0,1,0] op_sel_hi:[1,1,0]
v_pk_fma_f32 v[120:121], v[120:121], v[144:145], v[144:145] op_sel:[0,1,0] op_sel_hi:[1,1,0]
v_pk_fma_f32 v[122:123], v[122:123], v[144:145], v[144:145] op_sel:[0,1,0] op_sel_hi:[1,1,0]
v_pk_fma_f32 v[124:125], v[124:125], v[144:145], v[144:145] op_sel:[0,1,0] op_sel_hi:[1,1,0]
v_pk_fma_f32 v[126:127], v[126:127], v[144:145], v[144:145] op_sel:[0,1,0] op_sel_hi:[1,1,0]
v_xor_b32 v136, s52, v129
v_xor_b32 v137, s52, v131
v_or_b32 v136, v136, v137
v_xor_b32 v137, s52, v133
v_or_b32 v136, v136, v137
v_xor_b32 v137, s52, v135
v_or_b32 v136, v136, v137
v_cmp_ne_u32 vcc, 0, v136
s_nop 4
s_cbranch_vccz Lok_20
s_mov_b32 s73, 0x8000
Lpoll_21:
buffer_load_dwordx2 v[128:129], v22, s[40:43], s97 offen offset:0 sc1
buffer_load_dwordx2 v[130:131], v22, s[40:43], s98 offen offset:0 sc1
buffer_load_dwordx2 v[132:133], v22, s[40:43], s100 offen offset:0 sc1
buffer_load_dwordx2 v[134:135], v22, s[40:43], s101 offen offset:0 sc1
s_waitcnt vmcnt(0)
s_sub_u32 s73, s73, 1
s_cbranch_scc1 Lok_20
v_xor_b32 v136, s52, v129
v_xor_b32 v137, s52, v131
v_or_b32 v136, v136, v137
v_xor_b32 v137, s52, v133
v_or_b32 v136, v136, v137
v_xor_b32 v137, s52, v135
v_or_b32 v136, v136, v137
v_cmp_ne_u32 vcc, 0, v136
s_nop 4
s_cbranch_vccnz Lpoll_21
Lok_20:
s_lshl_b32 s60, s48, 9
s_add_u32 s60, s60, 0x25400
v_add_u32 v22, s60, v29
v_add_f32 v128, v128, v130
v_add_f32 v132, v132, v134
v_lshrrev_b32 v25, 5, v0
v_add_f32 v128, v128, v132
ds_write_b32 v22, v128 offset:0
v_lshl_add_u32 v25, v25, 4, s60
s_add_u32 s8, s54, 0
s_cmp_ge_u32 s8, 7
s_cselect_b32 s62, 7, 0
s_sub_u32 s8, s8, s62
s_lshl_b32 s8, s8, 14
ds_read_b128 v[160:163], v25 offset:0
s_add_u32 s9, s54, 1
s_cmp_ge_u32 s9, 7
s_cselect_b32 s62, 7, 0
s_sub_u32 s9, s9, s62
s_lshl_b32 s9, s9, 14
ds_read_b128 v[164:167], v25 offset:32
s_add_u32 s10, s54, 2
s_cmp_ge_u32 s10, 7
s_cselect_b32 s62, 7, 0
s_sub_u32 s10, s10, s62
s_lshl_b32 s10, s10, 14
ds_read_b128 v[168:171], v25 offset:64
s_add_u32 s11, s54, 3
s_cmp_ge_u32 s11, 7
s_cselect_b32 s62, 7, 0
s_sub_u32 s11, s11, s62
s_lshl_b32 s11, s11, 14
ds_read_b128 v[172:175], v25 offset:96
s_add_u32 s12, s54, 4
s_cmp_ge_u32 s12, 7
s_cselect_b32 s62, 7, 0
s_sub_u32 s12, s12, s62
s_lshl_b32 s12, s12, 14
ds_read_b128 v[176:179], v25 offset:128
s_add_u32 s13, s54, 5
s_cmp_ge_u32 s13, 7
s_cselect_b32 s62, 7, 0
s_sub_u32 s13, s13, s62
s_lshl_b32 s13, s13, 14
ds_read_b128 v[180:183], v25 offset:160
s_add_u32 s14, s54, 6
s_cmp_ge_u32 s14, 7
s_cselect_b32 s62, 7, 0
s_sub_u32 s14, s14, s62
s_lshl_b32 s14, s14, 14
ds_read_b128 v[184:187], v25 offset:192
s_cmp_eq_u32 s58, 0
s_cselect_b32 s20, s8, s9
s_lshl_b32 s20, s20, 4
s_add_u32 s20, s20, s56
ds_read_b128 v[188:191], v25 offset:224
s_cmp_eq_u32 s58, 0
s_cselect_b32 s21, s9, s10
s_lshl_b32 s21, s21, 4
s_add_u32 s21, s21, s56
s_cmp_eq_u32 s58, 0
s_cselect_b32 s22, s10, s11
s_lshl_b32 s22, s22, 4
s_add_u32 s22, s22, s56
s_cmp_eq_u32 s58, 0
s_cselect_b32 s23, s11, s12
s_lshl_b32 s23, s23, 4
s_add_u32 s23, s23, s56
s_cmp_eq_u32 s58, 0
s_cselect_b32 s44, s12, s13
s_lshl_b32 s44, s44, 4
s_add_u32 s44, s44, s56
s_cmp_eq_u32 s58, 0
s_cselect_b32 s45, s13, s14
s_lshl_b32 s45, s45, 4
s_add_u32 s45, s45, s56
s_cmp_eq_u32 s58, 0
s_cselect_b32 s46, s14, s8
s_lshl_b32 s46, s46, 4
s_add_u32 s46, s46, s56
v_accvgpr_read_b32 v140, a92
ds_read_b64_tr_b16 v[224:225], v140 offset:0
ds_read_b64_tr_b16 v[226:227], v140 offset:256
ds_read_b64_tr_b16 v[228:229], v140 offset:1024
ds_read_b64_tr_b16 v[230:231], v140 offset:1280
v_accvgpr_read_b32 v14, a93
v_add_u32 v15, 0x1000, v14
s_waitcnt lgkmcnt(0)
s_barrier
v_add_u32 v20, 0x14000, v20
ds_read_b64_tr_b16 v[32:33], v20 offset:0
ds_read_b64_tr_b16 v[34:35], v20 offset:1024
v_add_u32 v21, 0x14000, v21
ds_read_b64_tr_b16 v[36:37], v21 offset:0
ds_read_b64_tr_b16 v[38:39], v21 offset:1024
ds_read_b64_tr_b16 v[40:41], v20 offset:2048
ds_read_b64_tr_b16 v[42:43], v20 offset:3072
ds_read_b64_tr_b16 v[44:45], v21 offset:2048
ds_read_b64_tr_b16 v[46:47], v21 offset:3072
s_waitcnt vmcnt(15) lgkmcnt(6)
v_mfma_f32_32x32x16_bf16 v[112:127], v[32:35], a[0:3], v[112:127]
ds_read_b64_tr_b16 v[48:49], v20 offset:4096
ds_read_b64_tr_b16 v[50:51], v20 offset:5120
s_waitcnt lgkmcnt(6)
v_mfma_f32_32x32x16_bf16 v[144:159], v[36:39], a[0:3], 0
ds_read_b64_tr_b16 v[52:53], v21 offset:4096
ds_read_b64_tr_b16 v[54:55], v21 offset:5120
s_waitcnt vmcnt(14) lgkmcnt(6)
v_mfma_f32_32x32x16_bf16 v[112:127], v[40:43], a[4:7], v[112:127]
ds_read_b64_tr_b16 v[56:57], v20 offset:6144
ds_read_b64_tr_b16 v[58:59], v20 offset:7168
s_waitcnt lgkmcnt(6)
v_mfma_f32_32x32x16_bf16 v[144:159], v[44:47], a[4:7], v[144:159]
ds_read_b64_tr_b16 v[60:61], v21 offset:6144
ds_read_b64_tr_b16 v[62:63], v21 offset:7168
s_waitcnt vmcnt(13) lgkmcnt(6)
v_mfma_f32_32x32x16_bf16 v[112:127], v[48:51], a[8:11], v[112:127]
ds_read_b64_tr_b16 v[32:33], v20 offset:49152
ds_read_b64_tr_b16 v[34:35], v20 offset:50176
s_waitcnt lgkmcnt(6)
v_mfma_f32_32x32x16_bf16 v[144:159], v[52:55], a[8:11], v[144:159]
ds_read_b64_tr_b16 v[36:37], v21 offset:49152
ds_read_b64_tr_b16 v[38:39], v21 offset:50176
s_waitcnt vmcnt(12) lgkmcnt(6)
v_mfma_f32_32x32x16_bf16 v[112:127], v[56:59], a[12:15], v[112:127]
ds_read_b64_tr_b16 v[40:41], v20 offset:51200
ds_read_b64_tr_b16 v[42:43], v20 offset:52224
s_waitcnt lgkmcnt(6)
v_mfma_f32_32x32x16_bf16 v[144:159], v[60:63], a[12:15], v[144:159]
ds_read_b64_tr_b16 v[44:45], v21 offset:51200
ds_read_b64_tr_b16 v[46:47], v21 offset:52224
s_waitcnt vmcnt(11) lgkmcnt(6)
v_mfma_f32_32x32x16_bf16 v[112:127], v[32:35], a[16:19], v[112:127]
ds_read_b64_tr_b16 v[48:49], v20 offset:53248
ds_read_b64_tr_b16 v[50:51], v20 offset:54272
s_waitcnt lgkmcnt(6)
v_mfma_f32_32x32x16_bf16 v[144:159], v[36:39], a[16:19], v[144:159]
ds_read_b64_tr_b16 v[52:53], v21 offset:53248
ds_read_b64_tr_b16 v[54:55], v21 offset:54272
s_waitcnt vmcnt(10) lgkmcnt(6)
v_mfma_f32_32x32x16_bf16 v[112:127], v[40:43], a[20:23], v[112:127]
ds_read_b64_tr_b16 v[56:57], v20 offset:55296
ds_read_b64_tr_b16 v[58:59], v20 offset:56320
s_waitcnt lgkmcnt(6)
v_mfma_f32_32x32x16_bf16 v[144:159], v[44:47], a[20:23], v[144:159]
ds_read_b64_tr_b16 v[60:61], v21 offset:55296
ds_read_b64_tr_b16 v[62:63], v21 offset:56320
s_waitcnt vmcnt(9) lgkmcnt(6)
v_mfma_f32_32x32x16_bf16 v[112:127], v[48:51], a[24:27], v[112:127]
v_add_u32 v21, 0xffff0000, v21
ds_read_b64_tr_b16 v[32:33], v21 offset:0
ds_read_b64_tr_b16 v[34:35], v21 offset:1024
s_add_u32 m0, s59, 0x10000
s_mul_i32 s64, s65, 3584
s_add_u32 s64, s64, s77
buffer_load_dwordx4 v2, s[28:31], s64 offen offset:0 lds
s_waitcnt lgkmcnt(6)
v_mfma_f32_32x32x16_bf16 v[144:159], v[52:55], a[24:27], v[144:159]
ds_read_b64_tr_b16 v[36:37], v21 offset:2048
ds_read_b64_tr_b16 v[38:39], v21 offset:3072
s_waitcnt vmcnt(9) lgkmcnt(6)
v_mfma_f32_32x32x16_bf16 v[112:127], v[56:59], a[28:31], v[112:127]
ds_read_b64_tr_b16 v[40:41], v21 offset:4096
ds_read_b64_tr_b16 v[42:43], v21 offset:5120
buffer_load_dwordx4 v3, s[28:31], s64 offen offset:1024 lds
s_waitcnt lgkmcnt(6)
v_mfma_f32_32x32x16_bf16 v[144:159], v[60:63], a[28:31], v[144:159]
ds_read_b64_tr_b16 v[44:45], v21 offset:6144
ds_read_b64_tr_b16 v[46:47], v21 offset:7168
s_waitcnt vmcnt(9) lgkmcnt(6)
v_mfma_f32_32x32x16_bf16 v[144:159], v[32:35], a[32:35], v[144:159]
ds_read_b64_tr_b16 v[48:49], v21 offset:32768
ds_read_b64_tr_b16 v[50:51], v21 offset:33792
buffer_load_dwordx4 v4, s[28:31], s64 offen offset:2048 lds
s_waitcnt vmcnt(9) lgkmcnt(6)
v_mfma_f32_32x32x16_bf16 v[144:159], v[36:39], a[36:39], v[144:159]
ds_read_b64_tr_b16 v[52:53], v21 offset:34816
ds_read_b64_tr_b16 v[54:55], v21 offset:35840
s_waitcnt vmcnt(8) lgkmcnt(6)
v_mfma_f32_32x32x16_bf16 v[144:159], v[40:43], a[40:43], v[144:159]
ds_read_b64_tr_b16 v[56:57], v21 offset:36864
ds_read_b64_tr_b16 v[58:59], v21 offset:37888
buffer_load_dwordx4 v5, s[28:31], s64 offen offset:3072 lds
s_waitcnt vmcnt(8) lgkmcnt(6)
v_mfma_f32_32x32x16_bf16 v[144:159], v[44:47], a[44:47], v[144:159]
ds_read_b64_tr_b16 v[60:61], v21 offset:38912
ds_read_b64_tr_b16 v[62:63], v21 offset:39936
s_waitcnt vmcnt(7) lgkmcnt(6)
v_mfma_f32_32x32x16_bf16 v[144:159], v[48:51], a[48:51], v[144:159]
v_add_u32 v20, 0xffff0000, v20
ds_read_b64_tr_b16 v[32:33], v20 offset:0
ds_read_b64_tr_b16 v[34:35], v20 offset:1024
s_add_u32 m0, s59, 0x8000
s_mul_i32 s64, s66, 3584
s_add_u32 s64, s64, s77
buffer_load_dwordx4 v2, s[28:31], s64 offen offset:0 lds
s_waitcnt vmcnt(7) lgkmcnt(6)
v_mfma_f32_32x32x16_bf16 v[144:159], v[52:55], a[52:55], v[144:159]
ds_read_b64_tr_b16 v[36:37], v20 offset:2048
ds_read_b64_tr_b16 v[38:39], v20 offset:3072
s_waitcnt vmcnt(6) lgkmcnt(6)
v_mfma_f32_32x32x16_bf16 v[144:159], v[56:59], a[56:59], v[144:159]
ds_read_b64_tr_b16 v[40:41], v20 offset:4096
ds_read_b64_tr_b16 v[42:43], v20 offset:5120
buffer_load_dwordx4 v3, s[28:31], s64 offen offset:1024 lds
s_waitcnt vmcnt(6) lgkmcnt(6)
v_mfma_f32_32x32x16_bf16 v[144:159], v[60:63], a[60:63], v[144:159]
ds_read_b64_tr_b16 v[44:45], v20 offset:6144
ds_read_b64_tr_b16 v[46:47], v20 offset:7168
s_waitcnt lgkmcnt(6)
v_mfma_f32_32x32x16_bf16 v[112:127], v[32:35], a[32:35], v[112:127]
ds_read_b64_tr_b16 v[48:49], v20 offset:32768
ds_read_b64_tr_b16 v[50:51], v20 offset:33792
buffer_load_dwordx4 v4, s[28:31], s64 offen offset:2048 lds
s_waitcnt lgkmcnt(6)
v_mfma_f32_32x32x16_bf16 v[112:127], v[36:39], a[36:39], v[112:127]
ds_read_b64_tr_b16 v[52:53], v20 offset:34816
ds_read_b64_tr_b16 v[54:55], v20 offset:35840
s_add_u32 s60, s59, 0x24000
v_add_u32 v22, s60, v1
ds_write_b128 v22, v[144:147] offset:0
ds_write_b128 v22, v[148:151] offset:1024
ds_write_b128 v22, v[152:155] offset:2048
ds_write_b128 v22, v[156:159] offset:3072
s_waitcnt lgkmcnt(10)
v_mfma_f32_32x32x16_bf16 v[112:127], v[40:43], a[40:43], v[112:127]
ds_read_b64_tr_b16 v[56:57], v20 offset:36864
ds_read_b64_tr_b16 v[58:59], v20 offset:37888
buffer_load_dwordx4 v5, s[28:31], s64 offen offset:3072 lds
s_waitcnt lgkmcnt(10)
v_mfma_f32_32x32x16_bf16 v[112:127], v[44:47], a[44:47], v[112:127]
ds_read_b64_tr_b16 v[60:61], v20 offset:38912
ds_read_b64_tr_b16 v[62:63], v20 offset:39936
s_waitcnt lgkmcnt(10)
v_mfma_f32_32x32x16_bf16 v[112:127], v[48:51], a[48:51], v[112:127]
s_waitcnt lgkmcnt(8)
v_mfma_f32_32x32x16_bf16 v[112:127], v[52:55], a[52:55], v[112:127]
s_waitcnt lgkmcnt(0)
s_barrier
v_xor_b32 v22, 0x2000, v22
ds_read_b128 v[192:195], v22 offset:0
ds_read_b128 v[196:199], v22 offset:1024
ds_read_b128 v[200:203], v22 offset:2048
ds_read_b128 v[204:207], v22 offset:3072
v_mfma_f32_32x32x16_bf16 v[112:127], v[56:59], a[56:59], v[112:127]
v_mfma_f32_32x32x16_bf16 v[112:127], v[60:63], a[60:63], v[112:127]
s_waitcnt lgkmcnt(3)
s_nop 10
v_pk_add_f32 v[112:113], v[112:113], v[192:193]
v_pk_add_f32 v[114:115], v[114:115], v[194:195]
s_waitcnt lgkmcnt(2)
v_pk_add_f32 v[116:117], v[116:117], v[196:197]
v_pk_add_f32 v[118:119], v[118:119], v[198:199]
s_waitcnt lgkmcnt(1)
v_pk_add_f32 v[120:121], v[120:121], v[200:201]
v_pk_add_f32 v[122:123], v[122:123], v[202:203]
s_waitcnt lgkmcnt(0)
v_pk_add_f32 v[124:125], v[124:125], v[204:205]
v_pk_add_f32 v[126:127], v[126:127], v[206:207]
v_cvt_pk_bf16_f32 v32, v112, v113
v_cvt_pk_bf16_f32 v33, v114, v115
v_cvt_pk_bf16_f32 v34, v116, v117
v_cvt_pk_bf16_f32 v35, v118, v119
v_cvt_pk_bf16_f32 v36, v120, v121
v_cvt_pk_bf16_f32 v37, v122, v123
v_cvt_pk_bf16_f32 v38, v124, v125
v_cvt_pk_bf16_f32 v39, v126, v127
buffer_store_dwordx4 v[32:35], v1, s[40:43], s93 offen offset:0 sc1
buffer_store_dwordx4 v[36:39], v1, s[40:43], s93 offen offset:1024 sc1
v_pk_add_f32 v[192:193], v[112:113], v[114:115]
v_pk_mul_f32 v[194:195], v[112:113], v[112:113]
v_pk_fma_f32 v[194:195], v[114:115], v[114:115], v[194:195]
v_pk_add_f32 v[192:193], v[192:193], v[116:117]
v_pk_fma_f32 v[194:195], v[116:117], v[116:117], v[194:195]
v_pk_add_f32 v[192:193], v[192:193], v[118:119]
v_pk_fma_f32 v[194:195], v[118:119], v[118:119], v[194:195]
v_pk_add_f32 v[192:193], v[192:193], v[120:121]
v_pk_fma_f32 v[194:195], v[120:121], v[120:121], v[194:195]
v_pk_add_f32 v[192:193], v[192:193], v[122:123]
v_pk_fma_f32 v[194:195], v[122:123], v[122:123], v[194:195]
v_pk_add_f32 v[192:193], v[192:193], v[124:125]
v_pk_fma_f32 v[194:195], v[124:125], v[124:125], v[194:195]
v_pk_add_f32 v[192:193], v[192:193], v[126:127]
v_pk_fma_f32 v[194:195], v[126:127], v[126:127], v[194:195]
v_add_f32 v192, v192, v193
v_add_f32 v193, v194, v195
s_nop 1
v_permlane32_swap_b32 v192, v193
v_add_f32 v192, v192, v193
buffer_store_dword v192, v29, s[40:43], s94 offen sc1
s_cmp_lt_u32 s50, 8
s_cbranch_scc1 Lkv_22
v_cndmask_b32 v48, v224, 0, s[80:81]
v_cndmask_b32 v52, 0, v224, s[80:81]
v_cndmask_b32 v49, v225, 0, s[80:81]
v_cndmask_b32 v53, 0, v225, s[80:81]
v_cndmask_b32 v50, v226, 0, s[80:81]
v_cndmask_b32 v54, 0, v226, s[80:81]
v_cndmask_b32 v51, v227, 0, s[80:81]
v_cndmask_b32 v55, 0, v227, s[80:81]
v_cndmask_b32 v56, v228, 0, s[80:81]
v_cndmask_b32 v60, 0, v228, s[80:81]
v_cndmask_b32 v57, v229, 0, s[80:81]
v_cndmask_b32 v61, 0, v229, s[80:81]
v_cndmask_b32 v58, v230, 0, s[80:81]
v_cndmask_b32 v62, 0, v230, s[80:81]
v_cndmask_b32 v59, v231, 0, s[80:81]
v_cndmask_b32 v63, 0, v231, s[80:81]
v_pk_fma_f32 v[64:65], v[160:161], v[26:27], v[64:65] op_sel_hi:[1,0,1]
v_pk_fma_f32 v[66:67], v[162:163], v[26:27], v[66:67] op_sel_hi:[1,0,1]
v_pk_fma_f32 v[68:69], v[164:165], v[26:27], v[68:69] op_sel_hi:[1,0,1]
v_pk_fma_f32 v[70:71], v[166:167], v[26:27], v[70:71] op_sel_hi:[1,0,1]
v_pk_fma_f32 v[72:73], v[168:169], v[26:27], v[72:73] op_sel_hi:[1,0,1]
v_pk_fma_f32 v[74:75], v[170:171], v[26:27], v[74:75] op_sel_hi:[1,0,1]
v_pk_fma_f32 v[76:77], v[172:173], v[26:27], v[76:77] op_sel_hi:[1,0,1]
v_pk_fma_f32 v[78:79], v[174:175], v[26:27], v[78:79] op_sel_hi:[1,0,1]
v_pk_mul_f32 v[64:65], v[64:65], v[26:27] op_sel:[0,1] op_sel_hi:[1,1]
v_pk_mul_f32 v[66:67], v[66:67], v[26:27] op_sel:[0,1] op_sel_hi:[1,1]
v_pk_mul_f32 v[68:69], v[68:69], v[26:27] op_sel:[0,1] op_sel_hi:[1,1]
v_pk_mul_f32 v[70:71], v[70:71], v[26:27] op_sel:[0,1] op_sel_hi:[1,1]
v_pk_mul_f32 v[72:73], v[72:73], v[26:27] op_sel:[0,1] op_sel_hi:[1,1]
v_pk_mul_f32 v[74:75], v[74:75], v[26:27] op_sel:[0,1] op_sel_hi:[1,1]
v_pk_mul_f32 v[76:77], v[76:77], v[26:27] op_sel:[0,1] op_sel_hi:[1,1]
v_pk_mul_f32 v[78:79], v[78:79], v[26:27] op_sel:[0,1] op_sel_hi:[1,1]
v_pk_fma_f32 v[80:81], v[176:177], v[26:27], v[80:81] op_sel_hi:[1,0,1]
v_pk_fma_f32 v[82:83], v[178:179], v[26:27], v[82:83] op_sel_hi:[1,0,1]
v_pk_fma_f32 v[84:85], v[180:181], v[26:27], v[84:85] op_sel_hi:[1,0,1]
v_pk_fma_f32 v[86:87], v[182:183], v[26:27], v[86:87] op_sel_hi:[1,0,1]
s_add_u32 m0, s59, 0x18000
s_mul_i32 s64, s67, 3584
s_add_u32 s64, s64, s77
buffer_load_dwordx4 v2, s[28:31], s64 offen offset:0 lds
v_pk_fma_f32 v[88:89], v[184:185], v[26:27], v[88:89] op_sel_hi:[1,0,1]
v_pk_fma_f32 v[90:91], v[186:187], v[26:27], v[90:91] op_sel_hi:[1,0,1]
v_pk_fma_f32 v[92:93], v[188:189], v[26:27], v[92:93] op_sel_hi:[1,0,1]
v_pk_fma_f32 v[94:95], v[190:191], v[26:27], v[94:95] op_sel_hi:[1,0,1]
v_pk_mul_f32 v[80:81], v[80:81], v[26:27] op_sel:[0,1] op_sel_hi:[1,1]
v_pk_mul_f32 v[82:83], v[82:83], v[26:27] op_sel:[0,1] op_sel_hi:[1,1]
v_pk_mul_f32 v[84:85], v[84:85], v[26:27] op_sel:[0,1] op_sel_hi:[1,1]
v_pk_mul_f32 v[86:87], v[86:87], v[26:27] op_sel:[0,1] op_sel_hi:[1,1]
v_pk_mul_f32 v[88:89], v[88:89], v[26:27] op_sel:[0,1] op_sel_hi:[1,1]
v_pk_mul_f32 v[90:91], v[90:91], v[26:27] op_sel:[0,1] op_sel_hi:[1,1]
v_pk_mul_f32 v[92:93], v[92:93], v[26:27] op_sel:[0,1] op_sel_hi:[1,1]
v_pk_mul_f32 v[94:95], v[94:95], v[26:27] op_sel:[0,1] op_sel_hi:[1,1]
v_cvt_pk_bf16_f32 v32, v64, v65
v_cvt_pk_bf16_f32 v33, v66, v67
v_cvt_pk_bf16_f32 v34, v68, v69
v_cvt_pk_bf16_f32 v35, v70, v71
v_cvt_pk_bf16_f32 v36, v72, v73
v_cvt_pk_bf16_f32 v37, v74, v75
v_cvt_pk_bf16_f32 v38, v76, v77
v_cvt_pk_bf16_f32 v39, v78, v79
buffer_load_dwordx4 v3, s[28:31], s64 offen offset:1024 lds
v_cvt_pk_bf16_f32 v40, v80, v81
v_cvt_pk_bf16_f32 v41, v82, v83
v_cvt_pk_bf16_f32 v42, v84, v85
v_cvt_pk_bf16_f32 v43, v86, v87
v_cvt_pk_bf16_f32 v44, v88, v89
v_cvt_pk_bf16_f32 v45, v90, v91
v_cvt_pk_bf16_f32 v46, v92, v93
v_cvt_pk_bf16_f32 v47, v94, v95
v_mfma_f32_32x32x16_bf16 v[192:207], v[48:51], v[32:35], 0
v_mfma_f32_32x32x16_bf16 v[208:223], v[56:59], v[40:43], 0
v_mfma_f32_32x32x16_bf16 v[192:207], v[52:55], v[36:39], v[192:207]
v_mfma_f32_32x32x16_bf16 v[208:223], v[60:63], v[44:47], v[208:223]
v_and_b32 v23, 15, v0
v_lshlrev_b32 v23, 6, v23
s_lshl_b32 s96, s74, 10
s_add_u32 s96, s96, 0x1110000
s_nop 6
v_max3_f32 v80, v192, v193, v194
v_max3_f32 v100, v200, v201, v202
v_min3_f32 v81, v192, v193, v194
v_min3_f32 v101, v200, v201, v202
v_max3_f32 v80, v80, v195, v196
v_max3_f32 v100, v100, v203, v204
v_min3_f32 v81, v81, v195, v196
v_min3_f32 v101, v101, v203, v204
v_max3_f32 v80, v80, v197, v198
v_max3_f32 v100, v100, v205, v206
v_min3_f32 v81, v81, v197, v198
v_min3_f32 v101, v101, v205, v206
v_max_f32 v80, v80, v199
v_max_f32 v100, v100, v207
v_min_f32 v81, v81, v199
v_min_f32 v101, v101, v207
v_mul_f32 v80, 0x3fb8aa3b, v80
v_mul_f32 v100, 0x3fb8aa3b, v100
v_mul_f32 v81, 0xbfb8aa3b, v81
v_mul_f32 v101, 0xbfb8aa3b, v101
buffer_load_dwordx4 v4, s[28:31], s64 offen offset:2048 lds
v_permlane32_swap_b32 v80, v81
v_permlane32_swap_b32 v100, v101
v_max_f32 v80, v80, v81
v_max_f32 v100, v100, v101
v_mov_b32 v81, v80
v_mov_b32 v101, v100
s_nop 0
v_permlane32_swap_b32 v80, v81
v_permlane32_swap_b32 v100, v101
v_pk_fma_f32 v[64:65], v[192:193], s[78:79], v[80:81] op_sel_hi:[1,0,0] neg_lo:[0,0,1] neg_hi:[0,0,1]
v_pk_fma_f32 v[84:85], v[200:201], s[78:79], v[100:101] op_sel_hi:[1,0,0] neg_lo:[0,0,1] neg_hi:[0,0,1]
v_pk_fma_f32 v[72:73], v[192:193], s[78:79], v[80:81] op_sel:[0,0,1] op_sel_hi:[1,0,1] neg_lo:[1,0,1] neg_hi:[1,0,1]
v_pk_fma_f32 v[92:93], v[200:201], s[78:79], v[100:101] op_sel:[0,0,1] op_sel_hi:[1,0,1] neg_lo:[1,0,1] neg_hi:[1,0,1]
v_pk_fma_f32 v[66:67], v[194:195], s[78:79], v[80:81] op_sel_hi:[1,0,0] neg_lo:[0,0,1] neg_hi:[0,0,1]
v_pk_fma_f32 v[86:87], v[202:203], s[78:79], v[100:101] op_sel_hi:[1,0,0] neg_lo:[0,0,1] neg_hi:[0,0,1]
v_pk_fma_f32 v[74:75], v[194:195], s[78:79], v[80:81] op_sel:[0,0,1] op_sel_hi:[1,0,1] neg_lo:[1,0,1] neg_hi:[1,0,1]
v_pk_fma_f32 v[94:95], v[202:203], s[78:79], v[100:101] op_sel:[0,0,1] op_sel_hi:[1,0,1] neg_lo:[1,0,1] neg_hi:[1,0,1]
v_pk_fma_f32 v[68:69], v[196:197], s[78:79], v[80:81] op_sel_hi:[1,0,0] neg_lo:[0,0,1] neg_hi:[0,0,1]
v_pk_fma_f32 v[88:89], v[204:205], s[78:79], v[100:101] op_sel_hi:[1,0,0] neg_lo:[0,0,1] neg_hi:[0,0,1]
v_pk_fma_f32 v[76:77], v[196:197], s[78:79], v[80:81] op_sel:[0,0,1] op_sel_hi:[1,0,1] neg_lo:[1,0,1] neg_hi:[1,0,1]
v_pk_fma_f32 v[96:97], v[204:205], s[78:79], v[100:101] op_sel:[0,0,1] op_sel_hi:[1,0,1] neg_lo:[1,0,1] neg_hi:[1,0,1]
buffer_load_dwordx4 v5, s[28:31], s64 offen offset:3072 lds
s_waitcnt vmcnt(4)
s_mov_b64 exec, 0xffff
buffer_store_dword v30, v29, s[40:43], s99 offen sc1
s_mov_b64 exec, -1
v_pk_fma_f32 v[70:71], v[198:199], s[78:79], v[80:81] op_sel_hi:[1,0,0] neg_lo:[0,0,1] neg_hi:[0,0,1]
v_pk_fma_f32 v[90:91], v[206:207], s[78:79], v[100:101] op_sel_hi:[1,0,0] neg_lo:[0,0,1] neg_hi:[0,0,1]
v_pk_fma_f32 v[78:79], v[198:199], s[78:79], v[80:81] op_sel:[0,0,1] op_sel_hi:[1,0,1] neg_lo:[1,0,1] neg_hi:[1,0,1]
v_pk_fma_f32 v[98:99], v[206:207], s[78:79], v[100:101] op_sel:[0,0,1] op_sel_hi:[1,0,1] neg_lo:[1,0,1] neg_hi:[1,0,1]
v_exp_f32 v64, v64
v_exp_f32 v84, v84
v_exp_f32 v65, v65
v_exp_f32 v85, v85
v_exp_f32 v66, v66
v_exp_f32 v86, v86
v_exp_f32 v67, v67
v_exp_f32 v87, v87
v_exp_f32 v68, v68
v_exp_f32 v88, v88
v_exp_f32 v69, v69
v_exp_f32 v89, v89
v_exp_f32 v70, v70
v_exp_f32 v90, v90
v_exp_f32 v71, v71
v_exp_f32 v91, v91
s_add_u32 m0, s59, 0x1c000
s_mul_i32 s64, s68, 3584
s_add_u32 s64, s64, s77
buffer_load_dwordx4 v2, s[28:31], s64 offen offset:0 lds
v_exp_f32 v72, v72
v_exp_f32 v92, v92
v_exp_f32 v73, v73
v_exp_f32 v93, v93
v_exp_f32 v74, v74
v_exp_f32 v94, v94
v_exp_f32 v75, v75
v_exp_f32 v95, v95
v_exp_f32 v76, v76
v_exp_f32 v96, v96
v_exp_f32 v77, v77
v_exp_f32 v97, v97
v_exp_f32 v78, v78
v_exp_f32 v98, v98
v_exp_f32 v79, v79
v_exp_f32 v99, v99
v_pk_add_f32 v[80:81], v[64:65], v[66:67]
v_pk_add_f32 v[100:101], v[84:85], v[86:87]
v_pk_add_f32 v[82:83], v[72:73], v[74:75]
v_pk_add_f32 v[102:103], v[92:93], v[94:95]
buffer_load_dwordx4 v3, s[28:31], s64 offen offset:1024 lds
v_pk_add_f32 v[80:81], v[80:81], v[68:69]
v_pk_add_f32 v[100:101], v[100:101], v[88:89]
v_pk_add_f32 v[82:83], v[82:83], v[76:77]
v_pk_add_f32 v[102:103], v[102:103], v[96:97]
v_pk_add_f32 v[80:81], v[80:81], v[70:71]
v_pk_add_f32 v[100:101], v[100:101], v[90:91]
v_pk_add_f32 v[82:83], v[82:83], v[78:79]
v_pk_add_f32 v[102:103], v[102:103], v[98:99]
v_add_f32 v80, v80, v81
v_add_f32 v100, v100, v101
v_add_f32 v81, v82, v83
v_add_f32 v101, v102, v103
s_nop 0
v_permlane32_swap_b32 v80, v81
v_permlane32_swap_b32 v100, v101
v_add_f32 v80, v80, v81
v_add_f32 v100, v100, v101
v_mov_b32 v81, v80
v_mov_b32 v101, v100
s_nop 0
v_permlane32_swap_b32 v80, v81
v_permlane32_swap_b32 v100, v101
buffer_load_dwordx4 v4, s[28:31], s64 offen offset:2048 lds
v_rcp_f32 v80, v80
v_rcp_f32 v100, v100
v_rcp_f32 v81, v81
v_rcp_f32 v101, v101
v_pk_mul_f32 v[64:65], v[64:65], v[80:81] op_sel_hi:[1,0]
v_pk_mul_f32 v[84:85], v[84:85], v[100:101] op_sel_hi:[1,0]
v_pk_mul_f32 v[72:73], v[72:73], v[80:81] op_sel:[0,1] op_sel_hi:[1,1]
v_pk_mul_f32 v[92:93], v[92:93], v[100:101] op_sel:[0,1] op_sel_hi:[1,1]
v_pk_mul_f32 v[66:67], v[66:67], v[80:81] op_sel_hi:[1,0]
v_pk_mul_f32 v[86:87], v[86:87], v[100:101] op_sel_hi:[1,0]
v_pk_mul_f32 v[74:75], v[74:75], v[80:81] op_sel:[0,1] op_sel_hi:[1,1]
v_pk_mul_f32 v[94:95], v[94:95], v[100:101] op_sel:[0,1] op_sel_hi:[1,1]
v_pk_mul_f32 v[68:69], v[68:69], v[80:81] op_sel_hi:[1,0]
v_pk_mul_f32 v[88:89], v[88:89], v[100:101] op_sel_hi:[1,0]
v_pk_mul_f32 v[76:77], v[76:77], v[80:81] op_sel:[0,1] op_sel_hi:[1,1]
v_pk_mul_f32 v[96:97], v[96:97], v[100:101] op_sel:[0,1] op_sel_hi:[1,1]
v_pk_mul_f32 v[70:71], v[70:71], v[80:81] op_sel_hi:[1,0]
v_pk_mul_f32 v[90:91], v[90:91], v[100:101] op_sel_hi:[1,0]
v_pk_mul_f32 v[78:79], v[78:79], v[80:81] op_sel:[0,1] op_sel_hi:[1,1]
v_pk_mul_f32 v[98:99], v[98:99], v[100:101] op_sel:[0,1] op_sel_hi:[1,1]
buffer_load_dwordx4 v5, s[28:31], s64 offen offset:3072 lds
v_cvt_pk_bf16_f32 v224, v64, v65
v_cvt_pk_bf16_f32 v232, v84, v85
v_cvt_pk_bf16_f32 v225, v66, v67
v_cvt_pk_bf16_f32 v233, v86, v87
v_cvt_pk_bf16_f32 v226, v68, v69
v_cvt_pk_bf16_f32 v234, v88, v89
v_cvt_pk_bf16_f32 v227, v70, v71
v_cvt_pk_bf16_f32 v235, v90, v91
v_cvt_pk_bf16_f32 v228, v72, v73
v_cvt_pk_bf16_f32 v236, v92, v93
v_cvt_pk_bf16_f32 v229, v74, v75
v_cvt_pk_bf16_f32 v237, v94, v95
v_cvt_pk_bf16_f32 v230, v76, v77
v_cvt_pk_bf16_f32 v238, v96, v97
v_cvt_pk_bf16_f32 v231, v78, v79
v_cvt_pk_bf16_f32 v239, v98, v99
v_max3_f32 v80, v208, v209, v210
v_max3_f32 v100, v216, v217, v218
v_min3_f32 v81, v208, v209, v210
v_min3_f32 v101, v216, v217, v218
v_max3_f32 v80, v80, v211, v212
v_max3_f32 v100, v100, v219, v220
v_min3_f32 v81, v81, v211, v212
v_min3_f32 v101, v101, v219, v220
v_max3_f32 v80, v80, v213, v214
v_max3_f32 v100, v100, v221, v222
v_min3_f32 v81, v81, v213, v214
v_min3_f32 v101, v101, v221, v222
v_max_f32 v80, v80, v215
v_max_f32 v100, v100, v223
v_min_f32 v81, v81, v215
v_min_f32 v101, v101, v223
v_mul_f32 v80, 0x3fb8aa3b, v80
v_mul_f32 v100, 0x3fb8aa3b, v100
v_mul_f32 v81, 0xbfb8aa3b, v81
v_mul_f32 v101, 0xbfb8aa3b, v101
s_add_u32 m0, s59, 0x14000
s_mul_i32 s64, s66, 3584
s_add_u32 s64, s64, s77
s_add_u32 s64, s64, 0x80
buffer_load_dwordx4 v2, s[28:31], s64 offen offset:0 lds
v_permlane32_swap_b32 v80, v81
v_permlane32_swap_b32 v100, v101
v_max_f32 v80, v80, v81
v_max_f32 v100, v100, v101
v_mov_b32 v81, v80
v_mov_b32 v101, v100
s_nop 0
v_permlane32_swap_b32 v80, v81
v_permlane32_swap_b32 v100, v101
v_pk_fma_f32 v[64:65], v[208:209], s[78:79], v[80:81] op_sel_hi:[1,0,0] neg_lo:[0,0,1] neg_hi:[0,0,1]
v_pk_fma_f32 v[84:85], v[216:217], s[78:79], v[100:101] op_sel_hi:[1,0,0] neg_lo:[0,0,1] neg_hi:[0,0,1]
v_pk_fma_f32 v[72:73], v[208:209], s[78:79], v[80:81] op_sel:[0,0,1] op_sel_hi:[1,0,1] neg_lo:[1,0,1] neg_hi:[1,0,1]
v_pk_fma_f32 v[92:93], v[216:217], s[78:79], v[100:101] op_sel:[0,0,1] op_sel_hi:[1,0,1] neg_lo:[1,0,1] neg_hi:[1,0,1]
v_pk_fma_f32 v[66:67], v[210:211], s[78:79], v[80:81] op_sel_hi:[1,0,0] neg_lo:[0,0,1] neg_hi:[0,0,1]
v_pk_fma_f32 v[86:87], v[218:219], s[78:79], v[100:101] op_sel_hi:[1,0,0] neg_lo:[0,0,1] neg_hi:[0,0,1]
v_pk_fma_f32 v[74:75], v[210:211], s[78:79], v[80:81] op_sel:[0,0,1] op_sel_hi:[1,0,1] neg_lo:[1,0,1] neg_hi:[1,0,1]
v_pk_fma_f32 v[94:95], v[218:219], s[78:79], v[100:101] op_sel:[0,0,1] op_sel_hi:[1,0,1] neg_lo:[1,0,1] neg_hi:[1,0,1]
v_pk_fma_f32 v[68:69], v[212:213], s[78:79], v[80:81] op_sel_hi:[1,0,0] neg_lo:[0,0,1] neg_hi:[0,0,1]
v_pk_fma_f32 v[88:89], v[220:221], s[78:79], v[100:101] op_sel_hi:[1,0,0] neg_lo:[0,0,1] neg_hi:[0,0,1]
v_pk_fma_f32 v[76:77], v[212:213], s[78:79], v[80:81] op_sel:[0,0,1] op_sel_hi:[1,0,1] neg_lo:[1,0,1] neg_hi:[1,0,1]
v_pk_fma_f32 v[96:97], v[220:221], s[78:79], v[100:101] op_sel:[0,0,1] op_sel_hi:[1,0,1] neg_lo:[1,0,1] neg_hi:[1,0,1]
buffer_load_dwordx4 v3, s[28:31], s64 offen offset:1024 lds
v_pk_fma_f32 v[70:71], v[214:215], s[78:79], v[80:81] op_sel_hi:[1,0,0] neg_lo:[0,0,1] neg_hi:[0,0,1]
v_pk_fma_f32 v[90:91], v[222:223], s[78:79], v[100:101] op_sel_hi:[1,0,0] neg_lo:[0,0,1] neg_hi:[0,0,1]
v_pk_fma_f32 v[78:79], v[214:215], s[78:79], v[80:81] op_sel:[0,0,1] op_sel_hi:[1,0,1] neg_lo:[1,0,1] neg_hi:[1,0,1]
v_pk_fma_f32 v[98:99], v[222:223], s[78:79], v[100:101] op_sel:[0,0,1] op_sel_hi:[1,0,1] neg_lo:[1,0,1] neg_hi:[1,0,1]
v_exp_f32 v64, v64
v_exp_f32 v84, v84
v_exp_f32 v65, v65
v_exp_f32 v85, v85
v_exp_f32 v66, v66
v_exp_f32 v86, v86
v_exp_f32 v67, v67
v_exp_f32 v87, v87
v_exp_f32 v68, v68
v_exp_f32 v88, v88
v_exp_f32 v69, v69
v_exp_f32 v89, v89
v_exp_f32 v70, v70
v_exp_f32 v90, v90
v_exp_f32 v71, v71
v_exp_f32 v91, v91
buffer_load_dwordx4 v4, s[28:31], s64 offen offset:2048 lds
v_exp_f32 v72, v72
v_exp_f32 v92, v92
v_exp_f32 v73, v73
v_exp_f32 v93, v93
v_exp_f32 v74, v74
v_exp_f32 v94, v94
v_exp_f32 v75, v75
v_exp_f32 v95, v95
v_exp_f32 v76, v76
v_exp_f32 v96, v96
v_exp_f32 v77, v77
v_exp_f32 v97, v97
v_exp_f32 v78, v78
v_exp_f32 v98, v98
v_exp_f32 v79, v79
v_exp_f32 v99, v99
v_pk_add_f32 v[80:81], v[64:65], v[66:67]
v_pk_add_f32 v[100:101], v[84:85], v[86:87]
v_pk_add_f32 v[82:83], v[72:73], v[74:75]
v_pk_add_f32 v[102:103], v[92:93], v[94:95]
buffer_load_dwordx4 v5, s[28:31], s64 offen offset:3072 lds
v_pk_add_f32 v[80:81], v[80:81], v[68:69]
v_pk_add_f32 v[100:101], v[100:101], v[88:89]
v_pk_add_f32 v[82:83], v[82:83], v[76:77]
v_pk_add_f32 v[102:103], v[102:103], v[96:97]
v_pk_add_f32 v[80:81], v[80:81], v[70:71]
v_pk_add_f32 v[100:101], v[100:101], v[90:91]
v_pk_add_f32 v[82:83], v[82:83], v[78:79]
v_pk_add_f32 v[102:103], v[102:103], v[98:99]
v_add_f32 v80, v80, v81
v_add_f32 v100, v100, v101
v_add_f32 v81, v82, v83
v_add_f32 v101, v102, v103
s_nop 0
v_permlane32_swap_b32 v80, v81
v_permlane32_swap_b32 v100, v101
v_add_f32 v80, v80, v81
v_add_f32 v100, v100, v101
v_mov_b32 v81, v80
v_mov_b32 v101, v100
s_nop 0
v_permlane32_swap_b32 v80, v81
v_permlane32_swap_b32 v100, v101
v_rcp_f32 v80, v80
v_rcp_f32 v100, v100
v_rcp_f32 v81, v81
v_rcp_f32 v101, v101
v_pk_mul_f32 v[64:65], v[64:65], v[80:81] op_sel_hi:[1,0]
v_pk_mul_f32 v[84:85], v[84:85], v[100:101] op_sel_hi:[1,0]
v_pk_mul_f32 v[72:73], v[72:73], v[80:81] op_sel:[0,1] op_sel_hi:[1,1]
v_pk_mul_f32 v[92:93], v[92:93], v[100:101] op_sel:[0,1] op_sel_hi:[1,1]
v_pk_mul_f32 v[66:67], v[66:67], v[80:81] op_sel_hi:[1,0]
v_pk_mul_f32 v[86:87], v[86:87], v[100:101] op_sel_hi:[1,0]
v_pk_mul_f32 v[74:75], v[74:75], v[80:81] op_sel:[0,1] op_sel_hi:[1,1]
v_pk_mul_f32 v[94:95], v[94:95], v[100:101] op_sel:[0,1] op_sel_hi:[1,1]
v_pk_mul_f32 v[68:69], v[68:69], v[80:81] op_sel_hi:[1,0]
v_pk_mul_f32 v[88:89], v[88:89], v[100:101] op_sel_hi:[1,0]
v_pk_mul_f32 v[76:77], v[76:77], v[80:81] op_sel:[0,1] op_sel_hi:[1,1]
v_pk_mul_f32 v[96:97], v[96:97], v[100:101] op_sel:[0,1] op_sel_hi:[1,1]
v_pk_mul_f32 v[70:71], v[70:71], v[80:81] op_sel_hi:[1,0]
v_pk_mul_f32 v[90:91], v[90:91], v[100:101] op_sel_hi:[1,0]
v_pk_mul_f32 v[78:79], v[78:79], v[80:81] op_sel:[0,1] op_sel_hi:[1,1]
v_pk_mul_f32 v[98:99], v[98:99], v[100:101] op_sel:[0,1] op_sel_hi:[1,1]
v_cvt_pk_bf16_f32 v240, v64, v65
v_cvt_pk_bf16_f32 v248, v84, v85
v_cvt_pk_bf16_f32 v241, v66, v67
v_cvt_pk_bf16_f32 v249, v86, v87
v_cvt_pk_bf16_f32 v242, v68, v69
v_cvt_pk_bf16_f32 v250, v88, v89
v_cvt_pk_bf16_f32 v243, v70, v71
v_cvt_pk_bf16_f32 v251, v90, v91
v_cvt_pk_bf16_f32 v244, v72, v73
v_cvt_pk_bf16_f32 v252, v92, v93
v_cvt_pk_bf16_f32 v245, v74, v75
v_cvt_pk_bf16_f32 v253, v94, v95
v_cvt_pk_bf16_f32 v246, v76, v77
v_cvt_pk_bf16_f32 v254, v96, v97
v_cvt_pk_bf16_f32 v247, v78, v79
v_cvt_pk_bf16_f32 v255, v98, v99
v_mov_b32 v24, v30
s_mov_b64 exec, 0xffff
buffer_load_dword v24, v23, s[40:43], s96 offen sc1
s_mov_b64 exec, -1
s_branch Ljoin_23
Lkv_22:
v_accvgpr_read_b32 v192, a80
v_accvgpr_read_b32 v196, a81
v_xor_b32 v193, 16, v192
v_xor_b32 v194, 32, v192
v_xor_b32 v195, 48, v192
v_xor_b32 v197, 16, v196
v_xor_b32 v198, 32, v196
v_xor_b32 v199, 48, v196
v_xor_b32 v200, 64, v196
v_xor_b32 v201, 80, v196
v_xor_b32 v202, 96, v196
v_xor_b32 v203, 112, v196
v_pk_fma_f32 v[64:65], v[160:161], v[26:27], v[64:65] op_sel_hi:[1,0,1]
v_pk_fma_f32 v[66:67], v[162:163], v[26:27], v[66:67] op_sel_hi:[1,0,1]
v_pk_fma_f32 v[68:69], v[164:165], v[26:27], v[68:69] op_sel_hi:[1,0,1]
v_pk_fma_f32 v[70:71], v[166:167], v[26:27], v[70:71] op_sel_hi:[1,0,1]
v_pk_fma_f32 v[72:73], v[168:169], v[26:27], v[72:73] op_sel_hi:[1,0,1]
v_pk_fma_f32 v[74:75], v[170:171], v[26:27], v[74:75] op_sel_hi:[1,0,1]
ds_write_b64 v192, a[64:65] offset:0
v_pk_fma_f32 v[76:77], v[172:173], v[26:27], v[76:77] op_sel_hi:[1,0,1]
v_pk_fma_f32 v[78:79], v[174:175], v[26:27], v[78:79] op_sel_hi:[1,0,1]
v_pk_mul_f32 v[64:65], v[64:65], v[26:27] op_sel:[0,1] op_sel_hi:[1,1]
v_pk_mul_f32 v[66:67], v[66:67], v[26:27] op_sel:[0,1] op_sel_hi:[1,1]
v_pk_mul_f32 v[68:69], v[68:69], v[26:27] op_sel:[0,1] op_sel_hi:[1,1]
v_pk_mul_f32 v[70:71], v[70:71], v[26:27] op_sel:[0,1] op_sel_hi:[1,1]
ds_write_b64 v193, a[66:67] offset:0
v_pk_mul_f32 v[72:73], v[72:73], v[26:27] op_sel:[0,1] op_sel_hi:[1,1]
v_pk_mul_f32 v[74:75], v[74:75], v[26:27] op_sel:[0,1] op_sel_hi:[1,1]
v_pk_mul_f32 v[76:77], v[76:77], v[26:27] op_sel:[0,1] op_sel_hi:[1,1]
s_add_u32 m0, s59, 0x18000
s_mul_i32 s64, s67, 3584
s_add_u32 s64, s64, s77
buffer_load_dwordx4 v2, s[28:31], s64 offen offset:0 lds
v_pk_mul_f32 v[78:79], v[78:79], v[26:27] op_sel:[0,1] op_sel_hi:[1,1]
v_pk_fma_f32 v[80:81], v[176:177], v[26:27], v[80:81] op_sel_hi:[1,0,1]
v_pk_fma_f32 v[82:83], v[178:179], v[26:27], v[82:83] op_sel_hi:[1,0,1]
ds_write_b64 v194, a[68:69] offset:0
v_pk_fma_f32 v[84:85], v[180:181], v[26:27], v[84:85] op_sel_hi:[1,0,1]
v_pk_fma_f32 v[86:87], v[182:183], v[26:27], v[86:87] op_sel_hi:[1,0,1]
v_pk_fma_f32 v[88:89], v[184:185], v[26:27], v[88:89] op_sel_hi:[1,0,1]
v_pk_fma_f32 v[90:91], v[186:187], v[26:27], v[90:91] op_sel_hi:[1,0,1]
v_pk_fma_f32 v[92:93], v[188:189], v[26:27], v[92:93] op_sel_hi:[1,0,1]
v_pk_fma_f32 v[94:95], v[190:191], v[26:27], v[94:95] op_sel_hi:[1,0,1]
ds_write_b64 v195, a[70:71] offset:0
v_pk_mul_f32 v[80:81], v[80:81], v[26:27] op_sel:[0,1] op_sel_hi:[1,1]
v_pk_mul_f32 v[82:83], v[82:83], v[26:27] op_sel:[0,1] op_sel_hi:[1,1]
v_pk_mul_f32 v[84:85], v[84:85], v[26:27] op_sel:[0,1] op_sel_hi:[1,1]
v_pk_mul_f32 v[86:87], v[86:87], v[26:27] op_sel:[0,1] op_sel_hi:[1,1]
v_pk_mul_f32 v[88:89], v[88:89], v[26:27] op_sel:[0,1] op_sel_hi:[1,1]
v_pk_mul_f32 v[90:91], v[90:91], v[26:27] op_sel:[0,1] op_sel_hi:[1,1]
buffer_load_dwordx4 v3, s[28:31], s64 offen offset:1024 lds
ds_write_b64 v192, a[72:73] offset:8192
v_pk_mul_f32 v[92:93], v[92:93], v[26:27] op_sel:[0,1] op_sel_hi:[1,1]
v_pk_mul_f32 v[94:95], v[94:95], v[26:27] op_sel:[0,1] op_sel_hi:[1,1]
v_cvt_pk_bf16_f32 v32, v64, v65
v_cvt_pk_bf16_f32 v33, v66, v67
v_cvt_pk_bf16_f32 v34, v68, v69
v_cvt_pk_bf16_f32 v35, v70, v71
ds_write_b64 v193, a[74:75] offset:8192
v_cvt_pk_bf16_f32 v36, v72, v73
v_cvt_pk_bf16_f32 v37, v74, v75
v_cvt_pk_bf16_f32 v38, v76, v77
v_cvt_pk_bf16_f32 v39, v78, v79
v_cvt_pk_bf16_f32 v40, v80, v81
v_cvt_pk_bf16_f32 v41, v82, v83
ds_write_b64 v194, a[76:77] offset:8192
v_cvt_pk_bf16_f32 v42, v84, v85
v_cvt_pk_bf16_f32 v43, v86, v87
buffer_load_dwordx4 v4, s[28:31], s64 offen offset:2048 lds
v_cvt_pk_bf16_f32 v44, v88, v89
v_cvt_pk_bf16_f32 v45, v90, v91
v_cvt_pk_bf16_f32 v46, v92, v93
v_cvt_pk_bf16_f32 v47, v94, v95
ds_write_b64 v195, a[78:79] offset:8192
v_max3_f32 v48, v96, v97, v98
v_max3_f32 v52, v104, v105, v106
v_min3_f32 v49, v96, v97, v98
v_min3_f32 v53, v104, v105, v106
v_max3_f32 v48, v48, v99, v100
v_max3_f32 v52, v52, v107, v108
ds_write_b64 v196, v[32:33]
v_min3_f32 v49, v49, v99, v100
v_min3_f32 v53, v53, v107, v108
v_max3_f32 v48, v48, v101, v102
v_max3_f32 v52, v52, v109, v110
v_min3_f32 v49, v49, v101, v102
v_min3_f32 v53, v53, v109, v110
ds_write_b64 v197, v[34:35]
v_max_f32 v48, v48, v103
v_max_f32 v52, v52, v111
v_min_f32 v49, v49, v103
buffer_load_dwordx4 v5, s[28:31], s64 offen offset:3072 lds
v_min_f32 v53, v53, v111
v_mul_f32 v48, 0x3fb8aa3b, v48
v_mul_f32 v52, 0x3fb8aa3b, v52
ds_write_b64 v198, v[36:37]
v_mul_f32 v49, 0xbfb8aa3b, v49
v_mul_f32 v53, 0xbfb8aa3b, v53
s_nop 0
v_permlane32_swap_b32 v48, v49
v_permlane32_swap_b32 v52, v53
v_max_f32 v48, v48, v49
v_max_f32 v52, v52, v53
ds_write_b64 v199, v[38:39]
v_mov_b32 v49, v48
v_mov_b32 v53, v52
s_nop 0
v_permlane32_swap_b32 v48, v49
v_permlane32_swap_b32 v52, v53
v_pk_fma_f32 v[64:65], v[96:97], s[78:79], v[48:49] op_sel_hi:[1,0,0] neg_lo:[0,0,1] neg_hi:[0,0,1]
v_pk_fma_f32 v[80:81], v[104:105], s[78:79], v[52:53] op_sel_hi:[1,0,0] neg_lo:[0,0,1] neg_hi:[0,0,1]
s_add_u32 m0, s59, 0x1c000
s_mul_i32 s64, s68, 3584
s_add_u32 s64, s64, s77
buffer_load_dwordx4 v2, s[28:31], s64 offen offset:0 lds
ds_write_b64 v200, v[40:41]
v_pk_fma_f32 v[72:73], v[96:97], s[78:79], v[48:49] op_sel:[0,0,1] op_sel_hi:[1,0,1] neg_lo:[1,0,1] neg_hi:[1,0,1]
v_pk_fma_f32 v[88:89], v[104:105], s[78:79], v[52:53] op_sel:[0,0,1] op_sel_hi:[1,0,1] neg_lo:[1,0,1] neg_hi:[1,0,1]
v_pk_fma_f32 v[66:67], v[98:99], s[78:79], v[48:49] op_sel_hi:[1,0,0] neg_lo:[0,0,1] neg_hi:[0,0,1]
v_pk_fma_f32 v[82:83], v[106:107], s[78:79], v[52:53] op_sel_hi:[1,0,0] neg_lo:[0,0,1] neg_hi:[0,0,1]
v_pk_fma_f32 v[74:75], v[98:99], s[78:79], v[48:49] op_sel:[0,0,1] op_sel_hi:[1,0,1] neg_lo:[1,0,1] neg_hi:[1,0,1]
s_waitcnt vmcnt(5)
s_mov_b64 exec, 0xffff
buffer_store_dword v30, v29, s[40:43], s99 offen sc1
s_mov_b64 exec, -1
v_accvgpr_read_b32 v204, a82
v_accvgpr_read_b32 v205, a83
v_accvgpr_read_b32 v206, a84
v_accvgpr_read_b32 v207, a85
v_accvgpr_read_b32 v208, a86
v_add_u32 v192, 0x1c000, v192
v_add_u32 v193, 0x1c000, v193
v_add_u32 v194, 0x1c000, v194
v_add_u32 v195, 0x1c000, v195
v_and_b32 v23, 15, v0
v_lshlrev_b32 v23, 6, v23
s_lshl_b32 s96, s74, 10
s_add_u32 s96, s96, 0x1110000
s_lshl_b32 s60, s51, 4
s_add_u32 s60, s60, s49
s_lshl_b32 s60, s60, 14
s_add_u32 s60, s60, s59
s_add_u32 s93, s60, 0x2400000
v_pk_fma_f32 v[90:91], v[106:107], s[78:79], v[52:53] op_sel:[0,0,1] op_sel_hi:[1,0,1] neg_lo:[1,0,1] neg_hi:[1,0,1]
ds_write_b64 v201, v[42:43]
v_pk_fma_f32 v[68:69], v[100:101], s[78:79], v[48:49] op_sel_hi:[1,0,0] neg_lo:[0,0,1] neg_hi:[0,0,1]
v_pk_fma_f32 v[84:85], v[108:109], s[78:79], v[52:53] op_sel_hi:[1,0,0] neg_lo:[0,0,1] neg_hi:[0,0,1]
v_pk_fma_f32 v[76:77], v[100:101], s[78:79], v[48:49] op_sel:[0,0,1] op_sel_hi:[1,0,1] neg_lo:[1,0,1] neg_hi:[1,0,1]
v_pk_fma_f32 v[92:93], v[108:109], s[78:79], v[52:53] op_sel:[0,0,1] op_sel_hi:[1,0,1] neg_lo:[1,0,1] neg_hi:[1,0,1]
v_pk_fma_f32 v[70:71], v[102:103], s[78:79], v[48:49] op_sel_hi:[1,0,0] neg_lo:[0,0,1] neg_hi:[0,0,1]
v_pk_fma_f32 v[86:87], v[110:111], s[78:79], v[52:53] op_sel_hi:[1,0,0] neg_lo:[0,0,1] neg_hi:[0,0,1]
ds_write_b64 v202, v[44:45]
v_pk_fma_f32 v[78:79], v[102:103], s[78:79], v[48:49] op_sel:[0,0,1] op_sel_hi:[1,0,1] neg_lo:[1,0,1] neg_hi:[1,0,1]
v_pk_fma_f32 v[94:95], v[110:111], s[78:79], v[52:53] op_sel:[0,0,1] op_sel_hi:[1,0,1] neg_lo:[1,0,1] neg_hi:[1,0,1]
v_exp_f32 v64, v64
v_exp_f32 v80, v80
v_exp_f32 v65, v65
v_exp_f32 v81, v81
ds_write_b64 v203, v[46:47]
v_exp_f32 v66, v66
buffer_load_dwordx4 v3, s[28:31], s64 offen offset:1024 lds
v_exp_f32 v82, v82
v_exp_f32 v67, v67
v_exp_f32 v83, v83
v_exp_f32 v68, v68
v_exp_f32 v84, v84
v_exp_f32 v69, v69
v_exp_f32 v85, v85
v_exp_f32 v70, v70
v_exp_f32 v86, v86
v_exp_f32 v71, v71
v_exp_f32 v87, v87
v_exp_f32 v72, v72
v_exp_f32 v88, v88
v_exp_f32 v73, v73
v_exp_f32 v89, v89
v_exp_f32 v74, v74
v_exp_f32 v90, v90
buffer_load_dwordx4 v4, s[28:31], s64 offen offset:2048 lds
v_exp_f32 v75, v75
v_exp_f32 v91, v91
v_exp_f32 v76, v76
v_exp_f32 v92, v92
v_exp_f32 v77, v77
v_exp_f32 v93, v93
v_exp_f32 v78, v78
v_exp_f32 v94, v94
v_exp_f32 v79, v79
v_exp_f32 v95, v95
v_pk_add_f32 v[48:49], v[64:65], v[66:67]
v_pk_add_f32 v[52:53], v[80:81], v[82:83]
v_pk_add_f32 v[50:51], v[72:73], v[74:75]
v_pk_add_f32 v[54:55], v[88:89], v[90:91]
v_pk_add_f32 v[48:49], v[48:49], v[68:69]
v_pk_add_f32 v[52:53], v[52:53], v[84:85]
v_pk_add_f32 v[50:51], v[50:51], v[76:77]
buffer_load_dwordx4 v5, s[28:31], s64 offen offset:3072 lds
v_pk_add_f32 v[54:55], v[54:55], v[92:93]
v_pk_add_f32 v[48:49], v[48:49], v[70:71]
v_pk_add_f32 v[52:53], v[52:53], v[86:87]
v_pk_add_f32 v[50:51], v[50:51], v[78:79]
v_pk_add_f32 v[54:55], v[54:55], v[94:95]
v_add_f32 v48, v48, v49
v_add_f32 v52, v52, v53
v_add_f32 v49, v50, v51
v_add_f32 v53, v54, v55
s_nop 0
v_permlane32_swap_b32 v48, v49
v_permlane32_swap_b32 v52, v53
v_add_f32 v48, v48, v49
v_add_f32 v52, v52, v53
v_mov_b32 v49, v48
v_mov_b32 v53, v52
s_nop 0
v_permlane32_swap_b32 v48, v49
v_permlane32_swap_b32 v52, v53
s_add_u32 m0, s59, 0x14000
s_mul_i32 s64, s66, 3584
s_add_u32 s64, s64, s77
s_add_u32 s64, s64, 0x80
buffer_load_dwordx4 v2, s[28:31], s64 offen offset:0 lds
v_rcp_f32 v48, v48
v_rcp_f32 v52, v52
v_rcp_f32 v49, v49
v_rcp_f32 v53, v53
v_pk_mul_f32 v[64:65], v[64:65], v[48:49] op_sel_hi:[1,0]
v_pk_mul_f32 v[80:81], v[80:81], v[52:53] op_sel_hi:[1,0]
v_pk_mul_f32 v[72:73], v[72:73], v[48:49] op_sel:[0,1] op_sel_hi:[1,1]
v_pk_mul_f32 v[88:89], v[88:89], v[52:53] op_sel:[0,1] op_sel_hi:[1,1]
v_pk_mul_f32 v[66:67], v[66:67], v[48:49] op_sel_hi:[1,0]
v_pk_mul_f32 v[82:83], v[82:83], v[52:53] op_sel_hi:[1,0]
v_pk_mul_f32 v[74:75], v[74:75], v[48:49] op_sel:[0,1] op_sel_hi:[1,1]
v_pk_mul_f32 v[90:91], v[90:91], v[52:53] op_sel:[0,1] op_sel_hi:[1,1]
v_pk_mul_f32 v[68:69], v[68:69], v[48:49] op_sel_hi:[1,0]
v_pk_mul_f32 v[84:85], v[84:85], v[52:53] op_sel_hi:[1,0]
v_pk_mul_f32 v[76:77], v[76:77], v[48:49] op_sel:[0,1] op_sel_hi:[1,1]
v_pk_mul_f32 v[92:93], v[92:93], v[52:53] op_sel:[0,1] op_sel_hi:[1,1]
v_pk_mul_f32 v[70:71], v[70:71], v[48:49] op_sel_hi:[1,0]
buffer_load_dwordx4 v3, s[28:31], s64 offen offset:1024 lds
v_pk_mul_f32 v[86:87], v[86:87], v[52:53] op_sel_hi:[1,0]
v_pk_mul_f32 v[78:79], v[78:79], v[48:49] op_sel:[0,1] op_sel_hi:[1,1]
v_pk_mul_f32 v[94:95], v[94:95], v[52:53] op_sel:[0,1] op_sel_hi:[1,1]
buffer_load_dwordx4 v4, s[28:31], s64 offen offset:2048 lds
buffer_load_dwordx4 v5, s[28:31], s64 offen offset:3072 lds
v_cvt_pk_bf16_f32 v224, v64, v65
v_cvt_pk_bf16_f32 v232, v80, v81
v_cvt_pk_bf16_f32 v225, v66, v67
v_cvt_pk_bf16_f32 v233, v82, v83
ds_write_b64 v192, v[224:225] offset:0
ds_write_b64 v192, v[232:233] offset:8192
v_cvt_pk_bf16_f32 v226, v68, v69
v_cvt_pk_bf16_f32 v234, v84, v85
v_cvt_pk_bf16_f32 v227, v70, v71
v_cvt_pk_bf16_f32 v235, v86, v87
ds_write_b64 v193, v[226:227] offset:0
ds_write_b64 v193, v[234:235] offset:8192
v_cvt_pk_bf16_f32 v228, v72, v73
v_cvt_pk_bf16_f32 v236, v88, v89
v_cvt_pk_bf16_f32 v229, v74, v75
v_cvt_pk_bf16_f32 v237, v90, v91
ds_write_b64 v194, v[228:229] offset:0
ds_write_b64 v194, v[236:237] offset:8192
v_cvt_pk_bf16_f32 v230, v76, v77
v_cvt_pk_bf16_f32 v238, v92, v93
v_cvt_pk_bf16_f32 v231, v78, v79
v_cvt_pk_bf16_f32 v239, v94, v95
ds_write_b64 v195, v[230:231] offset:0
ds_write_b64 v195, v[238:239] offset:8192
s_waitcnt lgkmcnt(0)
s_barrier
ds_read_b64_tr_b16 v[36:37], v206 offset:0
ds_read_b64_tr_b16 v[38:39], v207 offset:0
ds_read_b64_tr_b16 v[32:33], v204 offset:0
ds_read_b64_tr_b16 v[34:35], v205 offset:0
ds_read_b64_tr_b16 v[44:45], v206 offset:2048
ds_read_b64_tr_b16 v[46:47], v207 offset:2048
ds_read_b64_tr_b16 v[40:41], v204 offset:1024
ds_read_b64_tr_b16 v[42:43], v205 offset:1024
ds_read_b64_tr_b16 v[52:53], v206 offset:4096
ds_read_b64_tr_b16 v[54:55], v207 offset:4096
ds_read_b64_tr_b16 v[48:49], v204 offset:2048
ds_read_b64_tr_b16 v[50:51], v205 offset:2048
ds_read_b64_tr_b16 v[60:61], v206 offset:6144
ds_read_b64_tr_b16 v[62:63], v207 offset:6144
ds_read_b64_tr_b16 v[56:57], v204 offset:3072
ds_read_b64_tr_b16 v[58:59], v205 offset:3072
v_mov_b32 v24, v30
s_mov_b64 exec, 0xffff
buffer_load_dword v24, v23, s[40:43], s96 offen sc1
s_mov_b64 exec, -1
s_waitcnt lgkmcnt(15)
v_cndmask_b32 v36, v36, v208, s[80:81]
v_cndmask_b32 v37, v37, v208, s[80:81]
s_waitcnt lgkmcnt(14)
v_cndmask_b32 v38, v38, v208, s[80:81]
v_cndmask_b32 v39, v39, v208, s[80:81]
s_waitcnt lgkmcnt(11)
v_cndmask_b32 v44, v44, v208, s[80:81]
v_cndmask_b32 v45, v45, v208, s[80:81]
s_waitcnt lgkmcnt(10)
v_cndmask_b32 v46, v46, v208, s[80:81]
v_cndmask_b32 v47, v47, v208, s[80:81]
v_mfma_f32_32x32x16_bf16 v[224:239], v[32:35], v[36:39], 0
ds_read_b64_tr_b16 v[36:37], v206 offset:8192
ds_read_b64_tr_b16 v[38:39], v207 offset:8192
ds_read_b64_tr_b16 v[32:33], v204 offset:4096
ds_read_b64_tr_b16 v[34:35], v205 offset:4096
s_waitcnt lgkmcnt(11)
v_cndmask_b32 v52, v52, v208, s[80:81]
v_cndmask_b32 v53, v53, v208, s[80:81]
s_waitcnt lgkmcnt(10)
v_cndmask_b32 v54, v54, v208, s[80:81]
v_cndmask_b32 v55, v55, v208, s[80:81]
v_mfma_f32_32x32x16_bf16 v[224:239], v[40:43], v[44:47], v[224:239]
ds_read_b64_tr_b16 v[44:45], v206 offset:10240
ds_read_b64_tr_b16 v[46:47], v207 offset:10240
ds_read_b64_tr_b16 v[40:41], v204 offset:5120
ds_read_b64_tr_b16 v[42:43], v205 offset:5120
s_waitcnt lgkmcnt(11)
v_cndmask_b32 v60, v60, v208, s[80:81]
v_cndmask_b32 v61, v61, v208, s[80:81]
s_waitcnt lgkmcnt(10)
v_cndmask_b32 v62, v62, v208, s[80:81]
v_cndmask_b32 v63, v63, v208, s[80:81]
v_mfma_f32_32x32x16_bf16 v[224:239], v[48:51], v[52:55], v[224:239]
ds_read_b64_tr_b16 v[52:53], v206 offset:12288
ds_read_b64_tr_b16 v[54:55], v207 offset:12288
ds_read_b64_tr_b16 v[48:49], v204 offset:6144
ds_read_b64_tr_b16 v[50:51], v205 offset:6144
s_waitcnt lgkmcnt(11)
v_cndmask_b32 v36, v36, v208, s[80:81]
v_cndmask_b32 v37, v37, v208, s[80:81]
s_waitcnt lgkmcnt(10)
v_cndmask_b32 v38, v38, v208, s[80:81]
v_cndmask_b32 v39, v39, v208, s[80:81]
v_mfma_f32_32x32x16_bf16 v[224:239], v[56:59], v[60:63], v[224:239]
ds_read_b64_tr_b16 v[60:61], v206 offset:14336
ds_read_b64_tr_b16 v[62:63], v207 offset:14336
ds_read_b64_tr_b16 v[56:57], v204 offset:7168
ds_read_b64_tr_b16 v[58:59], v205 offset:7168
s_waitcnt lgkmcnt(11)
v_cndmask_b32 v44, v44, v208, s[80:81]
v_cndmask_b32 v45, v45, v208, s[80:81]
s_waitcnt lgkmcnt(10)
v_cndmask_b32 v46, v46, v208, s[80:81]
v_cndmask_b32 v47, v47, v208, s[80:81]
v_mfma_f32_32x32x16_bf16 v[224:239], v[32:35], v[36:39], v[224:239]
s_waitcnt lgkmcnt(7)
v_cndmask_b32 v52, v52, v208, s[80:81]
v_cndmask_b32 v53, v53, v208, s[80:81]
s_waitcnt lgkmcnt(6)
v_cndmask_b32 v54, v54, v208, s[80:81]
v_cndmask_b32 v55, v55, v208, s[80:81]
v_mfma_f32_32x32x16_bf16 v[224:239], v[40:43], v[44:47], v[224:239]
s_waitcnt lgkmcnt(3)
v_cndmask_b32 v60, v60, v208, s[80:81]
v_cndmask_b32 v61, v61, v208, s[80:81]
s_waitcnt lgkmcnt(2)
v_cndmask_b32 v62, v62, v208, s[80:81]
v_cndmask_b32 v63, v63, v208, s[80:81]
v_mfma_f32_32x32x16_bf16 v[224:239], v[48:51], v[52:55], v[224:239]
s_waitcnt lgkmcnt(0)
v_mfma_f32_32x32x16_bf16 v[224:239], v[56:59], v[60:63], v[224:239]
Ljoin_23:
v_add_u32 v16, s59, v18
v_add_u32 v17, s59, v19
s_cmp_lt_u32 s75, 14
s_cselect_b32 s60, 0, 0x7ff00000
v_add_u32 v13, s60, v1
s_lshl_b32 s60, s74, 6
s_add_u32 s60, s60, s75
s_lshl_b32 s60, s60, 6
s_add_u32 s94, s60, 0x1150000
s_waitcnt vmcnt(5)
s_barrier
v_add_u32 v16, 0x10000, v16
ds_read_b64_tr_b16 v[32:33], v16 offset:0
ds_read_b64_tr_b16 v[34:35], v16 offset:1024
v_add_u32 v17, 0x10000, v17
ds_read_b64_tr_b16 v[36:37], v17 offset:0
ds_read_b64_tr_b16 v[38:39], v17 offset:1024
ds_read_b64_tr_b16 v[40:41], v16 offset:2048
ds_read_b64_tr_b16 v[42:43], v16 offset:3072
ds_read_b64_tr_b16 v[44:45], v17 offset:2048
ds_read_b64_tr_b16 v[46:47], v17 offset:3072
s_waitcnt lgkmcnt(6)
v_mfma_f32_32x32x16_bf16 a[128:143], a[252:255], v[32:35], 0
v_add_u32 v16, 0xffff0000, v16
ds_read_b64_tr_b16 v[48:49], v16 offset:0
ds_read_b64_tr_b16 v[50:51], v16 offset:1024
s_cmp_lt_u32 s50, 8
s_cbranch_scc0 Ljoin_25
buffer_store_dwordx4 v[224:227], v1, s[40:43], s93 offen offset:0 sc1
Ljoin_25:
s_waitcnt lgkmcnt(6)
v_mfma_f32_32x32x16_bf16 a[144:159], a[252:255], v[36:39], 0
v_add_u32 v17, 0xffff0000, v17
ds_read_b64_tr_b16 v[52:53], v17 offset:0
ds_read_b64_tr_b16 v[54:55], v17 offset:1024
s_cmp_lt_u32 s50, 8
s_cbranch_scc0 Ljoin_27
buffer_store_dwordx4 v[228:231], v1, s[40:43], s93 offen offset:1024 sc1
Ljoin_27:
s_waitcnt lgkmcnt(6)
v_mfma_f32_32x32x16_bf16 a[128:143], a[252:255], v[40:43], a[128:143]
ds_read_b64_tr_b16 v[56:57], v16 offset:2048
ds_read_b64_tr_b16 v[58:59], v16 offset:3072
s_cmp_lt_u32 s50, 8
s_cbranch_scc0 Ljoin_29
buffer_store_dwordx4 v[232:235], v1, s[40:43], s93 offen offset:2048 sc1
Ljoin_29:
s_waitcnt lgkmcnt(6)
v_mfma_f32_32x32x16_bf16 a[144:159], a[252:255], v[44:47], a[144:159]
ds_read_b64_tr_b16 v[60:61], v17 offset:2048
ds_read_b64_tr_b16 v[62:63], v17 offset:3072
s_cmp_lt_u32 s50, 8
s_cbranch_scc0 Ljoin_31
buffer_store_dwordx4 v[236:239], v1, s[40:43], s93 offen offset:3072 sc1
Ljoin_31:
s_waitcnt lgkmcnt(6)
v_mfma_f32_32x32x16_bf16 a[160:175], a[252:255], v[48:51], 0
v_add_u32 v18, 0x10000, v18
ds_read_b64_tr_b16 v[32:33], v18 offset:0
ds_read_b64_tr_b16 v[34:35], v18 offset:1024
s_waitcnt lgkmcnt(6)
v_mfma_f32_32x32x16_bf16 a[176:191], a[252:255], v[52:55], 0
v_add_u32 v19, 0x10000, v19
ds_read_b64_tr_b16 v[36:37], v19 offset:0
ds_read_b64_tr_b16 v[38:39], v19 offset:1024
s_waitcnt lgkmcnt(6)
v_mfma_f32_32x32x16_bf16 a[160:175], a[252:255], v[56:59], a[160:175]
ds_read_b64_tr_b16 v[40:41], v18 offset:2048
ds_read_b64_tr_b16 v[42:43], v18 offset:3072
s_waitcnt lgkmcnt(6)
v_mfma_f32_32x32x16_bf16 a[176:191], a[252:255], v[60:63], a[176:191]
ds_read_b64_tr_b16 v[44:45], v19 offset:2048
ds_read_b64_tr_b16 v[46:47], v19 offset:3072
s_waitcnt vmcnt(0)
v_cmp_ne_u32 vcc, s52, v24
s_nop 4
s_cbranch_vccz Lok_32
s_mov_b32 s73, 0x8000
Lpoll_33:
s_mov_b64 exec, 0xffff
buffer_load_dword v24, v23, s[40:43], s96 offen sc1
s_mov_b64 exec, -1
s_sub_u32 s73, s73, 1
s_waitcnt vmcnt(0)
s_cbranch_scc1 Lok_32
v_cmp_ne_u32 vcc, s52, v24
s_nop 4
s_cbranch_vccnz Lpoll_33
Lok_32:
s_mul_i32 s60, s74, 0x1c000
s_lshl_b32 s61, s75, 13
s_add_u32 s60, s60, s61
s_add_u32 s93, s60, 0x600000
s_lshl_b32 s88, s74, 15
s_lshl_b32 s89, s65, 6
s_add_u32 s88, s88, s89
s_add_u32 s88, s88, 0x200000
buffer_load_dwordx4 a[0:3], v1, s[40:43], s88 offen offset:0 sc1
buffer_load_dwordx4 a[4:7], v1, s[40:43], s88 offen offset:1024 sc1
buffer_load_dwordx4 a[8:11], v1, s[40:43], s88 offen offset:2048 sc1
buffer_load_dwordx4 a[12:15], v1, s[40:43], s88 offen offset:3072 sc1
s_add_u32 s88, s88, 0x1000
buffer_load_dwordx4 a[16:19], v1, s[40:43], s88 offen offset:0 sc1
buffer_load_dwordx4 a[20:23], v1, s[40:43], s88 offen offset:1024 sc1
buffer_load_dwordx4 a[24:27], v1, s[40:43], s88 offen offset:2048 sc1
buffer_load_dwordx4 a[28:31], v1, s[40:43], s88 offen offset:3072 sc1
s_lshl_b32 s88, s74, 15
s_lshl_b32 s89, s66, 6
s_add_u32 s88, s88, s89
s_add_u32 s88, s88, 0x200000
buffer_load_dwordx4 a[32:35], v1, s[40:43], s88 offen offset:0 sc1
buffer_load_dwordx4 a[36:39], v1, s[40:43], s88 offen offset:1024 sc1
v_and_b32 v25, 0x7c, v29
s_lshl_b32 s60, s48, 9
s_add_u32 s60, s60, 0x24c00
v_add_u32 v25, s60, v25
ds_write_b32 v25, a128 offset:0
ds_write_b32 v25, a144 offset:128
ds_write_b32 v25, a160 offset:256
ds_write_b32 v25, a176 offset:384
s_waitcnt lgkmcnt(0)
s_barrier
v_add_u32 v25, 0x24c00, v29
ds_read2st64_b32 v[192:193], v25 offset0:0 offset1:2
ds_read2st64_b32 v[194:195], v25 offset0:4 offset1:6
ds_read2st64_b32 v[196:197], v25 offset0:1 offset1:3
ds_read2st64_b32 v[198:199], v25 offset0:5 offset1:7
v_lshlrev_b32 v25, 3, v0
s_waitcnt lgkmcnt(3)
v_add_f32 v192, v192, v193
s_waitcnt lgkmcnt(2)
v_add_f32 v194, v194, v195
v_mov_b32 v193, v30
v_add_f32 v192, v192, v194
s_waitcnt lgkmcnt(1)
v_add_f32 v196, v196, v197
s_waitcnt lgkmcnt(0)
v_add_f32 v198, v198, v199
v_mov_b32 v197, v30
v_add_f32 v196, v196, v198
s_lshl_b32 s60, s49, 4
s_add_u32 s60, s60, s50
s_lshl_b32 s60, s60, 10
s_add_u32 s60, s60, 0xe20000
s_mov_b64 exec, s[84:85]
buffer_store_dwordx2 v[192:193], v25, s[40:43], s60 offen offset:0 sc1
buffer_store_dwordx2 v[196:197], v25, s[40:43], s60 offen offset:512 sc1
s_mov_b64 exec, -1
s_waitcnt vmcnt(11)
v_mfma_f32_32x32x16_bf16 v[64:79], v[32:35], a[0:3], 0
ds_read_b64_tr_b16 v[48:49], v18 offset:4096
ds_read_b64_tr_b16 v[50:51], v18 offset:5120
buffer_load_dwordx4 a[40:43], v1, s[40:43], s88 offen offset:2048 sc1
v_mfma_f32_32x32x16_bf16 v[80:95], v[36:39], a[0:3], 0
ds_read_b64_tr_b16 v[52:53], v19 offset:4096
ds_read_b64_tr_b16 v[54:55], v19 offset:5120
buffer_load_dwordx4 a[44:47], v1, s[40:43], s88 offen offset:3072 sc1
s_waitcnt vmcnt(12)
v_mfma_f32_32x32x16_bf16 v[64:79], v[40:43], a[4:7], v[64:79]
ds_read_b64_tr_b16 v[56:57], v18 offset:6144
ds_read_b64_tr_b16 v[58:59], v18 offset:7168
s_add_u32 s88, s88, 0x1000
buffer_load_dwordx4 a[48:51], v1, s[40:43], s88 offen offset:0 sc1
v_mfma_f32_32x32x16_bf16 v[80:95], v[44:47], a[4:7], v[80:95]
ds_read_b64_tr_b16 v[60:61], v19 offset:6144
ds_read_b64_tr_b16 v[62:63], v19 offset:7168
buffer_load_dwordx4 a[52:55], v1, s[40:43], s88 offen offset:1024 sc1
s_waitcnt vmcnt(13) lgkmcnt(6)
v_mfma_f32_32x32x16_bf16 v[64:79], v[48:51], a[8:11], v[64:79]
ds_read_b64_tr_b16 v[32:33], v18 offset:8192
ds_read_b64_tr_b16 v[34:35], v18 offset:9216
buffer_load_dwordx4 a[56:59], v1, s[40:43], s88 offen offset:2048 sc1
s_waitcnt lgkmcnt(6)
v_mfma_f32_32x32x16_bf16 v[80:95], v[52:55], a[8:11], v[80:95]
ds_read_b64_tr_b16 v[36:37], v19 offset:8192
ds_read_b64_tr_b16 v[38:39], v19 offset:9216
buffer_load_dwordx4 a[60:63], v1, s[40:43], s88 offen offset:3072 sc1
s_waitcnt vmcnt(14) lgkmcnt(6)
v_mfma_f32_32x32x16_bf16 v[64:79], v[56:59], a[12:15], v[64:79]
ds_read_b64_tr_b16 v[40:41], v18 offset:10240
ds_read_b64_tr_b16 v[42:43], v18 offset:11264
s_lshl_b32 s88, s74, 15
s_lshl_b32 s89, s67, 6
s_add_u32 s88, s88, s89
s_add_u32 s88, s88, 0x200000
buffer_load_dwordx4 a[64:67], v1, s[40:43], s88 offen offset:0 sc1
s_waitcnt lgkmcnt(6)
v_mfma_f32_32x32x16_bf16 v[80:95], v[60:63], a[12:15], v[80:95]
ds_read_b64_tr_b16 v[44:45], v19 offset:10240
ds_read_b64_tr_b16 v[46:47], v19 offset:11264
buffer_load_dwordx4 a[68:71], v1, s[40:43], s88 offen offset:1024 sc1
s_waitcnt vmcnt(15) lgkmcnt(6)
v_mfma_f32_32x32x16_bf16 v[64:79], v[32:35], a[16:19], v[64:79]
ds_read_b64_tr_b16 v[48:49], v18 offset:12288
ds_read_b64_tr_b16 v[50:51], v18 offset:13312
buffer_load_dwordx4 a[72:75], v1, s[40:43], s88 offen offset:2048 sc1
s_waitcnt lgkmcnt(6)
v_mfma_f32_32x32x16_bf16 v[80:95], v[36:39], a[16:19], v[80:95]
ds_read_b64_tr_b16 v[52:53], v19 offset:12288
ds_read_b64_tr_b16 v[54:55], v19 offset:13312
buffer_load_dwordx4 a[76:79], v1, s[40:43], s88 offen offset:3072 sc1
s_waitcnt vmcnt(16) lgkmcnt(6)
v_mfma_f32_32x32x16_bf16 v[64:79], v[40:43], a[20:23], v[64:79]
ds_read_b64_tr_b16 v[56:57], v18 offset:14336
ds_read_b64_tr_b16 v[58:59], v18 offset:15360
s_add_u32 s88, s88, 0x1000
buffer_load_dwordx4 a[80:83], v1, s[40:43], s88 offen offset:0 sc1
s_waitcnt lgkmcnt(6)
v_mfma_f32_32x32x16_bf16 v[80:95], v[44:47], a[20:23], v[80:95]
ds_read_b64_tr_b16 v[60:61], v19 offset:14336
ds_read_b64_tr_b16 v[62:63], v19 offset:15360
buffer_load_dwordx4 a[84:87], v1, s[40:43], s88 offen offset:1024 sc1
s_waitcnt vmcnt(17) lgkmcnt(6)
v_mfma_f32_32x32x16_bf16 v[64:79], v[48:51], a[24:27], v[64:79]
v_add_u32 v18, 0xffff8000, v18
ds_read_b64_tr_b16 v[32:33], v18 offset:0
ds_read_b64_tr_b16 v[34:35], v18 offset:1024
buffer_load_dwordx4 a[88:91], v1, s[40:43], s88 offen offset:2048 sc1
s_waitcnt lgkmcnt(6)
v_mfma_f32_32x32x16_bf16 v[80:95], v[52:55], a[24:27], v[80:95]
v_add_u32 v19, 0xffff8000, v19
ds_read_b64_tr_b16 v[36:37], v19 offset:0
ds_read_b64_tr_b16 v[38:39], v19 offset:1024
buffer_load_dwordx4 a[92:95], v1, s[40:43], s88 offen offset:3072 sc1
s_waitcnt vmcnt(18) lgkmcnt(6)
v_mfma_f32_32x32x16_bf16 v[64:79], v[56:59], a[28:31], v[64:79]
ds_read_b64_tr_b16 v[40:41], v18 offset:2048
ds_read_b64_tr_b16 v[42:43], v18 offset:3072
s_lshl_b32 s88, s74, 15
s_lshl_b32 s89, s68, 6
s_add_u32 s88, s88, s89
s_add_u32 s88, s88, 0x200000
buffer_load_dwordx4 a[96:99], v1, s[40:43], s88 offen offset:0 sc1
s_waitcnt lgkmcnt(6)
v_mfma_f32_32x32x16_bf16 v[80:95], v[60:63], a[28:31], v[80:95]
ds_read_b64_tr_b16 v[44:45], v19 offset:2048
ds_read_b64_tr_b16 v[46:47], v19 offset:3072
buffer_load_dwordx4 a[100:103], v1, s[40:43], s88 offen offset:1024 sc1
s_waitcnt vmcnt(19) lgkmcnt(6)
v_mfma_f32_32x32x16_bf16 v[64:79], v[32:35], a[32:35], v[64:79]
ds_read_b64_tr_b16 v[48:49], v18 offset:4096
ds_read_b64_tr_b16 v[50:51], v18 offset:5120
buffer_load_dwordx4 a[104:107], v1, s[40:43], s88 offen offset:2048 sc1
s_cmp_lt_u32 s50, 8
s_cbranch_scc0 Ljoin_35
s_mov_b64 exec, 0xffff
buffer_store_dword v30, v29, s[40:43], s92 offen sc1
s_mov_b64 exec, -1
Ljoin_35:
s_waitcnt lgkmcnt(6)
v_mfma_f32_32x32x16_bf16 v[80:95], v[36:39], a[32:35], v[80:95]
ds_read_b64_tr_b16 v[52:53], v19 offset:4096
ds_read_b64_tr_b16 v[54:55], v19 offset:5120
buffer_load_dwordx4 a[108:111], v1, s[40:43], s88 offen offset:3072 sc1
s_waitcnt vmcnt(20) lgkmcnt(6)
v_mfma_f32_32x32x16_bf16 v[64:79], v[40:43], a[36:39], v[64:79]
ds_read_b64_tr_b16 v[56:57], v18 offset:6144
ds_read_b64_tr_b16 v[58:59], v18 offset:7168
s_add_u32 s88, s88, 0x1000
buffer_load_dwordx4 a[112:115], v1, s[40:43], s88 offen offset:0 sc1
s_waitcnt lgkmcnt(6)
v_mfma_f32_32x32x16_bf16 v[80:95], v[44:47], a[36:39], v[80:95]
ds_read_b64_tr_b16 v[60:61], v19 offset:6144
ds_read_b64_tr_b16 v[62:63], v19 offset:7168
buffer_load_dwordx4 a[116:119], v1, s[40:43], s88 offen offset:1024 sc1
s_waitcnt vmcnt(19) lgkmcnt(6)
v_mfma_f32_32x32x16_bf16 v[64:79], v[48:51], a[40:43], v[64:79]
ds_read_b64_tr_b16 v[32:33], v18 offset:8192
ds_read_b64_tr_b16 v[34:35], v18 offset:9216
buffer_load_dwordx4 a[120:123], v1, s[40:43], s88 offen offset:2048 sc1
s_waitcnt lgkmcnt(6)
v_mfma_f32_32x32x16_bf16 v[80:95], v[52:55], a[40:43], v[80:95]
ds_read_b64_tr_b16 v[36:37], v19 offset:8192
ds_read_b64_tr_b16 v[38:39], v19 offset:9216
buffer_load_dwordx4 a[124:127], v1, s[40:43], s88 offen offset:3072 sc1
s_waitcnt vmcnt(20) lgkmcnt(6)
v_mfma_f32_32x32x16_bf16 v[64:79], v[56:59], a[44:47], v[64:79]
ds_read_b64_tr_b16 v[40:41], v18 offset:10240
ds_read_b64_tr_b16 v[42:43], v18 offset:11264
s_add_u32 m0, s59, 0x20000
s_mul_i32 s64, s67, 3584
s_add_u32 s64, s64, s77
s_add_u32 s64, s64, 0x80
buffer_load_dwordx4 v2, s[28:31], s64 offen offset:0 lds
s_waitcnt lgkmcnt(6)
v_mfma_f32_32x32x16_bf16 v[80:95], v[60:63], a[44:47], v[80:95]
ds_read_b64_tr_b16 v[44:45], v19 offset:10240
ds_read_b64_tr_b16 v[46:47], v19 offset:11264
s_waitcnt vmcnt(20) lgkmcnt(6)
v_mfma_f32_32x32x16_bf16 v[64:79], v[32:35], a[48:51], v[64:79]
ds_read_b64_tr_b16 v[48:49], v18 offset:12288
ds_read_b64_tr_b16 v[50:51], v18 offset:13312
buffer_load_dwordx4 v3, s[28:31], s64 offen offset:1024 lds
s_waitcnt lgkmcnt(6)
v_mfma_f32_32x32x16_bf16 v[80:95], v[36:39], a[48:51], v[80:95]
ds_read_b64_tr_b16 v[52:53], v19 offset:12288
ds_read_b64_tr_b16 v[54:55], v19 offset:13312
s_waitcnt vmcnt(20) lgkmcnt(6)
v_mfma_f32_32x32x16_bf16 v[64:79], v[40:43], a[52:55], v[64:79]
ds_read_b64_tr_b16 v[56:57], v18 offset:14336
ds_read_b64_tr_b16 v[58:59], v18 offset:15360
buffer_load_dwordx4 v4, s[28:31], s64 offen offset:2048 lds
s_waitcnt lgkmcnt(6)
v_mfma_f32_32x32x16_bf16 v[80:95], v[44:47], a[52:55], v[80:95]
ds_read_b64_tr_b16 v[60:61], v19 offset:14336
ds_read_b64_tr_b16 v[62:63], v19 offset:15360
s_waitcnt vmcnt(20) lgkmcnt(6)
v_mfma_f32_32x32x16_bf16 v[64:79], v[48:51], a[56:59], v[64:79]
v_add_u32 v18, 0x10000, v18
ds_read_b64_tr_b16 v[32:33], v18 offset:0
ds_read_b64_tr_b16 v[34:35], v18 offset:1024
buffer_load_dwordx4 v5, s[28:31], s64 offen offset:3072 lds
s_waitcnt lgkmcnt(6)
v_mfma_f32_32x32x16_bf16 v[80:95], v[52:55], a[56:59], v[80:95]
v_add_u32 v19, 0x10000, v19
ds_read_b64_tr_b16 v[36:37], v19 offset:0
ds_read_b64_tr_b16 v[38:39], v19 offset:1024
s_waitcnt vmcnt(20) lgkmcnt(6)
v_mfma_f32_32x32x16_bf16 v[64:79], v[56:59], a[60:63], v[64:79]
ds_read_b64_tr_b16 v[40:41], v18 offset:2048
ds_read_b64_tr_b16 v[42:43], v18 offset:3072
s_add_u32 m0, s59, 0x4000
s_mul_i32 s64, s68, 3584
s_add_u32 s64, s64, s77
s_add_u32 s64, s64, 0x80
buffer_load_dwordx4 v2, s[28:31], s64 offen offset:0 lds
s_waitcnt lgkmcnt(6)
v_mfma_f32_32x32x16_bf16 v[80:95], v[60:63], a[60:63], v[80:95]
ds_read_b64_tr_b16 v[44:45], v19 offset:2048
ds_read_b64_tr_b16 v[46:47], v19 offset:3072
s_waitcnt vmcnt(20) lgkmcnt(6)
v_mfma_f32_32x32x16_bf16 v[64:79], v[32:35], a[64:67], v[64:79]
ds_read_b64_tr_b16 v[48:49], v18 offset:4096
ds_read_b64_tr_b16 v[50:51], v18 offset:5120
buffer_load_dwordx4 v3, s[28:31], s64 offen offset:1024 lds
s_waitcnt lgkmcnt(6)
v_mfma_f32_32x32x16_bf16 v[80:95], v[36:39], a[64:67], v[80:95]
ds_read_b64_tr_b16 v[52:53], v19 offset:4096
ds_read_b64_tr_b16 v[54:55], v19 offset:5120
s_waitcnt vmcnt(20) lgkmcnt(6)
v_mfma_f32_32x32x16_bf16 v[64:79], v[40:43], a[68:71], v[64:79]
ds_read_b64_tr_b16 v[56:57], v18 offset:6144
ds_read_b64_tr_b16 v[58:59], v18 offset:7168
buffer_load_dwordx4 v4, s[28:31], s64 offen offset:2048 lds
s_waitcnt lgkmcnt(6)
v_mfma_f32_32x32x16_bf16 v[80:95], v[44:47], a[68:71], v[80:95]
ds_read_b64_tr_b16 v[60:61], v19 offset:6144
ds_read_b64_tr_b16 v[62:63], v19 offset:7168
s_waitcnt vmcnt(20) lgkmcnt(6)
v_mfma_f32_32x32x16_bf16 v[64:79], v[48:51], a[72:75], v[64:79]
ds_read_b64_tr_b16 v[32:33], v18 offset:8192
ds_read_b64_tr_b16 v[34:35], v18 offset:9216
buffer_load_dwordx4 v5, s[28:31], s64 offen offset:3072 lds
v_lshlrev_b32 v22, 3, v0
s_and_b32 s97, s49, 12
s_lshl_b32 s97, s97, 4
s_add_u32 s97, s97, s50
s_lshl_b32 s97, s97, 10
s_add_u32 s97, s97, 0xe20000
s_add_u32 s98, s97, 0x4000
s_add_u32 s100, s97, 0x8000
s_add_u32 s101, s97, 0xc000
buffer_load_dwordx2 v[128:129], v22, s[40:43], s97 offen offset:0 sc1
buffer_load_dwordx2 v[130:131], v22, s[40:43], s98 offen offset:0 sc1
buffer_load_dwordx2 v[132:133], v22, s[40:43], s100 offen offset:0 sc1
buffer_load_dwordx2 v[134:135], v22, s[40:43], s101 offen offset:0 sc1
buffer_load_dwordx2 v[136:137], v22, s[40:43], s97 offen offset:512 sc1
buffer_load_dwordx2 v[138:139], v22, s[40:43], s98 offen offset:512 sc1
buffer_load_dwordx2 v[140:141], v22, s[40:43], s100 offen offset:512 sc1
buffer_load_dwordx2 v[142:143], v22, s[40:43], s101 offen offset:512 sc1
s_waitcnt lgkmcnt(6)
v_mfma_f32_32x32x16_bf16 v[80:95], v[52:55], a[72:75], v[80:95]
ds_read_b64_tr_b16 v[36:37], v19 offset:8192
ds_read_b64_tr_b16 v[38:39], v19 offset:9216
s_waitcnt vmcnt(28) lgkmcnt(6)
v_mfma_f32_32x32x16_bf16 v[64:79], v[56:59], a[76:79], v[64:79]
ds_read_b64_tr_b16 v[40:41], v18 offset:10240
ds_read_b64_tr_b16 v[42:43], v18 offset:11264
v_accvgpr_read_b32 v2, a242
v_add_u32 v3, 0x1c00, v2
v_add_u32 v4, 0x3800, v2
v_add_u32 v5, 0x5400, v2
s_waitcnt lgkmcnt(6)
v_mfma_f32_32x32x16_bf16 v[80:95], v[60:63], a[76:79], v[80:95]
ds_read_b64_tr_b16 v[44:45], v19 offset:10240
ds_read_b64_tr_b16 v[46:47], v19 offset:11264
s_waitcnt vmcnt(27) lgkmcnt(6)
v_mfma_f32_32x32x16_bf16 v[64:79], v[32:35], a[80:83], v[64:79]
ds_read_b64_tr_b16 v[48:49], v18 offset:12288
ds_read_b64_tr_b16 v[50:51], v18 offset:13312
s_add_u32 m0, s59, 0xc000
s_nop 0
buffer_load_dwordx4 v2, s[32:35], s20 offen offset:0 lds
s_waitcnt lgkmcnt(6)
v_mfma_f32_32x32x16_bf16 v[80:95], v[36:39], a[80:83], v[80:95]
ds_read_b64_tr_b16 v[52:53], v19 offset:12288
ds_read_b64_tr_b16 v[54:55], v19 offset:13312
s_waitcnt vmcnt(27) lgkmcnt(6)
v_mfma_f32_32x32x16_bf16 v[64:79], v[40:43], a[84:87], v[64:79]
ds_read_b64_tr_b16 v[56:57], v18 offset:14336
ds_read_b64_tr_b16 v[58:59], v18 offset:15360
buffer_load_dwordx4 v3, s[32:35], s20 offen offset:1024 lds
s_waitcnt lgkmcnt(6)
v_mfma_f32_32x32x16_bf16 v[80:95], v[44:47], a[84:87], v[80:95]
ds_read_b64_tr_b16 v[60:61], v19 offset:14336
ds_read_b64_tr_b16 v[62:63], v19 offset:15360
s_waitcnt vmcnt(27) lgkmcnt(6)
v_mfma_f32_32x32x16_bf16 v[64:79], v[48:51], a[88:91], v[64:79]
ds_read_b64_tr_b16 v[32:33], v18 offset:16384
ds_read_b64_tr_b16 v[34:35], v18 offset:17408
buffer_load_dwordx4 v4, s[32:35], s20 offen offset:2048 lds
s_waitcnt lgkmcnt(6)
v_mfma_f32_32x32x16_bf16 v[80:95], v[52:55], a[88:91], v[80:95]
ds_read_b64_tr_b16 v[36:37], v19 offset:16384
ds_read_b64_tr_b16 v[38:39], v19 offset:17408
s_waitcnt vmcnt(27) lgkmcnt(6)
v_mfma_f32_32x32x16_bf16 v[64:79], v[56:59], a[92:95], v[64:79]
ds_read_b64_tr_b16 v[40:41], v18 offset:18432
ds_read_b64_tr_b16 v[42:43], v18 offset:19456
buffer_load_dwordx4 v5, s[32:35], s20 offen offset:3072 lds
s_waitcnt lgkmcnt(6)
v_mfma_f32_32x32x16_bf16 v[80:95], v[60:63], a[92:95], v[80:95]
ds_read_b64_tr_b16 v[44:45], v19 offset:18432
ds_read_b64_tr_b16 v[46:47], v19 offset:19456
s_waitcnt vmcnt(27) lgkmcnt(6)
v_mfma_f32_32x32x16_bf16 v[64:79], v[32:35], a[96:99], v[64:79]
ds_read_b64_tr_b16 v[48:49], v18 offset:20480
ds_read_b64_tr_b16 v[50:51], v18 offset:21504
s_lshl_b32 s90, s74, 12
s_add_u32 s90, s90, 0xd00000
buffer_load_dword v96, v29, s[40:43], s90 offen offset:0 sc1
s_waitcnt lgkmcnt(6)
v_mfma_f32_32x32x16_bf16 v[80:95], v[36:39], a[96:99], v[80:95]
ds_read_b64_tr_b16 v[52:53], v19 offset:20480
ds_read_b64_tr_b16 v[54:55], v19 offset:21504
s_waitcnt vmcnt(27) lgkmcnt(6)
v_mfma_f32_32x32x16_bf16 v[64:79], v[40:43], a[100:103], v[64:79]
ds_read_b64_tr_b16 v[56:57], v18 offset:22528
ds_read_b64_tr_b16 v[58:59], v18 offset:23552
buffer_load_dword v97, v29, s[40:43], s90 offen offset:256 sc1
s_waitcnt lgkmcnt(6)
v_mfma_f32_32x32x16_bf16 v[80:95], v[44:47], a[100:103], v[80:95]
ds_read_b64_tr_b16 v[60:61], v19 offset:22528
ds_read_b64_tr_b16 v[62:63], v19 offset:23552
s_waitcnt vmcnt(27) lgkmcnt(6)
v_mfma_f32_32x32x16_bf16 v[64:79], v[48:51], a[104:107], v[64:79]
ds_read_b64_tr_b16 v[32:33], v18 offset:24576
ds_read_b64_tr_b16 v[34:35], v18 offset:25600
buffer_load_dword v98, v29, s[40:43], s90 offen offset:512 sc1
s_waitcnt lgkmcnt(6)
v_mfma_f32_32x32x16_bf16 v[80:95], v[52:55], a[104:107], v[80:95]
ds_read_b64_tr_b16 v[36:37], v19 offset:24576
ds_read_b64_tr_b16 v[38:39], v19 offset:25600
s_waitcnt vmcnt(27) lgkmcnt(6)
v_mfma_f32_32x32x16_bf16 v[64:79], v[56:59], a[108:111], v[64:79]
ds_read_b64_tr_b16 v[40:41], v18 offset:26624
ds_read_b64_tr_b16 v[42:43], v18 offset:27648
buffer_load_dword v99, v29, s[40:43], s90 offen offset:768 sc1
s_waitcnt lgkmcnt(6)
v_mfma_f32_32x32x16_bf16 v[80:95], v[60:63], a[108:111], v[80:95]
ds_read_b64_tr_b16 v[44:45], v19 offset:26624
ds_read_b64_tr_b16 v[46:47], v19 offset:27648
s_waitcnt vmcnt(27) lgkmcnt(6)
v_mfma_f32_32x32x16_bf16 v[64:79], v[32:35], a[112:115], v[64:79]
ds_read_b64_tr_b16 v[48:49], v18 offset:28672
ds_read_b64_tr_b16 v[50:51], v18 offset:29696
buffer_load_dword v100, v29, s[40:43], s90 offen offset:1024 sc1
s_waitcnt lgkmcnt(6)
v_mfma_f32_32x32x16_bf16 v[80:95], v[36:39], a[112:115], v[80:95]
ds_read_b64_tr_b16 v[52:53], v19 offset:28672
ds_read_b64_tr_b16 v[54:55], v19 offset:29696
s_waitcnt vmcnt(27) lgkmcnt(6)
v_mfma_f32_32x32x16_bf16 v[64:79], v[40:43], a[116:119], v[64:79]
ds_read_b64_tr_b16 v[56:57], v18 offset:30720
ds_read_b64_tr_b16 v[58:59], v18 offset:31744
buffer_load_dword v101, v29, s[40:43], s90 offen offset:1280 sc1
s_waitcnt vmcnt(17)
v_xor_b32 v144, s52, v129
s_waitcnt vmcnt(16)
v_xor_b32 v145, s52, v131
v_or_b32 v144, v144, v145
s_waitcnt vmcnt(15)
v_xor_b32 v145, s52, v133
v_or_b32 v144, v144, v145
s_waitcnt vmcnt(14)
v_xor_b32 v145, s52, v135
v_or_b32 v144, v144, v145
s_waitcnt vmcnt(13)
v_xor_b32 v145, s52, v137
v_or_b32 v144, v144, v145
s_waitcnt vmcnt(12)
v_xor_b32 v145, s52, v139
v_or_b32 v144, v144, v145
s_waitcnt vmcnt(11)
v_xor_b32 v145, s52, v141
v_or_b32 v144, v144, v145
s_waitcnt vmcnt(10)
v_xor_b32 v145, s52, v143
v_or_b32 v144, v144, v145
v_cmp_ne_u32 vcc, 0, v144
s_nop 4
s_cbranch_vccz Lok_36
s_mov_b32 s73, 0x8000
Lpoll_37:
buffer_load_dwordx2 v[128:129], v22, s[40:43], s97 offen offset:0 sc1
buffer_load_dwordx2 v[130:131], v22, s[40:43], s98 offen offset:0 sc1
buffer_load_dwordx2 v[132:133], v22, s[40:43], s100 offen offset:0 sc1
buffer_load_dwordx2 v[134:135], v22, s[40:43], s101 offen offset:0 sc1
buffer_load_dwordx2 v[136:137], v22, s[40:43], s97 offen offset:512 sc1
buffer_load_dwordx2 v[138:139], v22, s[40:43], s98 offen offset:512 sc1
buffer_load_dwordx2 v[140:141], v22, s[40:43], s100 offen offset:512 sc1
buffer_load_dwordx2 v[142:143], v22, s[40:43], s101 offen offset:512 sc1
s_waitcnt vmcnt(0)
s_sub_u32 s73, s73, 1
s_cbranch_scc1 Lok_36
v_xor_b32 v144, s52, v129
v_xor_b32 v145, s52, v131
v_or_b32 v144, v144, v145
v_xor_b32 v145, s52, v133
v_or_b32 v144, v144, v145
v_xor_b32 v145, s52, v135
v_or_b32 v144, v144, v145
v_xor_b32 v145, s52, v137
v_or_b32 v144, v144, v145
v_xor_b32 v145, s52, v139
v_or_b32 v144, v144, v145
v_xor_b32 v145, s52, v141
v_or_b32 v144, v144, v145
v_xor_b32 v145, s52, v143
v_or_b32 v144, v144, v145
v_cmp_ne_u32 vcc, 0, v144
s_nop 4
s_cbranch_vccnz Lpoll_37
Lok_36:
s_lshl_b32 s60, s48, 9
s_add_u32 s60, s60, 0x25400
v_add_u32 v22, s60, v29
v_add_f32 v128, v128, v130
v_add_f32 v132, v132, v134
v_add_f32 v136, v136, v138
v_add_f32 v140, v140, v142
v_lshrrev_b32 v25, 5, v0
v_add_f32 v128, v128, v132
ds_write_b32 v22, v128 offset:0
v_add_f32 v136, v136, v140
ds_write_b32 v22, v136 offset:256
v_lshl_add_u32 v25, v25, 4, s60
s_waitcnt lgkmcnt(8)
v_mfma_f32_32x32x16_bf16 v[80:95], v[44:47], a[116:119], v[80:95]
ds_read_b64_tr_b16 v[60:61], v19 offset:30720
ds_read_b64_tr_b16 v[62:63], v19 offset:31744
ds_read_b128 v[192:195], v25 offset:0
ds_read_b128 v[196:199], v25 offset:32
s_waitcnt lgkmcnt(10)
v_mfma_f32_32x32x16_bf16 v[64:79], v[48:51], a[120:123], v[64:79]
buffer_load_dword v102, v29, s[40:43], s90 offen offset:1536 sc1
ds_read_b128 v[200:203], v25 offset:64
ds_read_b128 v[204:207], v25 offset:96
s_waitcnt lgkmcnt(10)
v_mfma_f32_32x32x16_bf16 v[80:95], v[52:55], a[120:123], v[80:95]
ds_read_b128 v[208:211], v25 offset:128
s_waitcnt lgkmcnt(9)
v_mfma_f32_32x32x16_bf16 v[64:79], v[56:59], a[124:127], v[64:79]
buffer_load_dword v103, v29, s[40:43], s90 offen offset:1792 sc1
ds_read_b128 v[212:215], v25 offset:160
ds_read_b128 v[216:219], v25 offset:192
s_waitcnt lgkmcnt(7)
v_mfma_f32_32x32x16_bf16 v[80:95], v[60:63], a[124:127], v[80:95]
ds_read_b128 v[220:223], v25 offset:224
buffer_load_dword v104, v29, s[40:43], s90 offen offset:2048 sc1
buffer_load_dword v105, v29, s[40:43], s90 offen offset:2304 sc1
buffer_load_dword v106, v29, s[40:43], s90 offen offset:2560 sc1
buffer_load_dword v107, v29, s[40:43], s90 offen offset:2816 sc1
buffer_load_dword v108, v29, s[40:43], s90 offen offset:3072 sc1
buffer_load_dword v109, v29, s[40:43], s90 offen offset:3328 sc1
buffer_load_dword v110, v29, s[40:43], s90 offen offset:3584 sc1
buffer_load_dword v111, v29, s[40:43], s90 offen offset:3840 sc1
s_waitcnt vmcnt(7)
v_add_f32 v96, v96, v104
s_waitcnt vmcnt(6)
v_add_f32 v97, v97, v105
s_waitcnt vmcnt(5)
v_add_f32 v98, v98, v106
s_waitcnt vmcnt(4)
v_add_f32 v99, v99, v107
s_waitcnt vmcnt(3)
v_add_f32 v100, v100, v108
s_waitcnt vmcnt(2)
v_add_f32 v101, v101, v109
s_waitcnt vmcnt(1)
v_add_f32 v102, v102, v110
s_waitcnt vmcnt(0)
v_add_f32 v103, v103, v111
v_add_f32 v96, v96, v100
v_add_f32 v97, v97, v101
v_add_f32 v98, v98, v102
v_add_f32 v99, v99, v103
v_add_f32 v96, v96, v98
v_add_f32 v97, v97, v99
v_add_f32 v96, v96, v97
v_mov_b32 v97, v96
s_nop 1
v_permlane32_swap_b32 v96, v97
v_mul_f32 v26, 0xbb000000, v96
v_mul_f32 v97, 0x3b000000, v97
v_fma_f32 v97, -v26, v26, v97
v_max_f32 v97, 0, v97
v_add_f32 v97, 0x3727c5ac, v97
v_rsq_f32 v98, v97
s_nop 0
v_mul_f32 v10, 0xc0135761, v98
v_mul_f32 v11, v98, v98
v_mul_f32 v11, v11, v98
v_mul_f32 v11, 0xbdd2d3e8, v11
v_rcp_f32 v12, v98
s_barrier
s_waitcnt lgkmcnt(7)
v_pk_fma_f32 v[64:65], v[192:193], v[26:27], v[64:65] op_sel_hi:[1,0,1]
v_pk_fma_f32 v[66:67], v[194:195], v[26:27], v[66:67] op_sel_hi:[1,0,1]
s_waitcnt lgkmcnt(6)
v_pk_fma_f32 v[68:69], v[196:197], v[26:27], v[68:69] op_sel_hi:[1,0,1]
v_pk_fma_f32 v[70:71], v[198:199], v[26:27], v[70:71] op_sel_hi:[1,0,1]
s_waitcnt lgkmcnt(5)
v_pk_fma_f32 v[72:73], v[200:201], v[26:27], v[72:73] op_sel_hi:[1,0,1]
v_pk_fma_f32 v[74:75], v[202:203], v[26:27], v[74:75] op_sel_hi:[1,0,1]
s_waitcnt lgkmcnt(4)
v_pk_fma_f32 v[76:77], v[204:205], v[26:27], v[76:77] op_sel_hi:[1,0,1]
v_pk_fma_f32 v[78:79], v[206:207], v[26:27], v[78:79] op_sel_hi:[1,0,1]
v_pk_mul_f32 v[32:33], v[64:65], v[64:65]
v_pk_mul_f32 v[34:35], v[66:67], v[66:67]
v_pk_mul_f32 v[36:37], v[68:69], v[68:69]
v_pk_mul_f32 v[38:39], v[70:71], v[70:71]
v_pk_mul_f32 v[40:41], v[72:73], v[72:73]
v_pk_mul_f32 v[42:43], v[74:75], v[74:75]
v_pk_mul_f32 v[44:45], v[76:77], v[76:77]
v_pk_mul_f32 v[46:47], v[78:79], v[78:79]
s_add_u32 m0, s59, 0x10000
s_nop 0
buffer_load_dwordx4 v2, s[32:35], s22 offen offset:0 lds
v_pk_fma_f32 v[32:33], v[32:33], v[10:11], v[10:11] op_sel:[0,1,0] op_sel_hi:[1,1,0]
v_pk_fma_f32 v[34:35], v[34:35], v[10:11], v[10:11] op_sel:[0,1,0] op_sel_hi:[1,1,0]
v_pk_fma_f32 v[36:37], v[36:37], v[10:11], v[10:11] op_sel:[0,1,0] op_sel_hi:[1,1,0]
v_pk_fma_f32 v[38:39], v[38:39], v[10:11], v[10:11] op_sel:[0,1,0] op_sel_hi:[1,1,0]
v_pk_fma_f32 v[40:41], v[40:41], v[10:11], v[10:11] op_sel:[0,1,0] op_sel_hi:[1,1,0]
v_pk_fma_f32 v[42:43], v[42:43], v[10:11], v[10:11] op_sel:[0,1,0] op_sel_hi:[1,1,0]
v_pk_fma_f32 v[44:45], v[44:45], v[10:11], v[10:11] op_sel:[0,1,0] op_sel_hi:[1,1,0]
v_pk_fma_f32 v[46:47], v[46:47], v[10:11], v[10:11] op_sel:[0,1,0] op_sel_hi:[1,1,0]
v_pk_mul_f32 v[32:33], v[32:33], v[64:65]
v_pk_mul_f32 v[34:35], v[34:35], v[66:67]
v_pk_mul_f32 v[36:37], v[36:37], v[68:69]
v_pk_mul_f32 v[38:39], v[38:39], v[70:71]
v_pk_mul_f32 v[40:41], v[40:41], v[72:73]
v_pk_mul_f32 v[42:43], v[42:43], v[74:75]
v_pk_mul_f32 v[44:45], v[44:45], v[76:77]
v_pk_mul_f32 v[46:47], v[46:47], v[78:79]
buffer_load_dwordx4 v3, s[32:35], s22 offen offset:1024 lds
v_exp_f32 v32, v32
v_exp_f32 v33, v33
v_exp_f32 v34, v34
v_exp_f32 v35, v35
v_exp_f32 v36, v36
v_exp_f32 v37, v37
v_exp_f32 v38, v38
v_exp_f32 v39, v39
v_exp_f32 v40, v40
v_exp_f32 v41, v41
v_exp_f32 v42, v42
v_exp_f32 v43, v43
v_exp_f32 v44, v44
v_exp_f32 v45, v45
v_exp_f32 v46, v46
v_exp_f32 v47, v47
buffer_load_dwordx4 v4, s[32:35], s22 offen offset:2048 lds
v_pk_fma_f32 v[32:33], v[32:33], v[12:13], v[12:13] op_sel_hi:[1,0,0]
v_pk_fma_f32 v[34:35], v[34:35], v[12:13], v[12:13] op_sel_hi:[1,0,0]
v_pk_fma_f32 v[36:37], v[36:37], v[12:13], v[12:13] op_sel_hi:[1,0,0]
v_pk_fma_f32 v[38:39], v[38:39], v[12:13], v[12:13] op_sel_hi:[1,0,0]
v_pk_fma_f32 v[40:41], v[40:41], v[12:13], v[12:13] op_sel_hi:[1,0,0]
v_pk_fma_f32 v[42:43], v[42:43], v[12:13], v[12:13] op_sel_hi:[1,0,0]
v_pk_fma_f32 v[44:45], v[44:45], v[12:13], v[12:13] op_sel_hi:[1,0,0]
v_pk_fma_f32 v[46:47], v[46:47], v[12:13], v[12:13] op_sel_hi:[1,0,0]
v_rcp_f32 v32, v32
v_rcp_f32 v33, v33
v_rcp_f32 v34, v34
v_rcp_f32 v35, v35
v_rcp_f32 v36, v36
v_rcp_f32 v37, v37
v_rcp_f32 v38, v38
v_rcp_f32 v39, v39
buffer_load_dwordx4 v5, s[32:35], s22 offen offset:3072 lds
v_rcp_f32 v40, v40
v_rcp_f32 v41, v41
v_rcp_f32 v42, v42
v_rcp_f32 v43, v43
v_rcp_f32 v44, v44
v_rcp_f32 v45, v45
v_rcp_f32 v46, v46
v_rcp_f32 v47, v47
v_pk_mul_f32 v[32:33], v[32:33], v[64:65]
v_pk_mul_f32 v[34:35], v[34:35], v[66:67]
v_pk_mul_f32 v[36:37], v[36:37], v[68:69]
v_pk_mul_f32 v[38:39], v[38:39], v[70:71]
v_pk_mul_f32 v[40:41], v[40:41], v[72:73]
v_pk_mul_f32 v[42:43], v[42:43], v[74:75]
v_pk_mul_f32 v[44:45], v[44:45], v[76:77]
v_pk_mul_f32 v[46:47], v[46:47], v[78:79]
s_add_u32 m0, s59, 0x8000
s_nop 0
buffer_load_dwordx4 v2, s[32:35], s44 offen offset:0 lds
v_cvt_pk_bf16_f32 v144, v32, v33
v_cvt_pk_bf16_f32 v145, v34, v35
v_cvt_pk_bf16_f32 v146, v36, v37
v_cvt_pk_bf16_f32 v147, v38, v39
v_cvt_pk_bf16_f32 v148, v40, v41
v_cvt_pk_bf16_f32 v149, v42, v43
v_cvt_pk_bf16_f32 v150, v44, v45
v_cvt_pk_bf16_f32 v151, v46, v47
buffer_store_dwordx4 v[144:147], v13, s[40:43], s93 offen offset:0 sc1
buffer_store_dwordx4 v[148:151], v13, s[40:43], s93 offen offset:1024 sc1
s_waitcnt lgkmcnt(3)
v_pk_fma_f32 v[80:81], v[208:209], v[26:27], v[80:81] op_sel_hi:[1,0,1]
v_pk_fma_f32 v[82:83], v[210:211], v[26:27], v[82:83] op_sel_hi:[1,0,1]
s_waitcnt lgkmcnt(2)
v_pk_fma_f32 v[84:85], v[212:213], v[26:27], v[84:85] op_sel_hi:[1,0,1]
v_pk_fma_f32 v[86:87], v[214:215], v[26:27], v[86:87] op_sel_hi:[1,0,1]
s_waitcnt lgkmcnt(1)
v_pk_fma_f32 v[88:89], v[216:217], v[26:27], v[88:89] op_sel_hi:[1,0,1]
v_pk_fma_f32 v[90:91], v[218:219], v[26:27], v[90:91] op_sel_hi:[1,0,1]
s_waitcnt lgkmcnt(0)
v_pk_fma_f32 v[92:93], v[220:221], v[26:27], v[92:93] op_sel_hi:[1,0,1]
v_pk_fma_f32 v[94:95], v[222:223], v[26:27], v[94:95] op_sel_hi:[1,0,1]
v_pk_mul_f32 v[32:33], v[80:81], v[80:81]
v_pk_mul_f32 v[34:35], v[82:83], v[82:83]
v_pk_mul_f32 v[36:37], v[84:85], v[84:85]
v_pk_mul_f32 v[38:39], v[86:87], v[86:87]
v_pk_mul_f32 v[40:41], v[88:89], v[88:89]
v_pk_mul_f32 v[42:43], v[90:91], v[90:91]
v_pk_mul_f32 v[44:45], v[92:93], v[92:93]
v_pk_mul_f32 v[46:47], v[94:95], v[94:95]
buffer_load_dwordx4 v3, s[32:35], s44 offen offset:1024 lds
v_pk_fma_f32 v[32:33], v[32:33], v[10:11], v[10:11] op_sel:[0,1,0] op_sel_hi:[1,1,0]
v_pk_fma_f32 v[34:35], v[34:35], v[10:11], v[10:11] op_sel:[0,1,0] op_sel_hi:[1,1,0]
v_pk_fma_f32 v[36:37], v[36:37], v[10:11], v[10:11] op_sel:[0,1,0] op_sel_hi:[1,1,0]
v_pk_fma_f32 v[38:39], v[38:39], v[10:11], v[10:11] op_sel:[0,1,0] op_sel_hi:[1,1,0]
v_pk_fma_f32 v[40:41], v[40:41], v[10:11], v[10:11] op_sel:[0,1,0] op_sel_hi:[1,1,0]
v_pk_fma_f32 v[42:43], v[42:43], v[10:11], v[10:11] op_sel:[0,1,0] op_sel_hi:[1,1,0]
v_pk_fma_f32 v[44:45], v[44:45], v[10:11], v[10:11] op_sel:[0,1,0] op_sel_hi:[1,1,0]
v_pk_fma_f32 v[46:47], v[46:47], v[10:11], v[10:11] op_sel:[0,1,0] op_sel_hi:[1,1,0]
v_pk_mul_f32 v[32:33], v[32:33], v[80:81]
v_pk_mul_f32 v[34:35], v[34:35], v[82:83]
v_pk_mul_f32 v[36:37], v[36:37], v[84:85]
v_pk_mul_f32 v[38:39], v[38:39], v[86:87]
v_pk_mul_f32 v[40:41], v[40:41], v[88:89]
v_pk_mul_f32 v[42:43], v[42:43], v[90:91]
v_pk_mul_f32 v[44:45], v[44:45], v[92:93]
v_pk_mul_f32 v[46:47], v[46:47], v[94:95]
buffer_load_dwordx4 v4, s[32:35], s44 offen offset:2048 lds
v_exp_f32 v32, v32
v_exp_f32 v33, v33
v_exp_f32 v34, v34
v_exp_f32 v35, v35
v_exp_f32 v36, v36
v_exp_f32 v37, v37
v_exp_f32 v38, v38
v_exp_f32 v39, v39
v_exp_f32 v40, v40
v_exp_f32 v41, v41
v_exp_f32 v42, v42
v_exp_f32 v43, v43
v_exp_f32 v44, v44
v_exp_f32 v45, v45
v_exp_f32 v46, v46
v_exp_f32 v47, v47
buffer_load_dwordx4 v5, s[32:35], s44 offen offset:3072 lds
v_pk_fma_f32 v[32:33], v[32:33], v[12:13], v[12:13] op_sel_hi:[1,0,0]
v_pk_fma_f32 v[34:35], v[34:35], v[12:13], v[12:13] op_sel_hi:[1,0,0]
v_pk_fma_f32 v[36:37], v[36:37], v[12:13], v[12:13] op_sel_hi:[1,0,0]
v_pk_fma_f32 v[38:39], v[38:39], v[12:13], v[12:13] op_sel_hi:[1,0,0]
v_pk_fma_f32 v[40:41], v[40:41], v[12:13], v[12:13] op_sel_hi:[1,0,0]
v_pk_fma_f32 v[42:43], v[42:43], v[12:13], v[12:13] op_sel_hi:[1,0,0]
v_pk_fma_f32 v[44:45], v[44:45], v[12:13], v[12:13] op_sel_hi:[1,0,0]
v_pk_fma_f32 v[46:47], v[46:47], v[12:13], v[12:13] op_sel_hi:[1,0,0]
v_rcp_f32 v32, v32
v_rcp_f32 v33, v33
v_rcp_f32 v34, v34
v_rcp_f32 v35, v35
v_rcp_f32 v36, v36
v_rcp_f32 v37, v37
v_rcp_f32 v38, v38
v_rcp_f32 v39, v39
s_add_u32 m0, s59, 0x18000
s_lshl_b32 s88, s58, 15
s_add_u32 s64, s46, s88
buffer_load_dwordx4 v2, s[32:35], s64 offen offset:0 lds
v_rcp_f32 v40, v40
v_rcp_f32 v41, v41
v_rcp_f32 v42, v42
v_rcp_f32 v43, v43
v_rcp_f32 v44, v44
v_rcp_f32 v45, v45
v_rcp_f32 v46, v46
v_rcp_f32 v47, v47
v_pk_mul_f32 v[32:33], v[32:33], v[80:81]
v_pk_mul_f32 v[34:35], v[34:35], v[82:83]
v_pk_mul_f32 v[36:37], v[36:37], v[84:85]
v_pk_mul_f32 v[38:39], v[38:39], v[86:87]
v_pk_mul_f32 v[40:41], v[40:41], v[88:89]
v_pk_mul_f32 v[42:43], v[42:43], v[90:91]
v_pk_mul_f32 v[44:45], v[44:45], v[92:93]
v_pk_mul_f32 v[46:47], v[46:47], v[94:95]
buffer_load_dwordx4 v3, s[32:35], s64 offen offset:1024 lds
v_cvt_pk_bf16_f32 v152, v32, v33
v_cvt_pk_bf16_f32 v153, v34, v35
v_cvt_pk_bf16_f32 v154, v36, v37
v_cvt_pk_bf16_f32 v155, v38, v39
v_cvt_pk_bf16_f32 v156, v40, v41
v_cvt_pk_bf16_f32 v157, v42, v43
v_cvt_pk_bf16_f32 v158, v44, v45
v_cvt_pk_bf16_f32 v159, v46, v47
buffer_store_dwordx4 v[152:155], v13, s[40:43], s93 offen offset:2048 sc1
buffer_store_dwordx4 v[156:159], v13, s[40:43], s93 offen offset:3072 sc1
v_add_u32 v18, 0xfffe8000, v18
ds_read_b64_tr_b16 v[32:33], v18 offset:0
ds_read_b64_tr_b16 v[34:35], v18 offset:1024
v_add_u32 v19, 0xfffe8000, v19
ds_read_b64_tr_b16 v[36:37], v19 offset:0
ds_read_b64_tr_b16 v[38:39], v19 offset:1024
ds_read_b64_tr_b16 v[40:41], v18 offset:2048
ds_read_b64_tr_b16 v[42:43], v18 offset:3072
ds_read_b64_tr_b16 v[44:45], v19 offset:2048
ds_read_b64_tr_b16 v[46:47], v19 offset:3072
s_waitcnt lgkmcnt(6)
v_mfma_f32_32x32x16_bf16 v[160:175], v[32:35], a[0:3], 0
ds_read_b64_tr_b16 v[48:49], v18 offset:4096
ds_read_b64_tr_b16 v[50:51], v18 offset:5120
buffer_load_dwordx4 v4, s[32:35], s64 offen offset:2048 lds
s_waitcnt lgkmcnt(6)
v_mfma_f32_32x32x16_bf16 v[176:191], v[36:39], a[0:3], 0
ds_read_b64_tr_b16 v[52:53], v19 offset:4096
ds_read_b64_tr_b16 v[54:55], v19 offset:5120
s_waitcnt vmcnt(8)
s_mov_b64 exec, 0xffff
buffer_store_dword v30, v29, s[40:43], s94 offen sc1
s_mov_b64 exec, -1
s_add_u32 s94, s94, 0x400
s_waitcnt lgkmcnt(6)
v_mfma_f32_32x32x16_bf16 v[160:175], v[40:43], a[4:7], v[160:175]
ds_read_b64_tr_b16 v[56:57], v18 offset:6144
ds_read_b64_tr_b16 v[58:59], v18 offset:7168
buffer_load_dwordx4 v5, s[32:35], s64 offen offset:3072 lds
s_waitcnt lgkmcnt(6)
v_mfma_f32_32x32x16_bf16 v[176:191], v[44:47], a[4:7], v[176:191]
ds_read_b64_tr_b16 v[60:61], v19 offset:6144
ds_read_b64_tr_b16 v[62:63], v19 offset:7168
s_waitcnt lgkmcnt(6)
v_mfma_f32_32x32x16_bf16 v[160:175], v[48:51], a[8:11], v[160:175]
ds_read_b64_tr_b16 v[32:33], v18 offset:8192
ds_read_b64_tr_b16 v[34:35], v18 offset:9216
s_add_u32 m0, s59, 0x1c000
s_add_u32 s64, s21, 0x8000
buffer_load_dwordx4 v2, s[32:35], s64 offen offset:0 lds
s_waitcnt lgkmcnt(6)
v_mfma_f32_32x32x16_bf16 v[176:191], v[52:55], a[8:11], v[176:191]
ds_read_b64_tr_b16 v[36:37], v19 offset:8192
ds_read_b64_tr_b16 v[38:39], v19 offset:9216
s_waitcnt lgkmcnt(6)
v_mfma_f32_32x32x16_bf16 v[160:175], v[56:59], a[12:15], v[160:175]
ds_read_b64_tr_b16 v[40:41], v18 offset:10240
ds_read_b64_tr_b16 v[42:43], v18 offset:11264
buffer_load_dwordx4 v3, s[32:35], s64 offen offset:1024 lds
s_waitcnt lgkmcnt(6)
v_mfma_f32_32x32x16_bf16 v[176:191], v[60:63], a[12:15], v[176:191]
ds_read_b64_tr_b16 v[44:45], v19 offset:10240
ds_read_b64_tr_b16 v[46:47], v19 offset:11264
s_waitcnt lgkmcnt(6)
v_mfma_f32_32x32x16_bf16 v[160:175], v[32:35], a[16:19], v[160:175]
ds_read_b64_tr_b16 v[48:49], v18 offset:12288
ds_read_b64_tr_b16 v[50:51], v18 offset:13312
buffer_load_dwordx4 v4, s[32:35], s64 offen offset:2048 lds
s_waitcnt lgkmcnt(6)
v_mfma_f32_32x32x16_bf16 v[176:191], v[36:39], a[16:19], v[176:191]
ds_read_b64_tr_b16 v[52:53], v19 offset:12288
ds_read_b64_tr_b16 v[54:55], v19 offset:13312
s_waitcnt lgkmcnt(6)
v_mfma_f32_32x32x16_bf16 v[160:175], v[40:43], a[20:23], v[160:175]
ds_read_b64_tr_b16 v[56:57], v18 offset:14336
ds_read_b64_tr_b16 v[58:59], v18 offset:15360
buffer_load_dwordx4 v5, s[32:35], s64 offen offset:3072 lds
s_waitcnt lgkmcnt(6)
v_mfma_f32_32x32x16_bf16 v[176:191], v[44:47], a[20:23], v[176:191]
ds_read_b64_tr_b16 v[60:61], v19 offset:14336
ds_read_b64_tr_b16 v[62:63], v19 offset:15360
s_waitcnt lgkmcnt(6)
v_mfma_f32_32x32x16_bf16 v[160:175], v[48:51], a[24:27], v[160:175]
v_add_u32 v18, 0x14000, v18
ds_read_b64_tr_b16 v[32:33], v18 offset:0
ds_read_b64_tr_b16 v[34:35], v18 offset:1024
s_waitcnt lgkmcnt(6)
v_mfma_f32_32x32x16_bf16 v[176:191], v[52:55], a[24:27], v[176:191]
v_add_u32 v19, 0x14000, v19
ds_read_b64_tr_b16 v[36:37], v19 offset:0
ds_read_b64_tr_b16 v[38:39], v19 offset:1024
s_waitcnt lgkmcnt(6)
v_mfma_f32_32x32x16_bf16 v[160:175], v[56:59], a[28:31], v[160:175]
ds_read_b64_tr_b16 v[40:41], v18 offset:2048
ds_read_b64_tr_b16 v[42:43], v18 offset:3072
s_waitcnt lgkmcnt(6)
v_mfma_f32_32x32x16_bf16 v[176:191], v[60:63], a[28:31], v[176:191]
ds_read_b64_tr_b16 v[44:45], v19 offset:2048
ds_read_b64_tr_b16 v[46:47], v19 offset:3072
s_waitcnt lgkmcnt(6)
v_mfma_f32_32x32x16_bf16 v[160:175], v[32:35], a[32:35], v[160:175]
ds_read_b64_tr_b16 v[48:49], v18 offset:4096
ds_read_b64_tr_b16 v[50:51], v18 offset:5120
s_waitcnt lgkmcnt(6)
v_mfma_f32_32x32x16_bf16 v[176:191], v[36:39], a[32:35], v[176:191]
ds_read_b64_tr_b16 v[52:53], v19 offset:4096
ds_read_b64_tr_b16 v[54:55], v19 offset:5120
s_waitcnt lgkmcnt(6)
v_mfma_f32_32x32x16_bf16 v[160:175], v[40:43], a[36:39], v[160:175]
ds_read_b64_tr_b16 v[56:57], v18 offset:6144
ds_read_b64_tr_b16 v[58:59], v18 offset:7168
s_cmp_lt_u32 s50, 8
s_cbranch_scc1 Ljoin_39
v_and_b32 v80, 15, v0
v_lshlrev_b32 v80, 6, v80
s_lshr_b32 s61, s49, 2
s_lshl_b32 s60, s51, 2
s_add_u32 s60, s60, s61
s_lshl_b32 s60, s60, 10
s_add_u32 s63, s60, 0x1120000
v_mov_b32 v81, v30
s_mov_b64 exec, 0xffff
buffer_load_dword v81, v80, s[40:43], s63 offen sc1
s_mov_b64 exec, -1
v_accvgpr_read_b32 v82, a243
Ljoin_39:
ds_read_b128 v[192:195], v25 offset:256
s_waitcnt lgkmcnt(7)
v_mfma_f32_32x32x16_bf16 v[176:191], v[44:47], a[36:39], v[176:191]
ds_read_b64_tr_b16 v[60:61], v19 offset:6144
ds_read_b64_tr_b16 v[62:63], v19 offset:7168
ds_read_b128 v[196:199], v25 offset:288
s_barrier
s_waitcnt lgkmcnt(8)
v_mfma_f32_32x32x16_bf16 v[160:175], v[48:51], a[40:43], v[160:175]
ds_read_b64_tr_b16 v[32:33], v18 offset:8192
ds_read_b64_tr_b16 v[34:35], v18 offset:9216
s_add_u32 m0, s59, 0x0
s_add_u32 s64, s23, 0x8000
buffer_load_dwordx4 v2, s[32:35], s64 offen offset:0 lds
ds_read_b128 v[200:203], v25 offset:320
s_waitcnt lgkmcnt(9)
v_mfma_f32_32x32x16_bf16 v[176:191], v[52:55], a[40:43], v[176:191]
ds_read_b64_tr_b16 v[36:37], v19 offset:8192
ds_read_b64_tr_b16 v[38:39], v19 offset:9216
ds_read_b128 v[204:207], v25 offset:352
s_waitcnt lgkmcnt(10)
v_mfma_f32_32x32x16_bf16 v[160:175], v[56:59], a[44:47], v[160:175]
ds_read_b64_tr_b16 v[40:41], v18 offset:10240
ds_read_b64_tr_b16 v[42:43], v18 offset:11264
buffer_load_dwordx4 v3, s[32:35], s64 offen offset:1024 lds
ds_read_b128 v[208:211], v25 offset:384
s_waitcnt lgkmcnt(10)
v_mfma_f32_32x32x16_bf16 v[176:191], v[60:63], a[44:47], v[176:191]
ds_read_b64_tr_b16 v[44:45], v19 offset:10240
ds_read_b64_tr_b16 v[46:47], v19 offset:11264
ds_read_b128 v[212:215], v25 offset:416
s_waitcnt lgkmcnt(10)
v_mfma_f32_32x32x16_bf16 v[160:175], v[32:35], a[48:51], v[160:175]
ds_read_b64_tr_b16 v[48:49], v18 offset:12288
ds_read_b64_tr_b16 v[50:51], v18 offset:13312
buffer_load_dwordx4 v4, s[32:35], s64 offen offset:2048 lds
ds_read_b128 v[216:219], v25 offset:448
s_waitcnt lgkmcnt(10)
v_mfma_f32_32x32x16_bf16 v[176:191], v[36:39], a[48:51], v[176:191]
ds_read_b64_tr_b16 v[52:53], v19 offset:12288
ds_read_b64_tr_b16 v[54:55], v19 offset:13312
ds_read_b128 v[220:223], v25 offset:480
s_waitcnt lgkmcnt(10)
v_mfma_f32_32x32x16_bf16 v[160:175], v[40:43], a[52:55], v[160:175]
ds_read_b64_tr_b16 v[56:57], v18 offset:14336
ds_read_b64_tr_b16 v[58:59], v18 offset:15360
buffer_load_dwordx4 v5, s[32:35], s64 offen offset:3072 lds
s_waitcnt lgkmcnt(9)
v_mfma_f32_32x32x16_bf16 v[176:191], v[44:47], a[52:55], v[176:191]
ds_read_b64_tr_b16 v[60:61], v19 offset:14336
ds_read_b64_tr_b16 v[62:63], v19 offset:15360
s_waitcnt lgkmcnt(8)
v_mfma_f32_32x32x16_bf16 v[160:175], v[48:51], a[56:59], v[160:175]
ds_read_b64_tr_b16 v[32:33], v18 offset:49152
ds_read_b64_tr_b16 v[34:35], v18 offset:50176
s_waitcnt lgkmcnt(7)
v_mfma_f32_32x32x16_bf16 v[176:191], v[52:55], a[56:59], v[176:191]
ds_read_b64_tr_b16 v[36:37], v19 offset:49152
ds_read_b64_tr_b16 v[38:39], v19 offset:50176
s_waitcnt lgkmcnt(6)
v_mfma_f32_32x32x16_bf16 v[160:175], v[56:59], a[60:63], v[160:175]
ds_read_b64_tr_b16 v[40:41], v18 offset:51200
ds_read_b64_tr_b16 v[42:43], v18 offset:52224
s_waitcnt lgkmcnt(6)
v_mfma_f32_32x32x16_bf16 v[176:191], v[60:63], a[60:63], v[176:191]
ds_read_b64_tr_b16 v[44:45], v19 offset:51200
ds_read_b64_tr_b16 v[46:47], v19 offset:52224
s_waitcnt lgkmcnt(6)
v_mfma_f32_32x32x16_bf16 v[160:175], v[32:35], a[64:67], v[160:175]
ds_read_b64_tr_b16 v[48:49], v18 offset:53248
ds_read_b64_tr_b16 v[50:51], v18 offset:54272
s_waitcnt lgkmcnt(6)
v_mfma_f32_32x32x16_bf16 v[176:191], v[36:39], a[64:67], v[176:191]
ds_read_b64_tr_b16 v[52:53], v19 offset:53248
ds_read_b64_tr_b16 v[54:55], v19 offset:54272
s_waitcnt lgkmcnt(6)
v_mfma_f32_32x32x16_bf16 v[160:175], v[40:43], a[68:71], v[160:175]
ds_read_b64_tr_b16 v[56:57], v18 offset:55296
ds_read_b64_tr_b16 v[58:59], v18 offset:56320
s_waitcnt lgkmcnt(6)
v_mfma_f32_32x32x16_bf16 v[176:191], v[44:47], a[68:71], v[176:191]
ds_read_b64_tr_b16 v[60:61], v19 offset:55296
ds_read_b64_tr_b16 v[62:63], v19 offset:56320
s_barrier
s_waitcnt lgkmcnt(6)
v_mfma_f32_32x32x16_bf16 v[160:175], v[48:51], a[72:75], v[160:175]
ds_read_b64_tr_b16 v[32:33], v18 offset:57344
ds_read_b64_tr_b16 v[34:35], v18 offset:58368
s_add_u32 m0, s59, 0x14000
s_add_u32 s64, s45, 0x8000
buffer_load_dwordx4 v2, s[32:35], s64 offen offset:0 lds
s_waitcnt vmcnt(12)
s_mov_b64 exec, 0xffff
buffer_store_dword v30, v29, s[40:43], s94 offen sc1
s_mov_b64 exec, -1
s_add_u32 s94, s94, 0x400
s_waitcnt lgkmcnt(6)
v_mfma_f32_32x32x16_bf16 v[176:191], v[52:55], a[72:75], v[176:191]
ds_read_b64_tr_b16 v[36:37], v19 offset:57344
ds_read_b64_tr_b16 v[38:39], v19 offset:58368
s_waitcnt lgkmcnt(6)
v_mfma_f32_32x32x16_bf16 v[160:175], v[56:59], a[76:79], v[160:175]
ds_read_b64_tr_b16 v[40:41], v18 offset:59392
ds_read_b64_tr_b16 v[42:43], v18 offset:60416
buffer_load_dwordx4 v3, s[32:35], s64 offen offset:1024 lds
s_cmp_lt_u32 s50, 8
s_cbranch_scc1 Ljoin_41
s_waitcnt vmcnt(7)
v_cmp_ne_u32 vcc, s52, v81
s_nop 4
s_cbranch_vccz Lok_42
s_mov_b32 s73, 0x8000
Lpoll_43:
s_mov_b64 exec, 0xffff
buffer_load_dword v81, v80, s[40:43], s63 offen sc1
s_mov_b64 exec, -1
s_sub_u32 s73, s73, 1
s_waitcnt vmcnt(0)
s_cbranch_scc1 Lok_42
v_cmp_ne_u32 vcc, s52, v81
s_nop 4
s_cbranch_vccnz Lpoll_43
Lok_42:
buffer_load_dword v64, v82, s[40:43], 0 offen sc1
s_mov_b32 s62, 0x4000
buffer_load_dword v65, v82, s[40:43], s62 offen sc1
s_mov_b32 s62, 0x8000
buffer_load_dword v66, v82, s[40:43], s62 offen sc1
s_mov_b32 s62, 0xc000
buffer_load_dword v67, v82, s[40:43], s62 offen sc1
s_mov_b32 s62, 0x10000
buffer_load_dword v68, v82, s[40:43], s62 offen sc1
s_mov_b32 s62, 0x14000
buffer_load_dword v69, v82, s[40:43], s62 offen sc1
s_mov_b32 s62, 0x18000
buffer_load_dword v70, v82, s[40:43], s62 offen sc1
s_mov_b32 s62, 0x1c000
buffer_load_dword v71, v82, s[40:43], s62 offen sc1
s_mov_b32 s62, 0x20000
buffer_load_dword v72, v82, s[40:43], s62 offen sc1
s_mov_b32 s62, 0x24000
buffer_load_dword v73, v82, s[40:43], s62 offen sc1
s_mov_b32 s62, 0x28000
buffer_load_dword v74, v82, s[40:43], s62 offen sc1
s_mov_b32 s62, 0x2c000
buffer_load_dword v75, v82, s[40:43], s62 offen sc1
s_mov_b32 s62, 0x30000
buffer_load_dword v76, v82, s[40:43], s62 offen sc1
s_mov_b32 s62, 0x34000
buffer_load_dword v77, v82, s[40:43], s62 offen sc1
s_mov_b32 s62, 0x38000
buffer_load_dword v78, v82, s[40:43], s62 offen sc1
s_mov_b32 s62, 0x3c000
buffer_load_dword v79, v82, s[40:43], s62 offen sc1
Ljoin_41:
s_waitcnt lgkmcnt(6)
v_mfma_f32_32x32x16_bf16 v[176:191], v[60:63], a[76:79], v[176:191]
ds_read_b64_tr_b16 v[44:45], v19 offset:59392
ds_read_b64_tr_b16 v[46:47], v19 offset:60416
s_waitcnt lgkmcnt(6)
v_mfma_f32_32x32x16_bf16 v[160:175], v[32:35], a[80:83], v[160:175]
ds_read_b64_tr_b16 v[48:49], v18 offset:61440
ds_read_b64_tr_b16 v[50:51], v18 offset:62464
buffer_load_dwordx4 v4, s[32:35], s64 offen offset:2048 lds
s_waitcnt lgkmcnt(6)
v_mfma_f32_32x32x16_bf16 v[176:191], v[36:39], a[80:83], v[176:191]
ds_read_b64_tr_b16 v[52:53], v19 offset:61440
ds_read_b64_tr_b16 v[54:55], v19 offset:62464
s_waitcnt lgkmcnt(6)
v_mfma_f32_32x32x16_bf16 v[160:175], v[40:43], a[84:87], v[160:175]
ds_read_b64_tr_b16 v[56:57], v18 offset:63488
ds_read_b64_tr_b16 v[58:59], v18 offset:64512
buffer_load_dwordx4 v5, s[32:35], s64 offen offset:3072 lds
s_waitcnt lgkmcnt(6)
v_mfma_f32_32x32x16_bf16 v[176:191], v[44:47], a[84:87], v[176:191]
ds_read_b64_tr_b16 v[60:61], v19 offset:63488
ds_read_b64_tr_b16 v[62:63], v19 offset:64512
s_waitcnt lgkmcnt(6)
v_mfma_f32_32x32x16_bf16 v[160:175], v[48:51], a[88:91], v[160:175]
v_add_u32 v18, 0xffff0000, v18
ds_read_b64_tr_b16 v[32:33], v18 offset:0
ds_read_b64_tr_b16 v[34:35], v18 offset:1024
v_accvgpr_read_b32 v23, a240
s_mov_b32 s96, 0x1150000
v_mov_b32 v24, v30
s_mov_b64 exec, 0x7f
buffer_load_dword v24, v23, s[40:43], s96 offen sc1
s_mov_b64 exec, -1
s_waitcnt lgkmcnt(6)
v_mfma_f32_32x32x16_bf16 v[176:191], v[52:55], a[88:91], v[176:191]
v_add_u32 v19, 0xffff0000, v19
ds_read_b64_tr_b16 v[36:37], v19 offset:0
ds_read_b64_tr_b16 v[38:39], v19 offset:1024
s_waitcnt lgkmcnt(6)
v_mfma_f32_32x32x16_bf16 v[160:175], v[56:59], a[92:95], v[160:175]
ds_read_b64_tr_b16 v[40:41], v18 offset:2048
ds_read_b64_tr_b16 v[42:43], v18 offset:3072
s_waitcnt lgkmcnt(6)
v_mfma_f32_32x32x16_bf16 v[176:191], v[60:63], a[92:95], v[176:191]
ds_read_b64_tr_b16 v[44:45], v19 offset:2048
ds_read_b64_tr_b16 v[46:47], v19 offset:3072
s_waitcnt lgkmcnt(6)
v_mfma_f32_32x32x16_bf16 v[160:175], v[32:35], a[96:99], v[160:175]
ds_read_b64_tr_b16 v[48:49], v18 offset:4096
ds_read_b64_tr_b16 v[50:51], v18 offset:5120
s_waitcnt lgkmcnt(6)
v_mfma_f32_32x32x16_bf16 v[176:191], v[36:39], a[96:99], v[176:191]
ds_read_b64_tr_b16 v[52:53], v19 offset:4096
ds_read_b64_tr_b16 v[54:55], v19 offset:5120
s_waitcnt lgkmcnt(6)
v_mfma_f32_32x32x16_bf16 v[160:175], v[40:43], a[100:103], v[160:175]
ds_read_b64_tr_b16 v[56:57], v18 offset:6144
ds_read_b64_tr_b16 v[58:59], v18 offset:7168
s_waitcnt lgkmcnt(6)
v_mfma_f32_32x32x16_bf16 v[176:191], v[44:47], a[100:103], v[176:191]
ds_read_b64_tr_b16 v[60:61], v19 offset:6144
ds_read_b64_tr_b16 v[62:63], v19 offset:7168
s_barrier
s_waitcnt lgkmcnt(6)
v_mfma_f32_32x32x16_bf16 v[160:175], v[48:51], a[104:107], v[160:175]
ds_read_b64_tr_b16 v[32:33], v18 offset:8192
ds_read_b64_tr_b16 v[34:35], v18 offset:9216
s_add_u32 m0, s59, 0x20000
s_add_u32 s64, s20, 0x10000
buffer_load_dwordx4 v2, s[32:35], s64 offen offset:0 lds
s_waitcnt lgkmcnt(6)
v_mfma_f32_32x32x16_bf16 v[176:191], v[52:55], a[104:107], v[176:191]
ds_read_b64_tr_b16 v[36:37], v19 offset:8192
ds_read_b64_tr_b16 v[38:39], v19 offset:9216
s_waitcnt lgkmcnt(6)
v_mfma_f32_32x32x16_bf16 v[160:175], v[56:59], a[108:111], v[160:175]
ds_read_b64_tr_b16 v[40:41], v18 offset:10240
ds_read_b64_tr_b16 v[42:43], v18 offset:11264
buffer_load_dwordx4 v3, s[32:35], s64 offen offset:1024 lds
s_waitcnt lgkmcnt(6)
v_mfma_f32_32x32x16_bf16 v[176:191], v[60:63], a[108:111], v[176:191]
ds_read_b64_tr_b16 v[44:45], v19 offset:10240
ds_read_b64_tr_b16 v[46:47], v19 offset:11264
s_waitcnt lgkmcnt(6)
v_mfma_f32_32x32x16_bf16 v[160:175], v[32:35], a[112:115], v[160:175]
ds_read_b64_tr_b16 v[48:49], v18 offset:12288
ds_read_b64_tr_b16 v[50:51], v18 offset:13312
buffer_load_dwordx4 v4, s[32:35], s64 offen offset:2048 lds
s_waitcnt lgkmcnt(6)
v_mfma_f32_32x32x16_bf16 v[176:191], v[36:39], a[112:115], v[176:191]
ds_read_b64_tr_b16 v[52:53], v19 offset:12288
ds_read_b64_tr_b16 v[54:55], v19 offset:13312
s_waitcnt lgkmcnt(6)
v_mfma_f32_32x32x16_bf16 v[160:175], v[40:43], a[116:119], v[160:175]
ds_read_b64_tr_b16 v[56:57], v18 offset:14336
ds_read_b64_tr_b16 v[58:59], v18 offset:15360
buffer_load_dwordx4 v5, s[32:35], s64 offen offset:3072 lds
s_waitcnt lgkmcnt(6)
v_mfma_f32_32x32x16_bf16 v[176:191], v[44:47], a[116:119], v[176:191]
ds_read_b64_tr_b16 v[60:61], v19 offset:14336
ds_read_b64_tr_b16 v[62:63], v19 offset:15360
s_waitcnt lgkmcnt(6)
v_mfma_f32_32x32x16_bf16 v[160:175], v[48:51], a[120:123], v[160:175]
s_cmp_lt_u32 s50, 8
s_cbranch_scc1 Ljoin_45
s_waitcnt vmcnt(14)
v_add_f32 v64, v64, v72
s_waitcnt vmcnt(13)
v_add_f32 v65, v65, v73
s_waitcnt vmcnt(12)
v_add_f32 v66, v66, v74
s_waitcnt vmcnt(11)
v_add_f32 v67, v67, v75
s_waitcnt vmcnt(10)
v_add_f32 v68, v68, v76
s_waitcnt vmcnt(9)
v_add_f32 v69, v69, v77
s_waitcnt vmcnt(8)
v_add_f32 v70, v70, v78
s_waitcnt vmcnt(7)
v_add_f32 v71, v71, v79
v_add_f32 v64, v64, v68
v_add_f32 v65, v65, v69
v_add_f32 v66, v66, v70
v_add_f32 v67, v67, v71
v_add_f32 v64, v64, v66
v_add_f32 v65, v65, v67
v_add_f32 v64, v64, v65
v_lshrrev_b32 v67, 5, v0
v_and_b32 v66, 28, v0
v_mov_b32_dpp v65, v64 quad_perm:[1,1,3,3] row_mask:0xf bank_mask:0xf
v_lshlrev_b32 v66, 2, v66
v_lshl_add_u32 v66, v67, 3, v66
v_and_b32 v67, 2, v0
v_cvt_pk_bf16_f32 v64, v64, v65
v_lshl_add_u32 v66, v67, 1, v66
s_lshl_b32 s60, s51, 4
s_add_u32 s60, s60, s49
s_lshl_b32 s60, s60, 2
s_add_u32 s60, s60, s48
s_lshl_b32 s61, s60, 7
s_add_u32 s61, s61, 0x1000000
s_mov_b32 exec_lo, 0x55555555
s_mov_b32 exec_hi, 0x55555555
buffer_store_dword v64, v66, s[40:43], s61 offen sc1
s_mov_b64 exec, -1
s_lshl_b32 s60, s60, 6
s_add_u32 s92, s60, 0x1130000
Ljoin_45:
s_waitcnt lgkmcnt(4)
v_mfma_f32_32x32x16_bf16 v[176:191], v[52:55], a[120:123], v[176:191]
s_waitcnt lgkmcnt(2)
v_mfma_f32_32x32x16_bf16 v[160:175], v[56:59], a[124:127], v[160:175]
s_waitcnt vmcnt(4)
v_cmp_ne_u32 vcc, s52, v24
s_nop 4
s_cmp_eq_u64 vcc, 0
s_cselect_b32 s97, 0, 0x7ff00000
v_add_u32 v16, s97, v14
s_waitcnt lgkmcnt(0)
v_mfma_f32_32x32x16_bf16 v[176:191], v[60:63], a[124:127], v[176:191]
s_mov_b32 s96, 0x1150400
v_mov_b32 v24, v30
s_mov_b64 exec, 0x7f
buffer_load_dword v24, v23, s[40:43], s96 offen sc1
s_mov_b64 exec, -1
s_barrier
v_pk_fma_f32 v[160:161], v[192:193], v[26:27], v[160:161] op_sel_hi:[1,0,1]
v_pk_fma_f32 v[162:163], v[194:195], v[26:27], v[162:163] op_sel_hi:[1,0,1]
v_pk_fma_f32 v[164:165], v[196:197], v[26:27], v[164:165] op_sel_hi:[1,0,1]
v_pk_fma_f32 v[166:167], v[198:199], v[26:27], v[166:167] op_sel_hi:[1,0,1]
v_pk_fma_f32 v[168:169], v[200:201], v[26:27], v[168:169] op_sel_hi:[1,0,1]
v_pk_fma_f32 v[170:171], v[202:203], v[26:27], v[170:171] op_sel_hi:[1,0,1]
v_pk_fma_f32 v[172:173], v[204:205], v[26:27], v[172:173] op_sel_hi:[1,0,1]
v_pk_fma_f32 v[174:175], v[206:207], v[26:27], v[174:175] op_sel_hi:[1,0,1]
v_pk_mul_f32 v[32:33], v[160:161], v[160:161]
v_pk_mul_f32 v[34:35], v[162:163], v[162:163]
v_pk_mul_f32 v[36:37], v[164:165], v[164:165]
v_pk_mul_f32 v[38:39], v[166:167], v[166:167]
v_pk_mul_f32 v[40:41], v[168:169], v[168:169]
v_pk_mul_f32 v[42:43], v[170:171], v[170:171]
v_pk_mul_f32 v[44:45], v[172:173], v[172:173]
v_pk_mul_f32 v[46:47], v[174:175], v[174:175]
v_pk_fma_f32 v[32:33], v[32:33], v[10:11], v[10:11] op_sel:[0,1,0] op_sel_hi:[1,1,0]
v_pk_fma_f32 v[34:35], v[34:35], v[10:11], v[10:11] op_sel:[0,1,0] op_sel_hi:[1,1,0]
v_pk_fma_f32 v[36:37], v[36:37], v[10:11], v[10:11] op_sel:[0,1,0] op_sel_hi:[1,1,0]
v_pk_fma_f32 v[38:39], v[38:39], v[10:11], v[10:11] op_sel:[0,1,0] op_sel_hi:[1,1,0]
buffer_load_dwordx4 a[128:131], v16, s[40:43], s8 offen offset:0 sc1
v_pk_fma_f32 v[40:41], v[40:41], v[10:11], v[10:11] op_sel:[0,1,0] op_sel_hi:[1,1,0]
v_pk_fma_f32 v[42:43], v[42:43], v[10:11], v[10:11] op_sel:[0,1,0] op_sel_hi:[1,1,0]
v_pk_fma_f32 v[44:45], v[44:45], v[10:11], v[10:11] op_sel:[0,1,0] op_sel_hi:[1,1,0]
v_pk_fma_f32 v[46:47], v[46:47], v[10:11], v[10:11] op_sel:[0,1,0] op_sel_hi:[1,1,0]
v_pk_mul_f32 v[32:33], v[32:33], v[160:161]
v_pk_mul_f32 v[34:35], v[34:35], v[162:163]
v_pk_mul_f32 v[36:37], v[36:37], v[164:165]
v_pk_mul_f32 v[38:39], v[38:39], v[166:167]
v_pk_mul_f32 v[40:41], v[40:41], v[168:169]
v_pk_mul_f32 v[42:43], v[42:43], v[170:171]
v_pk_mul_f32 v[44:45], v[44:45], v[172:173]
v_pk_mul_f32 v[46:47], v[46:47], v[174:175]
v_exp_f32 v32, v32
v_exp_f32 v33, v33
v_exp_f32 v34, v34
v_exp_f32 v35, v35
v_exp_f32 v36, v36
v_exp_f32 v37, v37
v_exp_f32 v38, v38
v_exp_f32 v39, v39
buffer_load_dwordx4 a[132:135], v16, s[40:43], s8 offen offset:1024 sc1
v_exp_f32 v40, v40
v_exp_f32 v41, v41
v_exp_f32 v42, v42
v_exp_f32 v43, v43
v_exp_f32 v44, v44
v_exp_f32 v45, v45
v_exp_f32 v46, v46
v_exp_f32 v47, v47
v_pk_fma_f32 v[32:33], v[32:33], v[12:13], v[12:13] op_sel_hi:[1,0,0]
v_pk_fma_f32 v[34:35], v[34:35], v[12:13], v[12:13] op_sel_hi:[1,0,0]
v_pk_fma_f32 v[36:37], v[36:37], v[12:13], v[12:13] op_sel_hi:[1,0,0]
v_pk_fma_f32 v[38:39], v[38:39], v[12:13], v[12:13] op_sel_hi:[1,0,0]
v_pk_fma_f32 v[40:41], v[40:41], v[12:13], v[12:13] op_sel_hi:[1,0,0]
v_pk_fma_f32 v[42:43], v[42:43], v[12:13], v[12:13] op_sel_hi:[1,0,0]
v_pk_fma_f32 v[44:45], v[44:45], v[12:13], v[12:13] op_sel_hi:[1,0,0]
v_pk_fma_f32 v[46:47], v[46:47], v[12:13], v[12:13] op_sel_hi:[1,0,0]
v_rcp_f32 v32, v32
v_rcp_f32 v33, v33
v_rcp_f32 v34, v34
v_rcp_f32 v35, v35
buffer_load_dwordx4 a[136:139], v16, s[40:43], s9 offen offset:0 sc1
v_rcp_f32 v36, v36
v_rcp_f32 v37, v37
v_rcp_f32 v38, v38
v_rcp_f32 v39, v39
v_rcp_f32 v40, v40
v_rcp_f32 v41, v41
v_rcp_f32 v42, v42
v_rcp_f32 v43, v43
v_rcp_f32 v44, v44
v_rcp_f32 v45, v45
v_rcp_f32 v46, v46
v_rcp_f32 v47, v47
v_pk_mul_f32 v[32:33], v[32:33], v[160:161]
v_pk_mul_f32 v[34:35], v[34:35], v[162:163]
v_pk_mul_f32 v[36:37], v[36:37], v[164:165]
v_pk_mul_f32 v[38:39], v[38:39], v[166:167]
v_pk_mul_f32 v[40:41], v[40:41], v[168:169]
v_pk_mul_f32 v[42:43], v[42:43], v[170:171]
v_pk_mul_f32 v[44:45], v[44:45], v[172:173]
v_pk_mul_f32 v[46:47], v[46:47], v[174:175]
buffer_load_dwordx4 a[140:143], v16, s[40:43], s9 offen offset:1024 sc1
v_cvt_pk_bf16_f32 v144, v32, v33
v_cvt_pk_bf16_f32 v145, v34, v35
v_cvt_pk_bf16_f32 v146, v36, v37
v_cvt_pk_bf16_f32 v147, v38, v39
v_cvt_pk_bf16_f32 v148, v40, v41
v_cvt_pk_bf16_f32 v149, v42, v43
v_cvt_pk_bf16_f32 v150, v44, v45
v_cvt_pk_bf16_f32 v151, v46, v47
s_waitcnt vmcnt(4)
v_cmp_ne_u32 vcc, s52, v24
s_nop 4
s_cmp_eq_u64 vcc, 0
s_cselect_b32 s98, 0, 0x7ff00000
v_add_u32 v17, s98, v14
s_cmp_lt_u32 s50, 8
s_cbranch_scc1 Ljoin_47
s_mov_b64 exec, 0xffff
buffer_store_dword v30, v29, s[40:43], s92 offen sc1
s_mov_b64 exec, -1
Ljoin_47:
s_add_u32 s93, s93, 0x1000
buffer_store_dwordx4 v[144:147], v13, s[40:43], s93 offen offset:0 sc1
buffer_store_dwordx4 v[148:151], v13, s[40:43], s93 offen offset:1024 sc1
v_pk_fma_f32 v[176:177], v[208:209], v[26:27], v[176:177] op_sel_hi:[1,0,1]
v_pk_fma_f32 v[178:179], v[210:211], v[26:27], v[178:179] op_sel_hi:[1,0,1]
v_pk_fma_f32 v[180:181], v[212:213], v[26:27], v[180:181] op_sel_hi:[1,0,1]
v_pk_fma_f32 v[182:183], v[214:215], v[26:27], v[182:183] op_sel_hi:[1,0,1]
v_pk_fma_f32 v[184:185], v[216:217], v[26:27], v[184:185] op_sel_hi:[1,0,1]
v_pk_fma_f32 v[186:187], v[218:219], v[26:27], v[186:187] op_sel_hi:[1,0,1]
v_pk_fma_f32 v[188:189], v[220:221], v[26:27], v[188:189] op_sel_hi:[1,0,1]
v_pk_fma_f32 v[190:191], v[222:223], v[26:27], v[190:191] op_sel_hi:[1,0,1]
v_pk_mul_f32 v[32:33], v[176:177], v[176:177]
v_pk_mul_f32 v[34:35], v[178:179], v[178:179]
v_pk_mul_f32 v[36:37], v[180:181], v[180:181]
v_pk_mul_f32 v[38:39], v[182:183], v[182:183]
v_pk_mul_f32 v[40:41], v[184:185], v[184:185]
v_pk_mul_f32 v[42:43], v[186:187], v[186:187]
v_pk_mul_f32 v[44:45], v[188:189], v[188:189]
v_pk_mul_f32 v[46:47], v[190:191], v[190:191]
v_pk_fma_f32 v[32:33], v[32:33], v[10:11], v[10:11] op_sel:[0,1,0] op_sel_hi:[1,1,0]
v_pk_fma_f32 v[34:35], v[34:35], v[10:11], v[10:11] op_sel:[0,1,0] op_sel_hi:[1,1,0]
v_pk_fma_f32 v[36:37], v[36:37], v[10:11], v[10:11] op_sel:[0,1,0] op_sel_hi:[1,1,0]
v_pk_fma_f32 v[38:39], v[38:39], v[10:11], v[10:11] op_sel:[0,1,0] op_sel_hi:[1,1,0]
buffer_load_dwordx4 a[144:147], v16, s[40:43], s10 offen offset:0 sc1
v_pk_fma_f32 v[40:41], v[40:41], v[10:11], v[10:11] op_sel:[0,1,0] op_sel_hi:[1,1,0]
v_pk_fma_f32 v[42:43], v[42:43], v[10:11], v[10:11] op_sel:[0,1,0] op_sel_hi:[1,1,0]
v_pk_fma_f32 v[44:45], v[44:45], v[10:11], v[10:11] op_sel:[0,1,0] op_sel_hi:[1,1,0]
v_pk_fma_f32 v[46:47], v[46:47], v[10:11], v[10:11] op_sel:[0,1,0] op_sel_hi:[1,1,0]
v_pk_mul_f32 v[32:33], v[32:33], v[176:177]
v_pk_mul_f32 v[34:35], v[34:35], v[178:179]
v_pk_mul_f32 v[36:37], v[36:37], v[180:181]
v_pk_mul_f32 v[38:39], v[38:39], v[182:183]
v_pk_mul_f32 v[40:41], v[40:41], v[184:185]
v_pk_mul_f32 v[42:43], v[42:43], v[186:187]
v_pk_mul_f32 v[44:45], v[44:45], v[188:189]
v_pk_mul_f32 v[46:47], v[46:47], v[190:191]
v_exp_f32 v32, v32
v_exp_f32 v33, v33
v_exp_f32 v34, v34
v_exp_f32 v35, v35
v_exp_f32 v36, v36
v_exp_f32 v37, v37
v_exp_f32 v38, v38
v_exp_f32 v39, v39
buffer_load_dwordx4 a[148:151], v16, s[40:43], s10 offen offset:1024 sc1
v_exp_f32 v40, v40
v_exp_f32 v41, v41
v_exp_f32 v42, v42
v_exp_f32 v43, v43
v_exp_f32 v44, v44
v_exp_f32 v45, v45
v_exp_f32 v46, v46
v_exp_f32 v47, v47
v_pk_fma_f32 v[32:33], v[32:33], v[12:13], v[12:13] op_sel_hi:[1,0,0]
v_pk_fma_f32 v[34:35], v[34:35], v[12:13], v[12:13] op_sel_hi:[1,0,0]
v_pk_fma_f32 v[36:37], v[36:37], v[12:13], v[12:13] op_sel_hi:[1,0,0]
v_pk_fma_f32 v[38:39], v[38:39], v[12:13], v[12:13] op_sel_hi:[1,0,0]
v_pk_fma_f32 v[40:41], v[40:41], v[12:13], v[12:13] op_sel_hi:[1,0,0]
v_pk_fma_f32 v[42:43], v[42:43], v[12:13], v[12:13] op_sel_hi:[1,0,0]
v_pk_fma_f32 v[44:45], v[44:45], v[12:13], v[12:13] op_sel_hi:[1,0,0]
v_pk_fma_f32 v[46:47], v[46:47], v[12:13], v[12:13] op_sel_hi:[1,0,0]
v_rcp_f32 v32, v32
v_rcp_f32 v33, v33
v_rcp_f32 v34, v34
v_rcp_f32 v35, v35
buffer_load_dwordx4 a[152:155], v16, s[40:43], s11 offen offset:0 sc1
v_rcp_f32 v36, v36
v_rcp_f32 v37, v37
v_rcp_f32 v38, v38
v_rcp_f32 v39, v39
v_rcp_f32 v40, v40
v_rcp_f32 v41, v41
v_rcp_f32 v42, v42
v_rcp_f32 v43, v43
v_rcp_f32 v44, v44
v_rcp_f32 v45, v45
v_rcp_f32 v46, v46
v_rcp_f32 v47, v47
v_pk_mul_f32 v[32:33], v[32:33], v[176:177]
v_pk_mul_f32 v[34:35], v[34:35], v[178:179]
v_pk_mul_f32 v[36:37], v[36:37], v[180:181]
v_pk_mul_f32 v[38:39], v[38:39], v[182:183]
v_pk_mul_f32 v[40:41], v[40:41], v[184:185]
v_pk_mul_f32 v[42:43], v[42:43], v[186:187]
v_pk_mul_f32 v[44:45], v[44:45], v[188:189]
v_pk_mul_f32 v[46:47], v[46:47], v[190:191]
buffer_load_dwordx4 a[156:159], v16, s[40:43], s11 offen offset:1024 sc1
v_cvt_pk_bf16_f32 v152, v32, v33
v_cvt_pk_bf16_f32 v153, v34, v35
v_cvt_pk_bf16_f32 v154, v36, v37
v_cvt_pk_bf16_f32 v155, v38, v39
v_cvt_pk_bf16_f32 v156, v40, v41
v_cvt_pk_bf16_f32 v157, v42, v43
v_cvt_pk_bf16_f32 v158, v44, v45
v_cvt_pk_bf16_f32 v159, v46, v47
buffer_store_dwordx4 v[152:155], v13, s[40:43], s93 offen offset:2048 sc1
buffer_store_dwordx4 v[156:159], v13, s[40:43], s93 offen offset:3072 sc1
buffer_load_dwordx4 a[160:163], v16, s[40:43], s12 offen offset:0 sc1
buffer_load_dwordx4 a[164:167], v16, s[40:43], s12 offen offset:1024 sc1
buffer_load_dwordx4 a[168:171], v16, s[40:43], s13 offen offset:0 sc1
buffer_load_dwordx4 a[172:175], v16, s[40:43], s13 offen offset:1024 sc1
buffer_load_dwordx4 a[176:179], v16, s[40:43], s14 offen offset:0 sc1
buffer_load_dwordx4 a[180:183], v16, s[40:43], s14 offen offset:1024 sc1
s_cmp_eq_u32 s97, 0
s_cbranch_scc1 Lhit_48
s_mov_b32 s60, 0x1150000
v_mov_b32 v22, v30
s_mov_b64 exec, 0x7f
buffer_load_dword v22, v23, s[40:43], s60 offen sc1
s_mov_b64 exec, -1
s_waitcnt vmcnt(0)
v_cmp_ne_u32 vcc, s52, v22
s_nop 4
s_cbranch_vccz Lok_49
s_mov_b32 s73, 0x8000
Lpoll_50:
s_mov_b64 exec, 0x7f
buffer_load_dword v22, v23, s[40:43], s60 offen sc1
s_mov_b64 exec, -1
s_sub_u32 s73, s73, 1
s_waitcnt vmcnt(0)
s_cbranch_scc1 Lok_49
v_cmp_ne_u32 vcc, s52, v22
s_nop 4
s_cbranch_vccnz Lpoll_50
Lok_49:
buffer_load_dwordx4 a[128:131], v14, s[40:43], s8 offen offset:0 sc1
buffer_load_dwordx4 a[132:135], v14, s[40:43], s8 offen offset:1024 sc1
buffer_load_dwordx4 a[136:139], v14, s[40:43], s9 offen offset:0 sc1
buffer_load_dwordx4 a[140:143], v14, s[40:43], s9 offen offset:1024 sc1
buffer_load_dwordx4 a[144:147], v14, s[40:43], s10 offen offset:0 sc1
buffer_load_dwordx4 a[148:151], v14, s[40:43], s10 offen offset:1024 sc1
buffer_load_dwordx4 a[152:155], v14, s[40:43], s11 offen offset:0 sc1
buffer_load_dwordx4 a[156:159], v14, s[40:43], s11 offen offset:1024 sc1
buffer_load_dwordx4 a[160:163], v14, s[40:43], s12 offen offset:0 sc1
buffer_load_dwordx4 a[164:167], v14, s[40:43], s12 offen offset:1024 sc1
buffer_load_dwordx4 a[168:171], v14, s[40:43], s13 offen offset:0 sc1
buffer_load_dwordx4 a[172:175], v14, s[40:43], s13 offen offset:1024 sc1
buffer_load_dwordx4 a[176:179], v14, s[40:43], s14 offen offset:0 sc1
buffer_load_dwordx4 a[180:183], v14, s[40:43], s14 offen offset:1024 sc1
Lhit_48:
s_barrier
ds_read_b64_tr_b16 v[32:33], v20 offset:32768
ds_read_b64_tr_b16 v[34:35], v20 offset:33792
ds_read_b64_tr_b16 v[36:37], v21 offset:32768
ds_read_b64_tr_b16 v[38:39], v21 offset:33792
ds_read_b64_tr_b16 v[40:41], v20 offset:34816
ds_read_b64_tr_b16 v[42:43], v20 offset:35840
ds_read_b64_tr_b16 v[44:45], v21 offset:34816
ds_read_b64_tr_b16 v[46:47], v21 offset:35840
s_waitcnt vmcnt(13) lgkmcnt(6)
v_mfma_f32_32x32x16_bf16 v[128:143], v[32:35], a[128:131], 0
ds_read_b64_tr_b16 v[48:49], v20 offset:36864
ds_read_b64_tr_b16 v[50:51], v20 offset:37888
s_add_u32 m0, s59, 0x4000
s_add_u32 s64, s22, 0x10000
buffer_load_dwordx4 v2, s[32:35], s64 offen offset:0 lds
s_waitcnt lgkmcnt(6)
v_mfma_f32_32x32x16_bf16 v[144:159], v[36:39], a[128:131], 0
ds_read_b64_tr_b16 v[52:53], v21 offset:36864
ds_read_b64_tr_b16 v[54:55], v21 offset:37888
buffer_load_dwordx4 v3, s[32:35], s64 offen offset:1024 lds
s_waitcnt vmcnt(14)
s_mov_b64 exec, 0xffff
buffer_store_dword v30, v29, s[40:43], s94 offen sc1
s_mov_b64 exec, -1
s_add_u32 s94, s94, 0x400
s_waitcnt lgkmcnt(6)
v_mfma_f32_32x32x16_bf16 v[128:143], v[40:43], a[132:135], v[128:143]
ds_read_b64_tr_b16 v[56:57], v20 offset:38912
ds_read_b64_tr_b16 v[58:59], v20 offset:39936
buffer_load_dwordx4 v4, s[32:35], s64 offen offset:2048 lds
s_waitcnt lgkmcnt(6)
v_mfma_f32_32x32x16_bf16 v[144:159], v[44:47], a[132:135], v[144:159]
ds_read_b64_tr_b16 v[60:61], v21 offset:38912
ds_read_b64_tr_b16 v[62:63], v21 offset:39936
buffer_load_dwordx4 v5, s[32:35], s64 offen offset:3072 lds
s_waitcnt vmcnt(16) lgkmcnt(6)
v_mfma_f32_32x32x16_bf16 v[128:143], v[48:51], a[136:139], v[128:143]
buffer_load_dwordx4 a[184:187], v17, s[40:43], s8 offen offset:2048 sc1
s_barrier
ds_read_b64_tr_b16 v[32:33], v20 offset:49152
ds_read_b64_tr_b16 v[34:35], v20 offset:50176
s_waitcnt lgkmcnt(6)
v_mfma_f32_32x32x16_bf16 v[144:159], v[52:55], a[136:139], v[144:159]
ds_read_b64_tr_b16 v[36:37], v21 offset:49152
ds_read_b64_tr_b16 v[38:39], v21 offset:50176
buffer_load_dwordx4 a[188:191], v17, s[40:43], s8 offen offset:3072 sc1
s_waitcnt vmcnt(17) lgkmcnt(6)
v_mfma_f32_32x32x16_bf16 v[128:143], v[56:59], a[140:143], v[128:143]
ds_read_b64_tr_b16 v[40:41], v20 offset:51200
ds_read_b64_tr_b16 v[42:43], v20 offset:52224
buffer_load_dwordx4 a[192:195], v17, s[40:43], s9 offen offset:2048 sc1
s_waitcnt lgkmcnt(6)
v_mfma_f32_32x32x16_bf16 v[144:159], v[60:63], a[140:143], v[144:159]
ds_read_b64_tr_b16 v[44:45], v21 offset:51200
ds_read_b64_tr_b16 v[46:47], v21 offset:52224
buffer_load_dwordx4 a[196:199], v17, s[40:43], s9 offen offset:3072 sc1
s_waitcnt vmcnt(18) lgkmcnt(6)
v_mfma_f32_32x32x16_bf16 v[128:143], v[32:35], a[144:147], v[128:143]
ds_read_b64_tr_b16 v[48:49], v20 offset:53248
ds_read_b64_tr_b16 v[50:51], v20 offset:54272
buffer_load_dwordx4 a[200:203], v17, s[40:43], s10 offen offset:2048 sc1
s_waitcnt lgkmcnt(6)
v_mfma_f32_32x32x16_bf16 v[144:159], v[36:39], a[144:147], v[144:159]
ds_read_b64_tr_b16 v[52:53], v21 offset:53248
ds_read_b64_tr_b16 v[54:55], v21 offset:54272
buffer_load_dwordx4 a[204:207], v17, s[40:43], s10 offen offset:3072 sc1
s_waitcnt vmcnt(19) lgkmcnt(6)
v_mfma_f32_32x32x16_bf16 v[128:143], v[40:43], a[148:151], v[128:143]
ds_read_b64_tr_b16 v[56:57], v20 offset:55296
ds_read_b64_tr_b16 v[58:59], v20 offset:56320
buffer_load_dwordx4 a[208:211], v17, s[40:43], s11 offen offset:2048 sc1
s_waitcnt lgkmcnt(6)
v_mfma_f32_32x32x16_bf16 v[144:159], v[44:47], a[148:151], v[144:159]
ds_read_b64_tr_b16 v[60:61], v21 offset:55296
ds_read_b64_tr_b16 v[62:63], v21 offset:56320
buffer_load_dwordx4 a[212:215], v17, s[40:43], s11 offen offset:3072 sc1
s_waitcnt vmcnt(20) lgkmcnt(6)
v_mfma_f32_32x32x16_bf16 v[128:143], v[48:51], a[152:155], v[128:143]
buffer_load_dwordx4 a[216:219], v17, s[40:43], s12 offen offset:2048 sc1
s_waitcnt vmcnt(20)
s_mov_b64 exec, 0xffff
buffer_store_dword v30, v29, s[40:43], s94 offen sc1
s_mov_b64 exec, -1
s_add_u32 s94, s94, 0x400
s_barrier
ds_read_b64_tr_b16 v[32:33], v20 offset:16384
ds_read_b64_tr_b16 v[34:35], v20 offset:17408
s_waitcnt lgkmcnt(6)
v_mfma_f32_32x32x16_bf16 v[144:159], v[52:55], a[152:155], v[144:159]
ds_read_b64_tr_b16 v[36:37], v21 offset:16384
ds_read_b64_tr_b16 v[38:39], v21 offset:17408
buffer_load_dwordx4 a[220:223], v17, s[40:43], s12 offen offset:3072 sc1
s_waitcnt lgkmcnt(6)
v_mfma_f32_32x32x16_bf16 v[128:143], v[56:59], a[156:159], v[128:143]
ds_read_b64_tr_b16 v[40:41], v20 offset:18432
ds_read_b64_tr_b16 v[42:43], v20 offset:19456
buffer_load_dwordx4 a[224:227], v17, s[40:43], s13 offen offset:2048 sc1
s_waitcnt lgkmcnt(6)
v_mfma_f32_32x32x16_bf16 v[144:159], v[60:63], a[156:159], v[144:159]
ds_read_b64_tr_b16 v[44:45], v21 offset:18432
ds_read_b64_tr_b16 v[46:47], v21 offset:19456
buffer_load_dwordx4 a[228:231], v17, s[40:43], s13 offen offset:3072 sc1
s_waitcnt vmcnt(23) lgkmcnt(6)
v_mfma_f32_32x32x16_bf16 v[128:143], v[32:35], a[160:163], v[128:143]
ds_read_b64_tr_b16 v[48:49], v20 offset:20480
ds_read_b64_tr_b16 v[50:51], v20 offset:21504
buffer_load_dwordx4 a[232:235], v17, s[40:43], s14 offen offset:2048 sc1
s_waitcnt lgkmcnt(6)
v_mfma_f32_32x32x16_bf16 v[144:159], v[36:39], a[160:163], v[144:159]
ds_read_b64_tr_b16 v[52:53], v21 offset:20480
ds_read_b64_tr_b16 v[54:55], v21 offset:21504
buffer_load_dwordx4 a[236:239], v17, s[40:43], s14 offen offset:3072 sc1
s_waitcnt vmcnt(24) lgkmcnt(6)
v_mfma_f32_32x32x16_bf16 v[128:143], v[40:43], a[164:167], v[128:143]
ds_read_b64_tr_b16 v[56:57], v20 offset:22528
ds_read_b64_tr_b16 v[58:59], v20 offset:23552
s_add_u32 m0, s59, 0xc000
s_add_u32 s64, s44, 0x10000
buffer_load_dwordx4 v2, s[32:35], s64 offen offset:0 lds
s_mov_b32 s96, 0x1150800
v_mov_b32 v24, v30
s_mov_b64 exec, 0x7f
buffer_load_dword v24, v23, s[40:43], s96 offen sc1
s_mov_b64 exec, -1
s_waitcnt lgkmcnt(6)
v_mfma_f32_32x32x16_bf16 v[144:159], v[44:47], a[164:167], v[144:159]
ds_read_b64_tr_b16 v[60:61], v21 offset:22528
ds_read_b64_tr_b16 v[62:63], v21 offset:23552
buffer_load_dwordx4 v3, s[32:35], s64 offen offset:1024 lds
s_waitcnt vmcnt(26) lgkmcnt(6)
v_mfma_f32_32x32x16_bf16 v[128:143], v[48:51], a[168:171], v[128:143]
buffer_load_dwordx4 v4, s[32:35], s64 offen offset:2048 lds
s_cmp_lt_u32 s50, 8
s_cbranch_scc1 Ljoin_52
v_lshlrev_b32 v104, 6, v0
s_lshl_b32 s60, s51, 12
s_add_u32 s63, s60, 0x1130000
buffer_load_dword v105, v104, s[40:43], s63 offen sc1
Ljoin_52:
s_cmp_eq_u32 s98, 0
s_cbranch_scc1 Lhit_53
s_mov_b32 s60, 0x1150400
v_mov_b32 v22, v30
s_mov_b64 exec, 0x7f
buffer_load_dword v22, v23, s[40:43], s60 offen sc1
s_mov_b64 exec, -1
s_waitcnt vmcnt(0)
v_cmp_ne_u32 vcc, s52, v22
s_nop 4
s_cbranch_vccz Lok_54
s_mov_b32 s73, 0x8000
Lpoll_55:
s_mov_b64 exec, 0x7f
buffer_load_dword v22, v23, s[40:43], s60 offen sc1
s_mov_b64 exec, -1
s_sub_u32 s73, s73, 1
s_waitcnt vmcnt(0)
s_cbranch_scc1 Lok_54
v_cmp_ne_u32 vcc, s52, v22
s_nop 4
s_cbranch_vccnz Lpoll_55
Lok_54:
buffer_load_dwordx4 a[184:187], v14, s[40:43], s8 offen offset:2048 sc1
buffer_load_dwordx4 a[188:191], v14, s[40:43], s8 offen offset:3072 sc1
buffer_load_dwordx4 a[192:195], v14, s[40:43], s9 offen offset:2048 sc1
buffer_load_dwordx4 a[196:199], v14, s[40:43], s9 offen offset:3072 sc1
buffer_load_dwordx4 a[200:203], v14, s[40:43], s10 offen offset:2048 sc1
buffer_load_dwordx4 a[204:207], v14, s[40:43], s10 offen offset:3072 sc1
buffer_load_dwordx4 a[208:211], v14, s[40:43], s11 offen offset:2048 sc1
buffer_load_dwordx4 a[212:215], v14, s[40:43], s11 offen offset:3072 sc1
buffer_load_dwordx4 a[216:219], v14, s[40:43], s12 offen offset:2048 sc1
buffer_load_dwordx4 a[220:223], v14, s[40:43], s12 offen offset:3072 sc1
buffer_load_dwordx4 a[224:227], v14, s[40:43], s13 offen offset:2048 sc1
buffer_load_dwordx4 a[228:231], v14, s[40:43], s13 offen offset:3072 sc1
buffer_load_dwordx4 a[232:235], v14, s[40:43], s14 offen offset:2048 sc1
buffer_load_dwordx4 a[236:239], v14, s[40:43], s14 offen offset:3072 sc1
Lhit_53:
s_barrier
v_add_u32 v20, 0x14000, v20
ds_read_b64_tr_b16 v[32:33], v20 offset:0
ds_read_b64_tr_b16 v[34:35], v20 offset:1024
s_waitcnt lgkmcnt(6)
v_mfma_f32_32x32x16_bf16 v[144:159], v[52:55], a[168:171], v[144:159]
v_add_u32 v21, 0x14000, v21
ds_read_b64_tr_b16 v[36:37], v21 offset:0
ds_read_b64_tr_b16 v[38:39], v21 offset:1024
buffer_load_dwordx4 v5, s[32:35], s64 offen offset:3072 lds
s_waitcnt vmcnt(27) lgkmcnt(6)
v_mfma_f32_32x32x16_bf16 v[128:143], v[56:59], a[172:175], v[128:143]
ds_read_b64_tr_b16 v[40:41], v20 offset:2048
ds_read_b64_tr_b16 v[42:43], v20 offset:3072
s_add_u32 m0, s59, 0x10000
s_add_u32 s64, s46, 0x10000
s_lshl_b32 s88, s58, 15
s_add_u32 s64, s64, s88
buffer_load_dwordx4 v2, s[32:35], s64 offen offset:0 lds
s_waitcnt lgkmcnt(6)
v_mfma_f32_32x32x16_bf16 v[144:159], v[60:63], a[172:175], v[144:159]
ds_read_b64_tr_b16 v[44:45], v21 offset:2048
ds_read_b64_tr_b16 v[46:47], v21 offset:3072
buffer_load_dwordx4 v3, s[32:35], s64 offen offset:1024 lds
s_waitcnt vmcnt(28) lgkmcnt(6)
v_mfma_f32_32x32x16_bf16 v[128:143], v[32:35], a[176:179], v[128:143]
ds_read_b64_tr_b16 v[48:49], v20 offset:4096
ds_read_b64_tr_b16 v[50:51], v20 offset:5120
buffer_load_dwordx4 v4, s[32:35], s64 offen offset:2048 lds
s_waitcnt lgkmcnt(6)
v_mfma_f32_32x32x16_bf16 v[144:159], v[36:39], a[176:179], v[144:159]
ds_read_b64_tr_b16 v[52:53], v21 offset:4096
ds_read_b64_tr_b16 v[54:55], v21 offset:5120
buffer_load_dwordx4 v5, s[32:35], s64 offen offset:3072 lds
s_waitcnt vmcnt(29) lgkmcnt(6)
v_mfma_f32_32x32x16_bf16 v[128:143], v[40:43], a[180:183], v[128:143]
ds_read_b64_tr_b16 v[56:57], v20 offset:6144
ds_read_b64_tr_b16 v[58:59], v20 offset:7168
s_waitcnt lgkmcnt(6)
v_mfma_f32_32x32x16_bf16 v[144:159], v[44:47], a[180:183], v[144:159]
ds_read_b64_tr_b16 v[60:61], v21 offset:6144
ds_read_b64_tr_b16 v[62:63], v21 offset:7168
s_waitcnt vmcnt(18) lgkmcnt(6)
v_mfma_f32_32x32x16_bf16 v[128:143], v[48:51], a[184:187], v[128:143]
s_waitcnt vmcnt(7)
v_cmp_ne_u32 vcc, s52, v24
s_nop 4
s_cmp_eq_u64 vcc, 0
s_cselect_b32 s100, 0, 0x7ff00000
v_add_u32 v16, s100, v15
s_barrier
ds_read_b64_tr_b16 v[32:33], v20 offset:16384
ds_read_b64_tr_b16 v[34:35], v20 offset:17408
s_waitcnt lgkmcnt(6)
v_mfma_f32_32x32x16_bf16 v[144:159], v[52:55], a[184:187], v[144:159]
ds_read_b64_tr_b16 v[36:37], v21 offset:16384
ds_read_b64_tr_b16 v[38:39], v21 offset:17408
buffer_load_dwordx4 a[0:3], v16, s[40:43], s8 offen offset:0 sc1
s_waitcnt lgkmcnt(6)
v_mfma_f32_32x32x16_bf16 v[128:143], v[56:59], a[188:191], v[128:143]
ds_read_b64_tr_b16 v[40:41], v20 offset:18432
ds_read_b64_tr_b16 v[42:43], v20 offset:19456
buffer_load_dwordx4 a[4:7], v16, s[40:43], s8 offen offset:1024 sc1
s_cmp_lt_u32 s50, 8
s_cbranch_scc1 Ljoin_57
s_waitcnt vmcnt(7)
v_cmp_ne_u32 vcc, s52, v105
s_nop 4
s_cbranch_vccz Lok_58
s_mov_b32 s73, 0x8000
Lpoll_59:
buffer_load_dword v105, v104, s[40:43], s63 offen sc1
s_sub_u32 s73, s73, 1
s_waitcnt vmcnt(0)
s_cbranch_scc1 Lok_58
v_cmp_ne_u32 vcc, s52, v105
s_nop 4
s_cbranch_vccnz Lpoll_59
Lok_58:
s_lshl_b32 s60, s51, 13
s_add_u32 s60, s60, 0x1000000
s_add_u32 s61, s60, 0x1000
buffer_load_dwordx4 v[64:67], v1, s[40:43], s60 offen offset:0 sc1
buffer_load_dwordx4 v[68:71], v1, s[40:43], s60 offen offset:1024 sc1
buffer_load_dwordx4 v[72:75], v1, s[40:43], s60 offen offset:2048 sc1
buffer_load_dwordx4 v[76:79], v1, s[40:43], s60 offen offset:3072 sc1
buffer_load_dwordx4 v[80:83], v1, s[40:43], s61 offen offset:0 sc1
buffer_load_dwordx4 v[84:87], v1, s[40:43], s61 offen offset:1024 sc1
buffer_load_dwordx4 v[88:91], v1, s[40:43], s61 offen offset:2048 sc1
buffer_load_dwordx4 v[92:95], v1, s[40:43], s61 offen offset:3072 sc1
Ljoin_57:
s_mov_b32 s96, 0x1150c00
v_mov_b32 v24, v30
s_mov_b64 exec, 0x7f
buffer_load_dword v24, v23, s[40:43], s96 offen sc1
s_mov_b64 exec, -1
s_waitcnt lgkmcnt(6)
v_mfma_f32_32x32x16_bf16 v[144:159], v[60:63], a[188:191], v[144:159]
ds_read_b64_tr_b16 v[44:45], v21 offset:18432
ds_read_b64_tr_b16 v[46:47], v21 offset:19456
buffer_load_dwordx4 a[8:11], v16, s[40:43], s9 offen offset:0 sc1
s_waitcnt lgkmcnt(6)
v_mfma_f32_32x32x16_bf16 v[128:143], v[32:35], a[192:195], v[128:143]
ds_read_b64_tr_b16 v[48:49], v20 offset:20480
ds_read_b64_tr_b16 v[50:51], v20 offset:21504
buffer_load_dwordx4 a[12:15], v16, s[40:43], s9 offen offset:1024 sc1
s_waitcnt lgkmcnt(6)
v_mfma_f32_32x32x16_bf16 v[144:159], v[36:39], a[192:195], v[144:159]
ds_read_b64_tr_b16 v[52:53], v21 offset:20480
ds_read_b64_tr_b16 v[54:55], v21 offset:21504
buffer_load_dwordx4 a[16:19], v16, s[40:43], s10 offen offset:0 sc1
s_waitcnt lgkmcnt(6)
v_mfma_f32_32x32x16_bf16 v[128:143], v[40:43], a[196:199], v[128:143]
ds_read_b64_tr_b16 v[56:57], v20 offset:22528
ds_read_b64_tr_b16 v[58:59], v20 offset:23552
buffer_load_dwordx4 a[20:23], v16, s[40:43], s10 offen offset:1024 sc1
s_waitcnt lgkmcnt(6)
v_mfma_f32_32x32x16_bf16 v[144:159], v[44:47], a[196:199], v[144:159]
ds_read_b64_tr_b16 v[60:61], v21 offset:22528
ds_read_b64_tr_b16 v[62:63], v21 offset:23552
buffer_load_dwordx4 a[24:27], v16, s[40:43], s11 offen offset:0 sc1
s_waitcnt lgkmcnt(6)
v_mfma_f32_32x32x16_bf16 v[128:143], v[48:51], a[200:203], v[128:143]
buffer_load_dwordx4 a[28:31], v16, s[40:43], s11 offen offset:1024 sc1
s_barrier
v_add_u32 v20, 0xfffe8000, v20
ds_read_b64_tr_b16 v[32:33], v20 offset:0
ds_read_b64_tr_b16 v[34:35], v20 offset:1024
s_waitcnt lgkmcnt(6)
v_mfma_f32_32x32x16_bf16 v[144:159], v[52:55], a[200:203], v[144:159]
v_add_u32 v21, 0xfffe8000, v21
ds_read_b64_tr_b16 v[36:37], v21 offset:0
ds_read_b64_tr_b16 v[38:39], v21 offset:1024
buffer_load_dwordx4 a[32:35], v16, s[40:43], s12 offen offset:0 sc1
s_waitcnt lgkmcnt(6)
v_mfma_f32_32x32x16_bf16 v[128:143], v[56:59], a[204:207], v[128:143]
ds_read_b64_tr_b16 v[40:41], v20 offset:2048
ds_read_b64_tr_b16 v[42:43], v20 offset:3072
buffer_load_dwordx4 a[36:39], v16, s[40:43], s12 offen offset:1024 sc1
s_waitcnt lgkmcnt(6)
v_mfma_f32_32x32x16_bf16 v[144:159], v[60:63], a[204:207], v[144:159]
ds_read_b64_tr_b16 v[44:45], v21 offset:2048
ds_read_b64_tr_b16 v[46:47], v21 offset:3072
buffer_load_dwordx4 a[40:43], v16, s[40:43], s13 offen offset:0 sc1
s_waitcnt lgkmcnt(6)
v_mfma_f32_32x32x16_bf16 v[128:143], v[32:35], a[208:211], v[128:143]
ds_read_b64_tr_b16 v[48:49], v20 offset:4096
ds_read_b64_tr_b16 v[50:51], v20 offset:5120
buffer_load_dwordx4 a[44:47], v16, s[40:43], s13 offen offset:1024 sc1
s_waitcnt lgkmcnt(6)
v_mfma_f32_32x32x16_bf16 v[144:159], v[36:39], a[208:211], v[144:159]
ds_read_b64_tr_b16 v[52:53], v21 offset:4096
ds_read_b64_tr_b16 v[54:55], v21 offset:5120
buffer_load_dwordx4 a[48:51], v16, s[40:43], s14 offen offset:0 sc1
s_waitcnt lgkmcnt(6)
v_mfma_f32_32x32x16_bf16 v[128:143], v[40:43], a[212:215], v[128:143]
ds_read_b64_tr_b16 v[56:57], v20 offset:6144
ds_read_b64_tr_b16 v[58:59], v20 offset:7168
buffer_load_dwordx4 a[52:55], v16, s[40:43], s14 offen offset:1024 sc1
s_cmp_lt_u32 s50, 8
s_cbranch_scc1 Ljoin_61
s_lshl_b32 s60, s74, 15
s_lshl_b32 s61, s51, 12
s_add_u32 s60, s60, s61
s_add_u32 s60, s60, 0x400000
s_waitcnt vmcnt(20)
v_mfma_f32_32x32x16_bf16 v[192:207], v[64:67], v[224:227], 0
s_waitcnt vmcnt(19)
v_mfma_f32_32x32x16_bf16 v[192:207], v[68:71], v[228:231], v[192:207]
s_waitcnt vmcnt(18)
v_mfma_f32_32x32x16_bf16 v[208:223], v[72:75], v[232:235], 0
s_waitcnt vmcnt(17)
v_mfma_f32_32x32x16_bf16 v[208:223], v[76:79], v[236:239], v[208:223]
s_nop 7
v_add_f32 v200, 0x358637bd, v200
v_rcp_f32 v200, v200
s_nop 0
v_mul_f32 v192, v192, v200
v_mul_f32 v193, v193, v200
v_mul_f32 v194, v194, v200
v_mul_f32 v195, v195, v200
v_mul_f32 v196, v196, v200
v_mul_f32 v197, v197, v200
v_mul_f32 v198, v198, v200
v_mul_f32 v199, v199, v200
v_cvt_pk_bf16_f32 v96, v192, v193
v_cvt_pk_bf16_f32 v97, v194, v195
v_cvt_pk_bf16_f32 v98, v196, v197
v_cvt_pk_bf16_f32 v99, v198, v199
buffer_store_dwordx4 v[96:99], v1, s[40:43], s60 offen offset:0 sc1
s_waitcnt vmcnt(17)
v_mfma_f32_32x32x16_bf16 v[192:207], v[80:83], v[240:243], 0
s_waitcnt vmcnt(16)
v_mfma_f32_32x32x16_bf16 v[192:207], v[84:87], v[244:247], v[192:207]
v_add_f32 v216, 0x358637bd, v216
v_rcp_f32 v216, v216
s_nop 0
v_mul_f32 v208, v208, v216
v_mul_f32 v209, v209, v216
v_mul_f32 v210, v210, v216
v_mul_f32 v211, v211, v216
v_mul_f32 v212, v212, v216
v_mul_f32 v213, v213, v216
v_mul_f32 v214, v214, v216
v_mul_f32 v215, v215, v216
v_cvt_pk_bf16_f32 v100, v208, v209
v_cvt_pk_bf16_f32 v101, v210, v211
v_cvt_pk_bf16_f32 v102, v212, v213
v_cvt_pk_bf16_f32 v103, v214, v215
buffer_store_dwordx4 v[100:103], v1, s[40:43], s60 offen offset:1024 sc1
s_waitcnt vmcnt(16)
v_mfma_f32_32x32x16_bf16 v[208:223], v[88:91], v[248:251], 0
s_waitcnt vmcnt(15)
v_mfma_f32_32x32x16_bf16 v[208:223], v[92:95], v[252:255], v[208:223]
v_add_f32 v200, 0x358637bd, v200
v_rcp_f32 v200, v200
s_nop 0
v_mul_f32 v192, v192, v200
v_mul_f32 v193, v193, v200
v_mul_f32 v194, v194, v200
v_mul_f32 v195, v195, v200
v_mul_f32 v196, v196, v200
v_mul_f32 v197, v197, v200
v_mul_f32 v198, v198, v200
v_mul_f32 v199, v199, v200
v_cvt_pk_bf16_f32 v104, v192, v193
v_cvt_pk_bf16_f32 v105, v194, v195
v_cvt_pk_bf16_f32 v106, v196, v197
v_cvt_pk_bf16_f32 v107, v198, v199
buffer_store_dwordx4 v[104:107], v1, s[40:43], s60 offen offset:2048 sc1
v_add_f32 v216, 0x358637bd, v216
v_rcp_f32 v216, v216
s_nop 0
v_mul_f32 v208, v208, v216
v_mul_f32 v209, v209, v216
v_mul_f32 v210, v210, v216
v_mul_f32 v211, v211, v216
v_mul_f32 v212, v212, v216
v_mul_f32 v213, v213, v216
v_mul_f32 v214, v214, v216
v_mul_f32 v215, v215, v216
v_cvt_pk_bf16_f32 v108, v208, v209
v_cvt_pk_bf16_f32 v109, v210, v211
v_cvt_pk_bf16_f32 v110, v212, v213
v_cvt_pk_bf16_f32 v111, v214, v215
buffer_store_dwordx4 v[108:111], v1, s[40:43], s60 offen offset:3072 sc1
s_lshl_b32 s60, s74, 3
s_add_u32 s60, s60, s51
s_lshl_b32 s60, s60, 6
s_add_u32 s92, s60, 0x1140000
Ljoin_61:
s_waitcnt vmcnt(12)
v_cmp_ne_u32 vcc, s52, v24
s_nop 4
s_cmp_eq_u64 vcc, 0
s_cselect_b32 s101, 0, 0x7ff00000
v_add_u32 v17, s101, v15
s_waitcnt lgkmcnt(6)
v_mfma_f32_32x32x16_bf16 v[144:159], v[44:47], a[212:215], v[144:159]
ds_read_b64_tr_b16 v[60:61], v21 offset:6144
ds_read_b64_tr_b16 v[62:63], v21 offset:7168
s_add_u32 m0, s59, 0x8000
s_add_u32 s64, s21, 0x18000
buffer_load_dwordx4 v2, s[32:35], s64 offen offset:0 lds
s_waitcnt lgkmcnt(6)
v_mfma_f32_32x32x16_bf16 v[128:143], v[48:51], a[216:219], v[128:143]
buffer_load_dwordx4 v3, s[32:35], s64 offen offset:1024 lds
s_barrier
v_add_u32 v20, 0x14000, v20
ds_read_b64_tr_b16 v[32:33], v20 offset:0
ds_read_b64_tr_b16 v[34:35], v20 offset:1024
s_waitcnt lgkmcnt(6)
v_mfma_f32_32x32x16_bf16 v[144:159], v[52:55], a[216:219], v[144:159]
v_add_u32 v21, 0x14000, v21
ds_read_b64_tr_b16 v[36:37], v21 offset:0
ds_read_b64_tr_b16 v[38:39], v21 offset:1024
buffer_load_dwordx4 v4, s[32:35], s64 offen offset:2048 lds
s_waitcnt lgkmcnt(6)
v_mfma_f32_32x32x16_bf16 v[128:143], v[56:59], a[220:223], v[128:143]
ds_read_b64_tr_b16 v[40:41], v20 offset:2048
ds_read_b64_tr_b16 v[42:43], v20 offset:3072
buffer_load_dwordx4 v5, s[32:35], s64 offen offset:3072 lds
s_waitcnt lgkmcnt(6)
v_mfma_f32_32x32x16_bf16 v[144:159], v[60:63], a[220:223], v[144:159]
ds_read_b64_tr_b16 v[44:45], v21 offset:2048
ds_read_b64_tr_b16 v[46:47], v21 offset:3072
s_add_u32 m0, s59, 0x18000
s_add_u32 s64, s23, 0x18000
buffer_load_dwordx4 v2, s[32:35], s64 offen offset:0 lds
s_waitcnt lgkmcnt(6)
v_mfma_f32_32x32x16_bf16 v[128:143], v[32:35], a[224:227], v[128:143]
ds_read_b64_tr_b16 v[48:49], v20 offset:4096
ds_read_b64_tr_b16 v[50:51], v20 offset:5120
buffer_load_dwordx4 v3, s[32:35], s64 offen offset:1024 lds
s_waitcnt lgkmcnt(6)
v_mfma_f32_32x32x16_bf16 v[144:159], v[36:39], a[224:227], v[144:159]
ds_read_b64_tr_b16 v[52:53], v21 offset:4096
ds_read_b64_tr_b16 v[54:55], v21 offset:5120
buffer_load_dwordx4 v4, s[32:35], s64 offen offset:2048 lds
s_waitcnt lgkmcnt(6)
v_mfma_f32_32x32x16_bf16 v[128:143], v[40:43], a[228:231], v[128:143]
ds_read_b64_tr_b16 v[56:57], v20 offset:6144
ds_read_b64_tr_b16 v[58:59], v20 offset:7168
buffer_load_dwordx4 v5, s[32:35], s64 offen offset:3072 lds
s_cmp_eq_u32 s100, 0
s_cbranch_scc1 Lhit_62
s_mov_b32 s60, 0x1150800
v_mov_b32 v22, v30
s_mov_b64 exec, 0x7f
buffer_load_dword v22, v23, s[40:43], s60 offen sc1
s_mov_b64 exec, -1
s_waitcnt vmcnt(0)
v_cmp_ne_u32 vcc, s52, v22
s_nop 4
s_cbranch_vccz Lok_63
s_mov_b32 s73, 0x8000
Lpoll_64:
s_mov_b64 exec, 0x7f
buffer_load_dword v22, v23, s[40:43], s60 offen sc1
s_mov_b64 exec, -1
s_sub_u32 s73, s73, 1
s_waitcnt vmcnt(0)
s_cbranch_scc1 Lok_63
v_cmp_ne_u32 vcc, s52, v22
s_nop 4
s_cbranch_vccnz Lpoll_64
Lok_63:
buffer_load_dwordx4 a[0:3], v15, s[40:43], s8 offen offset:0 sc1
buffer_load_dwordx4 a[4:7], v15, s[40:43], s8 offen offset:1024 sc1
buffer_load_dwordx4 a[8:11], v15, s[40:43], s9 offen offset:0 sc1
buffer_load_dwordx4 a[12:15], v15, s[40:43], s9 offen offset:1024 sc1
buffer_load_dwordx4 a[16:19], v15, s[40:43], s10 offen offset:0 sc1
buffer_load_dwordx4 a[20:23], v15, s[40:43], s10 offen offset:1024 sc1
buffer_load_dwordx4 a[24:27], v15, s[40:43], s11 offen offset:0 sc1
buffer_load_dwordx4 a[28:31], v15, s[40:43], s11 offen offset:1024 sc1
buffer_load_dwordx4 a[32:35], v15, s[40:43], s12 offen offset:0 sc1
buffer_load_dwordx4 a[36:39], v15, s[40:43], s12 offen offset:1024 sc1
buffer_load_dwordx4 a[40:43], v15, s[40:43], s13 offen offset:0 sc1
buffer_load_dwordx4 a[44:47], v15, s[40:43], s13 offen offset:1024 sc1
buffer_load_dwordx4 a[48:51], v15, s[40:43], s14 offen offset:0 sc1
buffer_load_dwordx4 a[52:55], v15, s[40:43], s14 offen offset:1024 sc1
Lhit_62:
s_waitcnt lgkmcnt(6)
v_mfma_f32_32x32x16_bf16 v[144:159], v[44:47], a[228:231], v[144:159]
ds_read_b64_tr_b16 v[60:61], v21 offset:6144
ds_read_b64_tr_b16 v[62:63], v21 offset:7168
buffer_load_dwordx4 a[56:59], v17, s[40:43], s8 offen offset:2048 sc1
s_waitcnt lgkmcnt(6)
v_mfma_f32_32x32x16_bf16 v[128:143], v[48:51], a[232:235], v[128:143]
buffer_load_dwordx4 a[60:63], v17, s[40:43], s8 offen offset:3072 sc1
s_barrier
ds_read_b64_tr_b16 v[32:33], v20 offset:49152
ds_read_b64_tr_b16 v[34:35], v20 offset:50176
s_waitcnt lgkmcnt(6)
v_mfma_f32_32x32x16_bf16 v[144:159], v[52:55], a[232:235], v[144:159]
ds_read_b64_tr_b16 v[36:37], v21 offset:49152
ds_read_b64_tr_b16 v[38:39], v21 offset:50176
buffer_load_dwordx4 a[64:67], v17, s[40:43], s9 offen offset:2048 sc1
s_waitcnt lgkmcnt(6)
v_mfma_f32_32x32x16_bf16 v[128:143], v[56:59], a[236:239], v[128:143]
ds_read_b64_tr_b16 v[40:41], v20 offset:51200
ds_read_b64_tr_b16 v[42:43], v20 offset:52224
buffer_load_dwordx4 a[68:71], v17, s[40:43], s9 offen offset:3072 sc1
s_waitcnt lgkmcnt(6)
v_mfma_f32_32x32x16_bf16 v[144:159], v[60:63], a[236:239], v[144:159]
ds_read_b64_tr_b16 v[44:45], v21 offset:51200
ds_read_b64_tr_b16 v[46:47], v21 offset:52224
buffer_load_dwordx4 a[72:75], v17, s[40:43], s10 offen offset:2048 sc1
s_waitcnt vmcnt(18) lgkmcnt(6)
v_mfma_f32_32x32x16_bf16 v[128:143], v[32:35], a[0:3], v[128:143]
ds_read_b64_tr_b16 v[48:49], v20 offset:53248
ds_read_b64_tr_b16 v[50:51], v20 offset:54272
buffer_load_dwordx4 a[76:79], v17, s[40:43], s10 offen offset:3072 sc1
s_cmp_lt_u32 s50, 8
s_cbranch_scc1 Ljoin_66
s_waitcnt vmcnt(14)
s_mov_b64 exec, 0xffff
buffer_store_dword v30, v29, s[40:43], s92 offen sc1
s_mov_b64 exec, -1
Ljoin_66:
s_waitcnt lgkmcnt(6)
v_mfma_f32_32x32x16_bf16 v[144:159], v[36:39], a[0:3], v[144:159]
ds_read_b64_tr_b16 v[52:53], v21 offset:53248
ds_read_b64_tr_b16 v[54:55], v21 offset:54272
buffer_load_dwordx4 a[80:83], v17, s[40:43], s11 offen offset:2048 sc1
s_waitcnt vmcnt(19) lgkmcnt(6)
v_mfma_f32_32x32x16_bf16 v[128:143], v[40:43], a[4:7], v[128:143]
ds_read_b64_tr_b16 v[56:57], v20 offset:55296
ds_read_b64_tr_b16 v[58:59], v20 offset:56320
buffer_load_dwordx4 a[84:87], v17, s[40:43], s11 offen offset:3072 sc1
s_waitcnt lgkmcnt(6)
v_mfma_f32_32x32x16_bf16 v[144:159], v[44:47], a[4:7], v[144:159]
ds_read_b64_tr_b16 v[60:61], v21 offset:55296
ds_read_b64_tr_b16 v[62:63], v21 offset:56320
buffer_load_dwordx4 a[88:91], v17, s[40:43], s12 offen offset:2048 sc1
s_waitcnt vmcnt(20) lgkmcnt(6)
v_mfma_f32_32x32x16_bf16 v[128:143], v[48:51], a[8:11], v[128:143]
buffer_load_dwordx4 a[92:95], v17, s[40:43], s12 offen offset:3072 sc1
s_barrier
v_add_u32 v20, 0xffff0000, v20
ds_read_b64_tr_b16 v[32:33], v20 offset:0
ds_read_b64_tr_b16 v[34:35], v20 offset:1024
s_waitcnt lgkmcnt(6)
v_mfma_f32_32x32x16_bf16 v[144:159], v[52:55], a[8:11], v[144:159]
v_add_u32 v21, 0xffff0000, v21
ds_read_b64_tr_b16 v[36:37], v21 offset:0
ds_read_b64_tr_b16 v[38:39], v21 offset:1024
buffer_load_dwordx4 a[96:99], v17, s[40:43], s13 offen offset:2048 sc1
s_waitcnt vmcnt(21) lgkmcnt(6)
v_mfma_f32_32x32x16_bf16 v[128:143], v[56:59], a[12:15], v[128:143]
ds_read_b64_tr_b16 v[40:41], v20 offset:2048
ds_read_b64_tr_b16 v[42:43], v20 offset:3072
buffer_load_dwordx4 a[100:103], v17, s[40:43], s13 offen offset:3072 sc1
s_waitcnt lgkmcnt(6)
v_mfma_f32_32x32x16_bf16 v[144:159], v[60:63], a[12:15], v[144:159]
ds_read_b64_tr_b16 v[44:45], v21 offset:2048
ds_read_b64_tr_b16 v[46:47], v21 offset:3072
buffer_load_dwordx4 a[104:107], v17, s[40:43], s14 offen offset:2048 sc1
s_waitcnt vmcnt(22) lgkmcnt(6)
v_mfma_f32_32x32x16_bf16 v[128:143], v[32:35], a[16:19], v[128:143]
ds_read_b64_tr_b16 v[48:49], v20 offset:4096
ds_read_b64_tr_b16 v[50:51], v20 offset:5120
buffer_load_dwordx4 a[108:111], v17, s[40:43], s14 offen offset:3072 sc1
s_waitcnt lgkmcnt(6)
v_mfma_f32_32x32x16_bf16 v[144:159], v[36:39], a[16:19], v[144:159]
ds_read_b64_tr_b16 v[52:53], v21 offset:4096
ds_read_b64_tr_b16 v[54:55], v21 offset:5120
s_add_u32 m0, s59, 0x1c000
s_add_u32 s64, s45, 0x18000
buffer_load_dwordx4 v2, s[32:35], s64 offen offset:0 lds
s_waitcnt vmcnt(23) lgkmcnt(6)
v_mfma_f32_32x32x16_bf16 v[128:143], v[40:43], a[20:23], v[128:143]
ds_read_b64_tr_b16 v[56:57], v20 offset:6144
ds_read_b64_tr_b16 v[58:59], v20 offset:7168
buffer_load_dwordx4 v3, s[32:35], s64 offen offset:1024 lds
s_waitcnt lgkmcnt(6)
v_mfma_f32_32x32x16_bf16 v[144:159], v[44:47], a[20:23], v[144:159]
ds_read_b64_tr_b16 v[60:61], v21 offset:6144
ds_read_b64_tr_b16 v[62:63], v21 offset:7168
buffer_load_dwordx4 v4, s[32:35], s64 offen offset:2048 lds
s_waitcnt vmcnt(24) lgkmcnt(6)
v_mfma_f32_32x32x16_bf16 v[128:143], v[48:51], a[24:27], v[128:143]
buffer_load_dwordx4 v5, s[32:35], s64 offen offset:3072 lds
s_barrier
ds_read_b64_tr_b16 v[32:33], v20 offset:32768
ds_read_b64_tr_b16 v[34:35], v20 offset:33792
s_waitcnt lgkmcnt(6)
v_mfma_f32_32x32x16_bf16 v[144:159], v[52:55], a[24:27], v[144:159]
ds_read_b64_tr_b16 v[36:37], v21 offset:32768
ds_read_b64_tr_b16 v[38:39], v21 offset:33792
s_add_u32 m0, s59, 0x0
s_mul_i32 s64, s65, 512
s_add_u32 s64, s64, s56
buffer_load_dwordx4 v6, s[16:19], s64 offen offset:0 lds
s_waitcnt vmcnt(25) lgkmcnt(6)
v_mfma_f32_32x32x16_bf16 v[128:143], v[56:59], a[28:31], v[128:143]
ds_read_b64_tr_b16 v[40:41], v20 offset:34816
ds_read_b64_tr_b16 v[42:43], v20 offset:35840
buffer_load_dwordx4 v7, s[16:19], s64 offen offset:1024 lds
s_waitcnt lgkmcnt(6)
v_mfma_f32_32x32x16_bf16 v[144:159], v[60:63], a[28:31], v[144:159]
ds_read_b64_tr_b16 v[44:45], v21 offset:34816
ds_read_b64_tr_b16 v[46:47], v21 offset:35840
buffer_load_dwordx4 v8, s[16:19], s64 offen offset:2048 lds
s_waitcnt vmcnt(26) lgkmcnt(6)
v_mfma_f32_32x32x16_bf16 v[128:143], v[32:35], a[32:35], v[128:143]
ds_read_b64_tr_b16 v[48:49], v20 offset:36864
ds_read_b64_tr_b16 v[50:51], v20 offset:37888
buffer_load_dwordx4 v9, s[16:19], s64 offen offset:3072 lds
s_waitcnt lgkmcnt(6)
v_mfma_f32_32x32x16_bf16 v[144:159], v[36:39], a[32:35], v[144:159]
ds_read_b64_tr_b16 v[52:53], v21 offset:36864
ds_read_b64_tr_b16 v[54:55], v21 offset:37888
s_add_u32 m0, s59, 0x14000
s_mul_i32 s64, s66, 512
s_add_u32 s64, s64, s56
buffer_load_dwordx4 v6, s[16:19], s64 offen offset:0 lds
s_waitcnt vmcnt(27) lgkmcnt(6)
v_mfma_f32_32x32x16_bf16 v[128:143], v[40:43], a[36:39], v[128:143]
ds_read_b64_tr_b16 v[56:57], v20 offset:38912
ds_read_b64_tr_b16 v[58:59], v20 offset:39936
buffer_load_dwordx4 v7, s[16:19], s64 offen offset:1024 lds
s_cmp_eq_u32 s101, 0
s_cbranch_scc1 Lhit_67
s_mov_b32 s60, 0x1150c00
v_mov_b32 v22, v30
s_mov_b64 exec, 0x7f
buffer_load_dword v22, v23, s[40:43], s60 offen sc1
s_mov_b64 exec, -1
s_waitcnt vmcnt(0)
v_cmp_ne_u32 vcc, s52, v22
s_nop 4
s_cbranch_vccz Lok_68
s_mov_b32 s73, 0x8000
Lpoll_69:
s_mov_b64 exec, 0x7f
buffer_load_dword v22, v23, s[40:43], s60 offen sc1
s_mov_b64 exec, -1
s_sub_u32 s73, s73, 1
s_waitcnt vmcnt(0)
s_cbranch_scc1 Lok_68
v_cmp_ne_u32 vcc, s52, v22
s_nop 4
s_cbranch_vccnz Lpoll_69
Lok_68:
buffer_load_dwordx4 a[56:59], v15, s[40:43], s8 offen offset:2048 sc1
buffer_load_dwordx4 a[60:63], v15, s[40:43], s8 offen offset:3072 sc1
buffer_load_dwordx4 a[64:67], v15, s[40:43], s9 offen offset:2048 sc1
buffer_load_dwordx4 a[68:71], v15, s[40:43], s9 offen offset:3072 sc1
buffer_load_dwordx4 a[72:75], v15, s[40:43], s10 offen offset:2048 sc1
buffer_load_dwordx4 a[76:79], v15, s[40:43], s10 offen offset:3072 sc1
buffer_load_dwordx4 a[80:83], v15, s[40:43], s11 offen offset:2048 sc1
buffer_load_dwordx4 a[84:87], v15, s[40:43], s11 offen offset:3072 sc1
buffer_load_dwordx4 a[88:91], v15, s[40:43], s12 offen offset:2048 sc1
buffer_load_dwordx4 a[92:95], v15, s[40:43], s12 offen offset:3072 sc1
buffer_load_dwordx4 a[96:99], v15, s[40:43], s13 offen offset:2048 sc1
buffer_load_dwordx4 a[100:103], v15, s[40:43], s13 offen offset:3072 sc1
buffer_load_dwordx4 a[104:107], v15, s[40:43], s14 offen offset:2048 sc1
buffer_load_dwordx4 a[108:111], v15, s[40:43], s14 offen offset:3072 sc1
Lhit_67:
s_waitcnt lgkmcnt(6)
v_mfma_f32_32x32x16_bf16 v[144:159], v[44:47], a[36:39], v[144:159]
ds_read_b64_tr_b16 v[60:61], v21 offset:38912
ds_read_b64_tr_b16 v[62:63], v21 offset:39936
buffer_load_dwordx4 v8, s[16:19], s64 offen offset:2048 lds
s_waitcnt vmcnt(28) lgkmcnt(6)
v_mfma_f32_32x32x16_bf16 v[128:143], v[48:51], a[40:43], v[128:143]
buffer_load_dwordx4 v9, s[16:19], s64 offen offset:3072 lds
v_and_b32 v23, 3, v0
v_lshlrev_b32 v23, 6, v23
s_lshl_b32 s60, s55, 1
s_add_u32 s60, s60, s57
s_lshl_b32 s60, s60, 8
s_add_u32 s96, s60, 0x1140000
v_mov_b32 v24, v30
s_mov_b64 exec, 0xf
buffer_load_dword v24, v23, s[40:43], s96 offen sc1
s_mov_b64 exec, -1
s_barrier
ds_read_b64_tr_b16 v[32:33], v20 offset:49152
ds_read_b64_tr_b16 v[34:35], v20 offset:50176
s_waitcnt lgkmcnt(6)
v_mfma_f32_32x32x16_bf16 v[144:159], v[52:55], a[40:43], v[144:159]
ds_read_b64_tr_b16 v[36:37], v21 offset:49152
ds_read_b64_tr_b16 v[38:39], v21 offset:50176
s_add_u32 m0, s59, 0x20000
s_mul_i32 s64, s67, 512
s_add_u32 s64, s64, s56
buffer_load_dwordx4 v6, s[16:19], s64 offen offset:0 lds
s_waitcnt vmcnt(30) lgkmcnt(6)
v_mfma_f32_32x32x16_bf16 v[128:143], v[56:59], a[44:47], v[128:143]
ds_read_b64_tr_b16 v[40:41], v20 offset:51200
ds_read_b64_tr_b16 v[42:43], v20 offset:52224
buffer_load_dwordx4 v7, s[16:19], s64 offen offset:1024 lds
s_waitcnt lgkmcnt(6)
v_mfma_f32_32x32x16_bf16 v[144:159], v[60:63], a[44:47], v[144:159]
ds_read_b64_tr_b16 v[44:45], v21 offset:51200
ds_read_b64_tr_b16 v[46:47], v21 offset:52224
buffer_load_dwordx4 v8, s[16:19], s64 offen offset:2048 lds
s_waitcnt vmcnt(31) lgkmcnt(6)
v_mfma_f32_32x32x16_bf16 v[128:143], v[32:35], a[48:51], v[128:143]
ds_read_b64_tr_b16 v[48:49], v20 offset:53248
ds_read_b64_tr_b16 v[50:51], v20 offset:54272
buffer_load_dwordx4 v9, s[16:19], s64 offen offset:3072 lds
s_waitcnt lgkmcnt(6)
v_mfma_f32_32x32x16_bf16 v[144:159], v[36:39], a[48:51], v[144:159]
ds_read_b64_tr_b16 v[52:53], v21 offset:53248
ds_read_b64_tr_b16 v[54:55], v21 offset:54272
s_add_u32 m0, s59, 0x4000
s_mul_i32 s64, s68, 512
s_add_u32 s64, s64, s56
buffer_load_dwordx4 v6, s[16:19], s64 offen offset:0 lds
s_waitcnt vmcnt(32) lgkmcnt(6)
v_mfma_f32_32x32x16_bf16 v[128:143], v[40:43], a[52:55], v[128:143]
ds_read_b64_tr_b16 v[56:57], v20 offset:55296
ds_read_b64_tr_b16 v[58:59], v20 offset:56320
buffer_load_dwordx4 v7, s[16:19], s64 offen offset:1024 lds
s_waitcnt lgkmcnt(6)
v_mfma_f32_32x32x16_bf16 v[144:159], v[44:47], a[52:55], v[144:159]
ds_read_b64_tr_b16 v[60:61], v21 offset:55296
ds_read_b64_tr_b16 v[62:63], v21 offset:56320
buffer_load_dwordx4 v8, s[16:19], s64 offen offset:2048 lds
s_waitcnt vmcnt(23) lgkmcnt(6)
v_mfma_f32_32x32x16_bf16 v[128:143], v[48:51], a[56:59], v[128:143]
buffer_load_dwordx4 v9, s[16:19], s64 offen offset:3072 lds
s_barrier
ds_read_b64_tr_b16 v[32:33], v20 offset:16384
ds_read_b64_tr_b16 v[34:35], v20 offset:17408
s_waitcnt lgkmcnt(6)
v_mfma_f32_32x32x16_bf16 v[144:159], v[52:55], a[56:59], v[144:159]
ds_read_b64_tr_b16 v[36:37], v21 offset:16384
ds_read_b64_tr_b16 v[38:39], v21 offset:17408
s_waitcnt vmcnt(23) lgkmcnt(6)
v_mfma_f32_32x32x16_bf16 v[128:143], v[56:59], a[60:63], v[128:143]
ds_read_b64_tr_b16 v[40:41], v20 offset:18432
ds_read_b64_tr_b16 v[42:43], v20 offset:19456
s_waitcnt lgkmcnt(6)
v_mfma_f32_32x32x16_bf16 v[144:159], v[60:63], a[60:63], v[144:159]
ds_read_b64_tr_b16 v[44:45], v21 offset:18432
ds_read_b64_tr_b16 v[46:47], v21 offset:19456
s_waitcnt vmcnt(22) lgkmcnt(6)
v_mfma_f32_32x32x16_bf16 v[128:143], v[32:35], a[64:67], v[128:143]
ds_read_b64_tr_b16 v[48:49], v20 offset:20480
ds_read_b64_tr_b16 v[50:51], v20 offset:21504
s_waitcnt vmcnt(8)
v_cmp_ne_u32 vcc, s52, v24
s_nop 4
s_cbranch_vccz Lok_70
s_mov_b32 s73, 0x8000
Lpoll_71:
s_mov_b64 exec, 0xf
buffer_load_dword v24, v23, s[40:43], s96 offen sc1
s_mov_b64 exec, -1
s_sub_u32 s73, s73, 1
s_waitcnt vmcnt(0)
s_cbranch_scc1 Lok_70
v_cmp_ne_u32 vcc, s52, v24
s_nop 4
s_cbranch_vccnz Lpoll_71
Lok_70:
s_waitcnt lgkmcnt(6)
v_mfma_f32_32x32x16_bf16 v[144:159], v[36:39], a[64:67], v[144:159]
ds_read_b64_tr_b16 v[52:53], v21 offset:20480
ds_read_b64_tr_b16 v[54:55], v21 offset:21504
s_lshl_b32 s88, s55, 15
s_lshl_b32 s89, s57, 14
s_add_u32 s88, s88, s89
s_add_u32 s88, s88, 0x400000
s_lshl_b32 s89, s65, 5
s_add_u32 s89, s89, s88
buffer_load_dwordx4 a[128:131], v1, s[40:43], s89 offen offset:0 sc1
s_waitcnt lgkmcnt(6)
v_mfma_f32_32x32x16_bf16 v[128:143], v[40:43], a[68:71], v[128:143]
ds_read_b64_tr_b16 v[56:57], v20 offset:22528
ds_read_b64_tr_b16 v[58:59], v20 offset:23552
buffer_load_dwordx4 a[132:135], v1, s[40:43], s89 offen offset:1024 sc1
s_waitcnt lgkmcnt(6)
v_mfma_f32_32x32x16_bf16 v[144:159], v[44:47], a[68:71], v[144:159]
ds_read_b64_tr_b16 v[60:61], v21 offset:22528
ds_read_b64_tr_b16 v[62:63], v21 offset:23552
buffer_load_dwordx4 a[136:139], v1, s[40:43], s89 offen offset:2048 sc1
s_waitcnt lgkmcnt(6)
v_mfma_f32_32x32x16_bf16 v[128:143], v[48:51], a[72:75], v[128:143]
buffer_load_dwordx4 a[140:143], v1, s[40:43], s89 offen offset:3072 sc1
s_barrier
v_add_u32 v20, 0x14000, v20
ds_read_b64_tr_b16 v[32:33], v20 offset:0
ds_read_b64_tr_b16 v[34:35], v20 offset:1024
s_waitcnt lgkmcnt(6)
v_mfma_f32_32x32x16_bf16 v[144:159], v[52:55], a[72:75], v[144:159]
v_add_u32 v21, 0x14000, v21
ds_read_b64_tr_b16 v[36:37], v21 offset:0
ds_read_b64_tr_b16 v[38:39], v21 offset:1024
s_lshl_b32 s89, s66, 5
s_add_u32 s89, s89, s88
buffer_load_dwordx4 a[144:147], v1, s[40:43], s89 offen offset:0 sc1
s_waitcnt lgkmcnt(6)
v_mfma_f32_32x32x16_bf16 v[128:143], v[56:59], a[76:79], v[128:143]
ds_read_b64_tr_b16 v[40:41], v20 offset:2048
ds_read_b64_tr_b16 v[42:43], v20 offset:3072
buffer_load_dwordx4 a[148:151], v1, s[40:43], s89 offen offset:1024 sc1
s_waitcnt lgkmcnt(6)
v_mfma_f32_32x32x16_bf16 v[144:159], v[60:63], a[76:79], v[144:159]
ds_read_b64_tr_b16 v[44:45], v21 offset:2048
ds_read_b64_tr_b16 v[46:47], v21 offset:3072
buffer_load_dwordx4 a[152:155], v1, s[40:43], s89 offen offset:2048 sc1
s_waitcnt lgkmcnt(6)
v_mfma_f32_32x32x16_bf16 v[128:143], v[32:35], a[80:83], v[128:143]
ds_read_b64_tr_b16 v[48:49], v20 offset:4096
ds_read_b64_tr_b16 v[50:51], v20 offset:5120
buffer_load_dwordx4 a[156:159], v1, s[40:43], s89 offen offset:3072 sc1
s_waitcnt lgkmcnt(6)
v_mfma_f32_32x32x16_bf16 v[144:159], v[36:39], a[80:83], v[144:159]
ds_read_b64_tr_b16 v[52:53], v21 offset:4096
ds_read_b64_tr_b16 v[54:55], v21 offset:5120
s_lshl_b32 s89, s67, 5
s_add_u32 s89, s89, s88
buffer_load_dwordx4 a[160:163], v1, s[40:43], s89 offen offset:0 sc1
s_waitcnt lgkmcnt(6)
v_mfma_f32_32x32x16_bf16 v[128:143], v[40:43], a[84:87], v[128:143]
ds_read_b64_tr_b16 v[56:57], v20 offset:6144
ds_read_b64_tr_b16 v[58:59], v20 offset:7168
buffer_load_dwordx4 a[164:167], v1, s[40:43], s89 offen offset:1024 sc1
s_waitcnt lgkmcnt(6)
v_mfma_f32_32x32x16_bf16 v[144:159], v[44:47], a[84:87], v[144:159]
ds_read_b64_tr_b16 v[60:61], v21 offset:6144
ds_read_b64_tr_b16 v[62:63], v21 offset:7168
buffer_load_dwordx4 a[168:171], v1, s[40:43], s89 offen offset:2048 sc1
s_waitcnt lgkmcnt(6)
v_mfma_f32_32x32x16_bf16 v[128:143], v[48:51], a[88:91], v[128:143]
buffer_load_dwordx4 a[172:175], v1, s[40:43], s89 offen offset:3072 sc1
s_barrier
ds_read_b64_tr_b16 v[32:33], v20 offset:16384
ds_read_b64_tr_b16 v[34:35], v20 offset:17408
s_waitcnt lgkmcnt(6)
v_mfma_f32_32x32x16_bf16 v[144:159], v[52:55], a[88:91], v[144:159]
ds_read_b64_tr_b16 v[36:37], v21 offset:16384
ds_read_b64_tr_b16 v[38:39], v21 offset:17408
s_lshl_b32 s89, s68, 5
s_add_u32 s89, s89, s88
buffer_load_dwordx4 a[176:179], v1, s[40:43], s89 offen offset:0 sc1
s_waitcnt lgkmcnt(6)
v_mfma_f32_32x32x16_bf16 v[128:143], v[56:59], a[92:95], v[128:143]
ds_read_b64_tr_b16 v[40:41], v20 offset:18432
ds_read_b64_tr_b16 v[42:43], v20 offset:19456
buffer_load_dwordx4 a[180:183], v1, s[40:43], s89 offen offset:1024 sc1
s_waitcnt lgkmcnt(6)
v_mfma_f32_32x32x16_bf16 v[144:159], v[60:63], a[92:95], v[144:159]
ds_read_b64_tr_b16 v[44:45], v21 offset:18432
ds_read_b64_tr_b16 v[46:47], v21 offset:19456
buffer_load_dwordx4 a[184:187], v1, s[40:43], s89 offen offset:2048 sc1
s_waitcnt lgkmcnt(6)
v_mfma_f32_32x32x16_bf16 v[128:143], v[32:35], a[96:99], v[128:143]
ds_read_b64_tr_b16 v[48:49], v20 offset:20480
ds_read_b64_tr_b16 v[50:51], v20 offset:21504
buffer_load_dwordx4 a[188:191], v1, s[40:43], s89 offen offset:3072 sc1
s_waitcnt lgkmcnt(6)
v_mfma_f32_32x32x16_bf16 v[144:159], v[36:39], a[96:99], v[144:159]
ds_read_b64_tr_b16 v[52:53], v21 offset:20480
ds_read_b64_tr_b16 v[54:55], v21 offset:21504
s_waitcnt lgkmcnt(6)
v_mfma_f32_32x32x16_bf16 v[128:143], v[40:43], a[100:103], v[128:143]
ds_read_b64_tr_b16 v[56:57], v20 offset:22528
ds_read_b64_tr_b16 v[58:59], v20 offset:23552
s_waitcnt lgkmcnt(6)
v_mfma_f32_32x32x16_bf16 v[144:159], v[44:47], a[100:103], v[144:159]
ds_read_b64_tr_b16 v[60:61], v21 offset:22528
ds_read_b64_tr_b16 v[62:63], v21 offset:23552
s_waitcnt lgkmcnt(6)
v_mfma_f32_32x32x16_bf16 v[128:143], v[48:51], a[104:107], v[128:143]
s_barrier
v_add_u32 v20, 0xfffe8000, v20
ds_read_b64_tr_b16 v[32:33], v20 offset:0
ds_read_b64_tr_b16 v[34:35], v20 offset:1024
s_waitcnt lgkmcnt(6)
v_mfma_f32_32x32x16_bf16 v[144:159], v[52:55], a[104:107], v[144:159]
v_add_u32 v21, 0xfffe8000, v21
ds_read_b64_tr_b16 v[36:37], v21 offset:0
ds_read_b64_tr_b16 v[38:39], v21 offset:1024
s_waitcnt lgkmcnt(6)
v_mfma_f32_32x32x16_bf16 v[128:143], v[56:59], a[108:111], v[128:143]
ds_read_b64_tr_b16 v[40:41], v20 offset:2048
ds_read_b64_tr_b16 v[42:43], v20 offset:3072
s_waitcnt lgkmcnt(6)
v_mfma_f32_32x32x16_bf16 v[144:159], v[60:63], a[108:111], v[144:159]
ds_read_b64_tr_b16 v[44:45], v21 offset:2048
ds_read_b64_tr_b16 v[46:47], v21 offset:3072
s_waitcnt vmcnt(15) lgkmcnt(6)
v_mfma_f32_32x32x16_bf16 v[160:175], v[32:35], a[128:131], 0
ds_read_b64_tr_b16 v[48:49], v20 offset:4096
ds_read_b64_tr_b16 v[50:51], v20 offset:5120
s_waitcnt lgkmcnt(6)
v_mfma_f32_32x32x16_bf16 v[176:191], v[36:39], a[128:131], 0
ds_read_b64_tr_b16 v[52:53], v21 offset:4096
ds_read_b64_tr_b16 v[54:55], v21 offset:5120
s_add_u32 s60, s59, 0x24000
v_add_u32 v23, s60, v1
ds_write_b128 v23, v[144:147] offset:0
ds_write_b128 v23, v[148:151] offset:1024
ds_write_b128 v23, v[152:155] offset:2048
ds_write_b128 v23, v[156:159] offset:3072
s_waitcnt vmcnt(14) lgkmcnt(10)
v_mfma_f32_32x32x16_bf16 v[160:175], v[40:43], a[132:135], v[160:175]
ds_read_b64_tr_b16 v[56:57], v20 offset:6144
ds_read_b64_tr_b16 v[58:59], v20 offset:7168
s_waitcnt lgkmcnt(10)
v_mfma_f32_32x32x16_bf16 v[176:191], v[44:47], a[132:135], v[176:191]
ds_read_b64_tr_b16 v[60:61], v21 offset:6144
ds_read_b64_tr_b16 v[62:63], v21 offset:7168
s_waitcnt vmcnt(13) lgkmcnt(10)
v_mfma_f32_32x32x16_bf16 v[160:175], v[48:51], a[136:139], v[160:175]
s_waitcnt lgkmcnt(4)
s_barrier
v_add_u32 v20, 0x14000, v20
ds_read_b64_tr_b16 v[32:33], v20 offset:0
ds_read_b64_tr_b16 v[34:35], v20 offset:1024
v_mfma_f32_32x32x16_bf16 v[176:191], v[52:55], a[136:139], v[176:191]
v_add_u32 v21, 0x14000, v21
ds_read_b64_tr_b16 v[36:37], v21 offset:0
ds_read_b64_tr_b16 v[38:39], v21 offset:1024
s_waitcnt vmcnt(12) lgkmcnt(6)
v_mfma_f32_32x32x16_bf16 v[160:175], v[56:59], a[140:143], v[160:175]
ds_read_b64_tr_b16 v[40:41], v20 offset:2048
ds_read_b64_tr_b16 v[42:43], v20 offset:3072
v_xor_b32 v23, 0x2000, v23
ds_read_b128 v[64:67], v23 offset:0
ds_read_b128 v[68:71], v23 offset:1024
ds_read_b128 v[72:75], v23 offset:2048
ds_read_b128 v[76:79], v23 offset:3072
s_waitcnt lgkmcnt(10)
v_mfma_f32_32x32x16_bf16 v[176:191], v[60:63], a[140:143], v[176:191]
ds_read_b64_tr_b16 v[44:45], v21 offset:2048
ds_read_b64_tr_b16 v[46:47], v21 offset:3072
s_waitcnt vmcnt(11) lgkmcnt(10)
v_mfma_f32_32x32x16_bf16 v[160:175], v[32:35], a[144:147], v[160:175]
ds_read_b64_tr_b16 v[48:49], v20 offset:4096
ds_read_b64_tr_b16 v[50:51], v20 offset:5120
s_waitcnt lgkmcnt(10)
v_mfma_f32_32x32x16_bf16 v[176:191], v[36:39], a[144:147], v[176:191]
ds_read_b64_tr_b16 v[52:53], v21 offset:4096
ds_read_b64_tr_b16 v[54:55], v21 offset:5120
s_waitcnt vmcnt(10) lgkmcnt(10)
v_mfma_f32_32x32x16_bf16 v[160:175], v[40:43], a[148:151], v[160:175]
ds_read_b64_tr_b16 v[56:57], v20 offset:6144
ds_read_b64_tr_b16 v[58:59], v20 offset:7168
s_mov_b32 s78, 0xbfb8aa3b
v_pk_add_f32 v[128:129], v[128:129], v[112:113]
v_pk_add_f32 v[130:131], v[130:131], v[114:115]
v_pk_add_f32 v[132:133], v[132:133], v[116:117]
v_pk_add_f32 v[134:135], v[134:135], v[118:119]
v_pk_add_f32 v[136:137], v[136:137], v[120:121]
v_pk_add_f32 v[138:139], v[138:139], v[122:123]
v_pk_add_f32 v[140:141], v[140:141], v[124:125]
v_pk_add_f32 v[142:143], v[142:143], v[126:127]
s_waitcnt lgkmcnt(11)
v_pk_add_f32 v[128:129], v[128:129], v[64:65]
v_pk_add_f32 v[130:131], v[130:131], v[66:67]
s_waitcnt lgkmcnt(10)
v_pk_add_f32 v[132:133], v[132:133], v[68:69]
v_pk_add_f32 v[134:135], v[134:135], v[70:71]
s_waitcnt lgkmcnt(9)
v_pk_add_f32 v[136:137], v[136:137], v[72:73]
v_pk_add_f32 v[138:139], v[138:139], v[74:75]
s_waitcnt lgkmcnt(8)
v_pk_add_f32 v[140:141], v[140:141], v[76:77]
v_pk_add_f32 v[142:143], v[142:143], v[78:79]
v_pk_mul_f32 v[192:193], v[128:129], s[78:79] op_sel_hi:[1,0]
v_pk_mul_f32 v[194:195], v[130:131], s[78:79] op_sel_hi:[1,0]
v_pk_mul_f32 v[196:197], v[132:133], s[78:79] op_sel_hi:[1,0]
v_pk_mul_f32 v[198:199], v[134:135], s[78:79] op_sel_hi:[1,0]
v_pk_mul_f32 v[200:201], v[136:137], s[78:79] op_sel_hi:[1,0]
v_pk_mul_f32 v[202:203], v[138:139], s[78:79] op_sel_hi:[1,0]
v_pk_mul_f32 v[204:205], v[140:141], s[78:79] op_sel_hi:[1,0]
v_pk_mul_f32 v[206:207], v[142:143], s[78:79] op_sel_hi:[1,0]
v_exp_f32 v192, v192
v_exp_f32 v193, v193
v_exp_f32 v194, v194
v_exp_f32 v195, v195
v_exp_f32 v196, v196
v_exp_f32 v197, v197
v_exp_f32 v198, v198
v_exp_f32 v199, v199
v_exp_f32 v200, v200
v_exp_f32 v201, v201
v_exp_f32 v202, v202
v_exp_f32 v203, v203
v_exp_f32 v204, v204
v_exp_f32 v205, v205
v_exp_f32 v206, v206
v_exp_f32 v207, v207
v_pk_add_f32 v[192:193], v[192:193], 1.0 op_sel_hi:[1,0]
v_pk_add_f32 v[194:195], v[194:195], 1.0 op_sel_hi:[1,0]
v_pk_add_f32 v[196:197], v[196:197], 1.0 op_sel_hi:[1,0]
v_pk_add_f32 v[198:199], v[198:199], 1.0 op_sel_hi:[1,0]
v_pk_add_f32 v[200:201], v[200:201], 1.0 op_sel_hi:[1,0]
v_pk_add_f32 v[202:203], v[202:203], 1.0 op_sel_hi:[1,0]
v_pk_add_f32 v[204:205], v[204:205], 1.0 op_sel_hi:[1,0]
v_pk_add_f32 v[206:207], v[206:207], 1.0 op_sel_hi:[1,0]
v_rcp_f32 v192, v192
v_rcp_f32 v193, v193
v_rcp_f32 v194, v194
v_rcp_f32 v195, v195
v_rcp_f32 v196, v196
v_rcp_f32 v197, v197
v_rcp_f32 v198, v198
v_rcp_f32 v199, v199
v_rcp_f32 v200, v200
v_rcp_f32 v201, v201
v_rcp_f32 v202, v202
v_rcp_f32 v203, v203
v_rcp_f32 v204, v204
v_rcp_f32 v205, v205
v_rcp_f32 v206, v206
v_rcp_f32 v207, v207
v_pk_mul_f32 v[128:129], v[128:129], v[192:193]
v_pk_mul_f32 v[130:131], v[130:131], v[194:195]
v_pk_mul_f32 v[132:133], v[132:133], v[196:197]
v_pk_mul_f32 v[134:135], v[134:135], v[198:199]
v_pk_mul_f32 v[136:137], v[136:137], v[200:201]
v_pk_mul_f32 v[138:139], v[138:139], v[202:203]
v_pk_mul_f32 v[140:141], v[140:141], v[204:205]
v_pk_mul_f32 v[142:143], v[142:143], v[206:207]
s_waitcnt lgkmcnt(6)
v_mfma_f32_32x32x16_bf16 v[176:191], v[44:47], a[148:151], v[176:191]
ds_read_b64_tr_b16 v[60:61], v21 offset:6144
ds_read_b64_tr_b16 v[62:63], v21 offset:7168
s_waitcnt vmcnt(9) lgkmcnt(6)
v_mfma_f32_32x32x16_bf16 v[160:175], v[48:51], a[152:155], v[160:175]
v_accvgpr_read_b32 v25, a241
v_accvgpr_read_b32 v96, a244
v_accvgpr_read_b32 v97, a245
s_barrier
ds_read_b64_tr_b16 v[32:33], v20 offset:49152
ds_read_b64_tr_b16 v[34:35], v20 offset:50176
s_waitcnt lgkmcnt(6)
v_mfma_f32_32x32x16_bf16 v[176:191], v[52:55], a[152:155], v[176:191]
ds_read_b64_tr_b16 v[36:37], v21 offset:49152
ds_read_b64_tr_b16 v[38:39], v21 offset:50176
v_accvgpr_read_b32 v98, a246
v_accvgpr_read_b32 v99, a247
s_waitcnt vmcnt(8) lgkmcnt(6)
v_mfma_f32_32x32x16_bf16 v[160:175], v[56:59], a[156:159], v[160:175]
ds_read_b64_tr_b16 v[40:41], v20 offset:51200
ds_read_b64_tr_b16 v[42:43], v20 offset:52224
v_accvgpr_read_b32 v100, a248
v_accvgpr_read_b32 v101, a249
s_waitcnt lgkmcnt(6)
v_mfma_f32_32x32x16_bf16 v[176:191], v[60:63], a[156:159], v[176:191]
ds_read_b64_tr_b16 v[44:45], v21 offset:51200
ds_read_b64_tr_b16 v[46:47], v21 offset:52224
v_accvgpr_read_b32 v102, a250
v_accvgpr_read_b32 v103, a251
s_waitcnt vmcnt(7) lgkmcnt(6)
v_mfma_f32_32x32x16_bf16 v[160:175], v[32:35], a[160:163], v[160:175]
ds_read_b64_tr_b16 v[48:49], v20 offset:53248
ds_read_b64_tr_b16 v[50:51], v20 offset:54272
v_lshlrev_b32 v112, 16, v96
v_and_b32 v113, 0xffff0000, v96
s_waitcnt lgkmcnt(6)
v_mfma_f32_32x32x16_bf16 v[176:191], v[36:39], a[160:163], v[176:191]
ds_read_b64_tr_b16 v[52:53], v21 offset:53248
ds_read_b64_tr_b16 v[54:55], v21 offset:54272
v_lshlrev_b32 v114, 16, v97
v_and_b32 v115, 0xffff0000, v97
s_waitcnt vmcnt(6) lgkmcnt(6)
v_mfma_f32_32x32x16_bf16 v[160:175], v[40:43], a[164:167], v[160:175]
ds_read_b64_tr_b16 v[56:57], v20 offset:55296
ds_read_b64_tr_b16 v[58:59], v20 offset:56320
v_lshlrev_b32 v116, 16, v98
v_and_b32 v117, 0xffff0000, v98
s_waitcnt lgkmcnt(6)
v_mfma_f32_32x32x16_bf16 v[176:191], v[44:47], a[164:167], v[176:191]
ds_read_b64_tr_b16 v[60:61], v21 offset:55296
ds_read_b64_tr_b16 v[62:63], v21 offset:56320
v_lshlrev_b32 v118, 16, v99
v_and_b32 v119, 0xffff0000, v99
s_waitcnt vmcnt(5) lgkmcnt(6)
v_mfma_f32_32x32x16_bf16 v[160:175], v[48:51], a[168:171], v[160:175]
v_lshlrev_b32 v120, 16, v100
v_and_b32 v121, 0xffff0000, v100
s_barrier
v_add_u32 v21, 0xffff0000, v21
ds_read_b64_tr_b16 v[32:33], v21 offset:0
ds_read_b64_tr_b16 v[34:35], v21 offset:1024
s_waitcnt lgkmcnt(6)
v_mfma_f32_32x32x16_bf16 v[176:191], v[52:55], a[168:171], v[176:191]
ds_read_b64_tr_b16 v[36:37], v21 offset:2048
ds_read_b64_tr_b16 v[38:39], v21 offset:3072
v_lshlrev_b32 v122, 16, v101
v_and_b32 v123, 0xffff0000, v101
s_waitcnt vmcnt(4) lgkmcnt(6)
v_mfma_f32_32x32x16_bf16 v[160:175], v[56:59], a[172:175], v[160:175]
ds_read_b64_tr_b16 v[40:41], v21 offset:4096
ds_read_b64_tr_b16 v[42:43], v21 offset:5120
v_lshlrev_b32 v124, 16, v102
v_and_b32 v125, 0xffff0000, v102
s_waitcnt lgkmcnt(6)
v_mfma_f32_32x32x16_bf16 v[176:191], v[60:63], a[172:175], v[176:191]
ds_read_b64_tr_b16 v[44:45], v21 offset:6144
ds_read_b64_tr_b16 v[46:47], v21 offset:7168
v_lshlrev_b32 v126, 16, v103
v_and_b32 v127, 0xffff0000, v103
s_waitcnt vmcnt(3) lgkmcnt(6)
v_mfma_f32_32x32x16_bf16 v[176:191], v[32:35], a[176:179], v[176:191]
v_add_u32 v20, 0xffff0000, v20
ds_read_b64_tr_b16 v[48:49], v20 offset:0
ds_read_b64_tr_b16 v[50:51], v20 offset:1024
s_waitcnt vmcnt(2) lgkmcnt(6)
v_mfma_f32_32x32x16_bf16 v[176:191], v[36:39], a[180:183], v[176:191]
ds_read_b64_tr_b16 v[52:53], v20 offset:2048
ds_read_b64_tr_b16 v[54:55], v20 offset:3072
s_waitcnt vmcnt(1) lgkmcnt(6)
v_mfma_f32_32x32x16_bf16 v[176:191], v[40:43], a[184:187], v[176:191]
ds_read_b64_tr_b16 v[56:57], v20 offset:4096
ds_read_b64_tr_b16 v[58:59], v20 offset:5120
s_waitcnt vmcnt(0) lgkmcnt(6)
v_mfma_f32_32x32x16_bf16 v[176:191], v[44:47], a[188:191], v[176:191]
ds_read_b64_tr_b16 v[60:61], v20 offset:6144
ds_read_b64_tr_b16 v[62:63], v20 offset:7168
s_waitcnt lgkmcnt(6)
v_mfma_f32_32x32x16_bf16 v[160:175], v[48:51], a[176:179], v[160:175]
s_add_u32 s60, s59, 0x24000
v_add_u32 v22, s60, v1
s_nop 5
ds_write_b128 v22, v[176:179] offset:0
ds_write_b128 v22, v[180:183] offset:1024
ds_write_b128 v22, v[184:187] offset:2048
ds_write_b128 v22, v[188:191] offset:3072
s_waitcnt lgkmcnt(8)
v_mfma_f32_32x32x16_bf16 v[160:175], v[52:55], a[180:183], v[160:175]
s_waitcnt lgkmcnt(6)
v_mfma_f32_32x32x16_bf16 v[160:175], v[56:59], a[184:187], v[160:175]
s_waitcnt lgkmcnt(4)
v_mfma_f32_32x32x16_bf16 v[160:175], v[60:63], a[188:191], v[160:175]
s_waitcnt lgkmcnt(0)
s_barrier
v_xor_b32 v22, 0x2000, v22
ds_read_b128 v[80:83], v22 offset:0
ds_read_b128 v[84:87], v22 offset:1024
ds_read_b128 v[88:91], v22 offset:2048
ds_read_b128 v[92:95], v22 offset:3072
s_waitcnt lgkmcnt(3)
s_nop 3
v_pk_add_f32 v[160:161], v[160:161], v[80:81]
v_pk_add_f32 v[162:163], v[162:163], v[82:83]
s_waitcnt lgkmcnt(2)
v_pk_add_f32 v[164:165], v[164:165], v[84:85]
v_pk_add_f32 v[166:167], v[166:167], v[86:87]
s_waitcnt lgkmcnt(1)
v_pk_add_f32 v[168:169], v[168:169], v[88:89]
v_pk_add_f32 v[170:171], v[170:171], v[90:91]
s_waitcnt lgkmcnt(0)
v_pk_add_f32 v[172:173], v[172:173], v[92:93]
v_pk_add_f32 v[174:175], v[174:175], v[94:95]
v_pk_fma_f32 v[128:129], v[128:129], v[160:161], v[112:113]
v_pk_fma_f32 v[130:131], v[130:131], v[162:163], v[114:115]
v_pk_fma_f32 v[132:133], v[132:133], v[164:165], v[116:117]
v_pk_fma_f32 v[134:135], v[134:135], v[166:167], v[118:119]
v_pk_fma_f32 v[136:137], v[136:137], v[168:169], v[120:121]
v_pk_fma_f32 v[138:139], v[138:139], v[170:171], v[122:123]
v_pk_fma_f32 v[140:141], v[140:141], v[172:173], v[124:125]
v_pk_fma_f32 v[142:143], v[142:143], v[174:175], v[126:127]
v_cvt_pk_bf16_f32 v48, v128, v129
v_cvt_pk_bf16_f32 v49, v130, v131
v_cvt_pk_bf16_f32 v50, v132, v133
v_cvt_pk_bf16_f32 v51, v134, v135
v_cvt_pk_bf16_f32 v52, v136, v137
v_cvt_pk_bf16_f32 v53, v138, v139
v_cvt_pk_bf16_f32 v54, v140, v141
v_cvt_pk_bf16_f32 v55, v142, v143
v_permlane32_swap_b32 v48, v50
v_permlane32_swap_b32 v49, v51
v_permlane32_swap_b32 v52, v54
v_permlane32_swap_b32 v53, v55
buffer_store_dwordx4 v[48:51], v25, s[36:39], 0 offen offset:0
buffer_store_dwordx4 v[52:55], v25, s[36:39], 0 offen offset:32
s_or_b32 s60, s2, s48
s_cmp_lg_u32 s60, 0
s_cbranch_scc1 Lnoep_72
s_mov_b32 s60, 0x1200000
s_mov_b64 exec, 1
buffer_store_dword v30, v29, s[40:43], s60 offen sc1
s_mov_b64 exec, -1
Lnoep_72:
L_end:
s_endpgm
L_code_end:
.set CODE_BYTES, L_code_end-recurrent_scan__linear_kernel_hedgehog__mixer_s_mlp__prompt_kernel
.section .rodata,"a"
.p2align 6
.amdhsa_kernel recurrent_scan__linear_kernel_hedgehog__mixer_s_mlp__prompt_kernel
  .amdhsa_next_free_vgpr 512
  .amdhsa_next_free_sgpr 102
  .amdhsa_accum_offset 256
  .amdhsa_group_segment_fixed_size 0
  .amdhsa_kernarg_size 96
  .amdhsa_user_sgpr_count 2
  .amdhsa_user_sgpr_kernarg_segment_ptr 1
  .amdhsa_system_sgpr_workgroup_id_x 1
.end_amdhsa_kernel
```
